```python
import torch

def _softmax(x, axis=-1):
    return torch.softmax(x, dim=axis)

def _gelu(x):
    return torch.nn.functional.gelu(x, approximate='tanh')

def _silu(x):
    return torch.nn.functional.silu(x)

def _sigmoid(x):
    return torch.sigmoid(x)

def _layernorm(x, axis=-1, eps=1e-05):
    m = x.mean(dim=axis, keepdim=True)
    v = x.var(dim=axis, keepdim=True, unbiased=False)
    return (x - m) / torch.sqrt(v + eps)

def _scatter_add(tgt, idx, src, axis=0):
    return tgt.clone().index_add_(axis, idx, src)

def _segment_sum(src, seg, n):
    out = torch.zeros((n,) + src.shape[1:], dtype=src.dtype)
    return out.index_add_(0, seg, src)

def _pad(x, pw):
    flat = tuple((v for pair in reversed(pw) for v in pair))
    return torch.nn.functional.pad(x, flat)
kernel_name = 'sequential_preLN__memory_aug_recurrent_mem_tr__glu_gated_reglu__prompt'

def setup_inputs():

    _w = lambda a: (lambda t: t.to(torch.bfloat16) if t.is_floating_point() else t)(torch.as_tensor(a))

    def _A_setup():
        B, S, Dm = (1, 2048, 448)
        H, Dh = (16, 256)
        M, seg = (8, 32)
        seg = min(seg, S)
        S = S // seg * seg
        return {'x': _w((lambda *s: torch.randn(*s, dtype=torch.bfloat16) * 0.05)(B, S, Dm)), 'mem0': _w((lambda *s: torch.randn(*s, dtype=torch.bfloat16) * 0.2)(B, M, Dm)), 'Wq': _w((lambda *s: torch.randn(*s, dtype=torch.bfloat16) * 1.6)(Dm, H, Dh) * Dm ** (-0.5)), 'Wk': _w((lambda *s: torch.randn(*s, dtype=torch.bfloat16) * 1.6)(Dm, H, Dh) * Dm ** (-0.5)), 'Wv': _w((lambda *s: torch.randn(*s, dtype=torch.bfloat16) * 0.2)(Dm, H, Dh) * Dm ** (-0.5)), 'Wo': _w((lambda *s: torch.randn(*s, dtype=torch.bfloat16) * 0.2)(H, Dh, Dm) * (H * Dh) ** (-0.5)), 'seg_len': seg}
    _A_in = _A_setup()

    def _B_setup():
        B, S, D, F = (1, 2048, 448, 1792)
        return {'x': _w((lambda *s: torch.randn(*s, dtype=torch.bfloat16) * 0.05)(B, S, D)), 'W_gate': _w((lambda *s: torch.randn(*s, dtype=torch.bfloat16) * 0.2)(D, F) * (2.0 / D) ** 0.5), 'W_up': _w((lambda *s: torch.randn(*s, dtype=torch.bfloat16) * 0.2)(D, F) * (2.0 / D) ** 0.5), 'W_down': _w((lambda *s: torch.randn(*s, dtype=torch.bfloat16) * 0.2)(F, D) * (1.0 / F) ** 0.5)}
    _B_in = _B_setup()
    return {'A_x': _A_in['x'], 'A_mem0': _A_in['mem0'], 'A_Wq': _A_in['Wq'], 'A_Wk': _A_in['Wk'], 'A_Wv': _A_in['Wv'], 'A_Wo': _A_in['Wo'], 'A_seg_len': _A_in['seg_len'], 'B_x': _B_in['x'], 'B_W_gate': _B_in['W_gate'], 'B_W_up': _B_in['W_up'], 'B_W_down': _B_in['W_down']}

def reference(A_x, A_mem0, A_Wq, A_Wk, A_Wv, A_Wo, A_seg_len, B_x, B_W_gate, B_W_up, B_W_down):

    def _A_ref(x, mem0, Wq, Wk, Wv, Wo, seg_len):
        B, S, Dm = x.shape
        H, Dh = (Wq.shape[1], Wq.shape[2])
        M = mem0.shape[1]
        scale = Dh ** (-0.5)
        n_seg = S // seg_len
        L = M + seg_len
        idx = torch.arange(L)
        mask = (idx[:, None] < M) | (idx[:, None] >= idx[None, :])
        mem = mem0
        outs = []
        for s in range(n_seg):
            xs = x[:, s * seg_len:(s + 1) * seg_len, :].clone()
            h = torch.concatenate([mem, xs], axis=1)
            q = torch.einsum('btd,dhe->bhte', h, Wq)
            k = torch.einsum('btd,dhe->bhte', h, Wk)
            v = torch.einsum('btd,dhe->bhte', h, Wv)
            scores = torch.einsum('bhqe,bhke->bhqk', q, k) * scale
            scores = torch.where(mask[None, None], scores, -1000000000.0)
            p = _softmax(scores, axis=-1)
            o = torch.einsum('bhqk,bhke->bhqe', p, v)
            o = torch.einsum('bhte,hed->btd', o, Wo)
            mem = o[:, :M, :].clone()
            outs.append(o[:, M:, :])
        return torch.concatenate(outs, axis=1)

    def _B_ref(x, W_gate, W_up, W_down):
        gate = torch.einsum('bsd,df->bsf', x, W_gate)
        up = torch.einsum('bsd,df->bsf', x, W_up)
        gate = gate * (lambda x, dt: x.to(dt))(gate > 0, gate.dtype)
        h = gate * up
        return torch.einsum('bsf,fd->bsd', h, W_down)
    x = A_x
    h = x + _A_ref(_layernorm(x, axis=-1), A_mem0, A_Wq, A_Wk, A_Wv, A_Wo, A_seg_len)
    h2 = h + _B_ref(_layernorm(h, axis=-1), B_W_gate, B_W_up, B_W_down)
    return h2
```

```asm
; @launch kernel=k1_kernel grid=(593,1,1) block=(256,1,1) lds=70656
; @launch kernel=k2_kernel grid=(256,1,1) block=(256,1,1) lds=162368
.amdgcn_target "amdgcn-amd-amdhsa--gfx950"
.text
.globl k1_kernel
.p2align 8
.type k1_kernel,@function
k1_kernel:
    s_cmp_ge_u32 s2, 593
    s_cbranch_scc1 K1_EXIT
    s_load_dwordx16 s[8:23], s[0:1], 0
    s_load_dwordx8 s[24:31], s[0:1], 64
    s_load_dwordx4 s[32:35], s[0:1], 96
    v_lshrrev_b32 v2, 6, v0
    v_and_b32 v1, 63, v0
    s_nop 0
    v_readfirstlane_b32 s40, v2
    s_waitcnt lgkmcnt(0)
    s_mov_b32 s36, s34
    s_and_b32 s37, s35, 0xffff
    s_mov_b32 s38, 0x10000000
    s_mov_b32 s39, 0x00020000
    s_cmp_lt_u32 s2, 448
    s_cbranch_scc1 K1_AB
    s_cmp_lt_u32 s2, 577
    s_cbranch_scc1 K1_LN
    s_branch K1_INIT
K1_EXIT:
    s_endpgm
K1_AB:
    s_cmp_ge_u32 s2, 224
    s_cselect_b32 s62, 1, 0
    s_cselect_b32 s63, 224, 0
    s_sub_u32 s2, s2, s63
    s_lshr_b32 s42, s2, 3
    s_mul_i32 s41, s42, 9363
    s_lshr_b32 s41, s41, 16
    s_mul_i32 s43, s41, 7
    s_sub_u32 s42, s42, s43
    s_lshl_b32 s41, s41, 3
    s_and_b32 s43, s2, 7
    s_add_u32 s41, s41, s43
    s_and_b32 s43, s41, 15
    s_lshr_b32 s48, s41, 4
    v_and_b32 v2, 15, v1
    v_lshrrev_b32 v3, 4, v1
    s_cmp_eq_u32 s48, 0
    s_cselect_b32 s44, s12, s16
    s_cselect_b32 s45, s13, s17
    s_cselect_b32 s49, 0x3d800000, 1.0
    s_and_b32 s45, s45, 0xffff
    s_mov_b32 s46, 0x380000
    s_mov_b32 s47, 0x00020000
    v_lshrrev_b32 v4, 5, v1
    s_lshl_b32 s50, s40, 4
    v_add_u32 v5, s50, v4
    v_lshlrev_b32 v5, 13, v5
    v_and_b32 v10, 31, v1
    v_lshl_add_u32 v5, v10, 4, v5
    s_lshl_b32 s51, s43, 9
    v_add_u32 v5, s51, v5
    s_mul_i32 s50, s40, 8448
    s_add_u32 s50, s50, 36864
    v_mul_u32_u24 v4, 528, v4
    v_lshl_add_u32 v4, v10, 4, v4
    v_add_u32 v4, s50, v4
    v_mul_u32_u24 v11, 528, v2
    v_lshl_add_u32 v11, v3, 4, v11
    v_add_u32 v11, s50, v11
    v_lshrrev_b32 v6, 1, v3
    v_lshlrev_b32 v6, 9, v6
    v_lshl_add_u32 v6, v2, 4, v6
    v_and_b32 v7, 1, v3
    v_lshl_add_u32 v6, v7, 3, v6
    s_mul_i32 s52, s41, 14
    s_lshl_b32 s53, s42, 1
    s_add_u32 s52, s52, s53
    s_mul_i32 s52, s52, 28
    s_add_u32 s52, s52, s40
    s_lshl_b32 s52, s52, 10
    s_add_u32 s52, s52, 4194304
    s_cmp_eq_u32 s48, 0
    s_cbranch_scc0 K1_AB_RESB
    s_mov_b32 s56, s14
    s_and_b32 s57, s15, 0xffff
    s_mov_b32 s58, 0x380000
    s_mov_b32 s59, 0x00020000
    v_lshrrev_b32 v10, 5, v0
    v_and_b32 v12, 31, v0
    s_lshl_b32 s53, s42, 6
    v_add_u32 v13, s53, v10
    v_lshlrev_b32 v13, 13, v13
    v_lshl_add_u32 v13, v12, 4, v13
    v_add_u32 v13, s51, v13
    v_mul_u32_u24 v14, 528, v10
    v_lshl_add_u32 v14, v12, 4, v14
    s_mov_b32 s53, 0
    buffer_load_dwordx4 v[64:67], v13, s[56:59], s53 offen
    s_mov_b32 s53, 65536
    buffer_load_dwordx4 v[68:71], v13, s[56:59], s53 offen
    s_mov_b32 s53, 131072
    buffer_load_dwordx4 v[72:75], v13, s[56:59], s53 offen
    s_mov_b32 s53, 196608
    buffer_load_dwordx4 v[76:79], v13, s[56:59], s53 offen
    s_mov_b32 s53, 262144
    buffer_load_dwordx4 v[80:83], v13, s[56:59], s53 offen
    s_mov_b32 s53, 327680
    buffer_load_dwordx4 v[84:87], v13, s[56:59], s53 offen
    s_mov_b32 s53, 393216
    buffer_load_dwordx4 v[88:91], v13, s[56:59], s53 offen
    s_mov_b32 s53, 458752
    buffer_load_dwordx4 v[92:95], v13, s[56:59], s53 offen
    s_mul_i32 s53, s62, 2097152
    s_add_u32 s53, s53, 0
    buffer_load_dwordx4 v[192:195], v5, s[44:47], s53 offen offset:0
    s_add_u32 s53, s53, 16384
    buffer_load_dwordx4 v[196:199], v5, s[44:47], s53 offen
    s_add_u32 s53, s53, 16384
    buffer_load_dwordx4 v[200:203], v5, s[44:47], s53 offen
    s_add_u32 s53, s53, 16384
    buffer_load_dwordx4 v[204:207], v5, s[44:47], s53 offen
    s_add_u32 s53, s53, 16384
    buffer_load_dwordx4 v[208:211], v5, s[44:47], s53 offen
    s_add_u32 s53, s53, 16384
    buffer_load_dwordx4 v[212:215], v5, s[44:47], s53 offen
    s_add_u32 s53, s53, 16384
    buffer_load_dwordx4 v[216:219], v5, s[44:47], s53 offen
    s_add_u32 s53, s53, 16384
    buffer_load_dwordx4 v[220:223], v5, s[44:47], s53 offen
    s_waitcnt vmcnt(15)
    ds_write_b128 v14, v[64:67] offset:0
    s_waitcnt vmcnt(14)
    ds_write_b128 v14, v[68:71] offset:4224
    s_waitcnt vmcnt(13)
    ds_write_b128 v14, v[72:75] offset:8448
    s_waitcnt vmcnt(12)
    ds_write_b128 v14, v[76:79] offset:12672
    s_waitcnt vmcnt(11)
    ds_write_b128 v14, v[80:83] offset:16896
    s_waitcnt vmcnt(10)
    ds_write_b128 v14, v[84:87] offset:21120
    s_waitcnt vmcnt(9)
    ds_write_b128 v14, v[88:91] offset:25344
    s_waitcnt vmcnt(8)
    ds_write_b128 v14, v[92:95] offset:29568
    s_waitcnt lgkmcnt(0)
    s_barrier
    v_lshrrev_b32 v10, 3, v2
    v_lshlrev_b32 v10, 4, v10
    v_bfe_u32 v12, v2, 1, 2
    v_lshl_add_u32 v10, v12, 2, v10
    v_and_b32 v12, 1, v2
    v_add_u32 v10, v10, v12
    v_mul_u32_u24 v10, 528, v10
    v_lshl_add_u32 v10, v3, 4, v10
    ds_read_b128 v[64:67], v10 offset:0
    ds_read_b128 v[68:71], v10 offset:64
    ds_read_b128 v[72:75], v10 offset:128
    ds_read_b128 v[76:79], v10 offset:192
    ds_read_b128 v[80:83], v10 offset:256
    ds_read_b128 v[84:87], v10 offset:320
    ds_read_b128 v[88:91], v10 offset:384
    ds_read_b128 v[92:95], v10 offset:448
    s_waitcnt lgkmcnt(0)
    ds_read_b128 v[96:99], v10 offset:16896
    ds_read_b128 v[100:103], v10 offset:16960
    ds_read_b128 v[104:107], v10 offset:17024
    ds_read_b128 v[108:111], v10 offset:17088
    ds_read_b128 v[112:115], v10 offset:17152
    ds_read_b128 v[116:119], v10 offset:17216
    ds_read_b128 v[120:123], v10 offset:17280
    ds_read_b128 v[124:127], v10 offset:17344
    s_waitcnt lgkmcnt(0)
    ds_read_b128 v[128:131], v10 offset:1056
    ds_read_b128 v[132:135], v10 offset:1120
    ds_read_b128 v[136:139], v10 offset:1184
    ds_read_b128 v[140:143], v10 offset:1248
    ds_read_b128 v[144:147], v10 offset:1312
    ds_read_b128 v[148:151], v10 offset:1376
    ds_read_b128 v[152:155], v10 offset:1440
    ds_read_b128 v[156:159], v10 offset:1504
    s_waitcnt lgkmcnt(0)
    ds_read_b128 v[160:163], v10 offset:17952
    ds_read_b128 v[164:167], v10 offset:18016
    ds_read_b128 v[168:171], v10 offset:18080
    ds_read_b128 v[172:175], v10 offset:18144
    ds_read_b128 v[176:179], v10 offset:18208
    ds_read_b128 v[180:183], v10 offset:18272
    ds_read_b128 v[184:187], v10 offset:18336
    ds_read_b128 v[188:191], v10 offset:18400
    s_waitcnt lgkmcnt(0)
    s_branch K1_AB_MAIN
K1_AB_RESB:
    s_mov_b32 s56, s18
    s_and_b32 s57, s19, 0xffff
    s_mov_b32 s58, 0x380000
    s_mov_b32 s59, 0x00020000
    v_lshrrev_b32 v10, 3, v0
    v_and_b32 v12, 7, v0
    s_lshl_b32 s53, s43, 8
    v_add_u32 v13, s53, v10
    v_mul_u32_u24 v13, 896, v13
    v_lshl_add_u32 v13, v12, 4, v13
    s_lshl_b32 s53, s42, 7
    v_add_u32 v13, s53, v13
    v_mul_u32_u24 v14, 144, v10
    v_lshl_add_u32 v14, v12, 4, v14
    s_mov_b32 s53, 0
    buffer_load_dwordx4 v[64:67], v13, s[56:59], s53 offen
    s_mov_b32 s53, 28672
    buffer_load_dwordx4 v[68:71], v13, s[56:59], s53 offen
    s_mov_b32 s53, 57344
    buffer_load_dwordx4 v[72:75], v13, s[56:59], s53 offen
    s_mov_b32 s53, 86016
    buffer_load_dwordx4 v[76:79], v13, s[56:59], s53 offen
    s_mov_b32 s53, 114688
    buffer_load_dwordx4 v[80:83], v13, s[56:59], s53 offen
    s_mov_b32 s53, 143360
    buffer_load_dwordx4 v[84:87], v13, s[56:59], s53 offen
    s_mov_b32 s53, 172032
    buffer_load_dwordx4 v[88:91], v13, s[56:59], s53 offen
    s_mov_b32 s53, 200704
    buffer_load_dwordx4 v[92:95], v13, s[56:59], s53 offen
    s_mul_i32 s53, s62, 2097152
    s_add_u32 s53, s53, 0
    buffer_load_dwordx4 v[192:195], v5, s[44:47], s53 offen offset:0
    s_add_u32 s53, s53, 16384
    buffer_load_dwordx4 v[196:199], v5, s[44:47], s53 offen
    s_add_u32 s53, s53, 16384
    buffer_load_dwordx4 v[200:203], v5, s[44:47], s53 offen
    s_add_u32 s53, s53, 16384
    buffer_load_dwordx4 v[204:207], v5, s[44:47], s53 offen
    s_add_u32 s53, s53, 16384
    buffer_load_dwordx4 v[208:211], v5, s[44:47], s53 offen
    s_add_u32 s53, s53, 16384
    buffer_load_dwordx4 v[212:215], v5, s[44:47], s53 offen
    s_add_u32 s53, s53, 16384
    buffer_load_dwordx4 v[216:219], v5, s[44:47], s53 offen
    s_add_u32 s53, s53, 16384
    buffer_load_dwordx4 v[220:223], v5, s[44:47], s53 offen
    s_waitcnt vmcnt(15)
    ds_write_b128 v14, v[64:67] offset:0
    s_waitcnt vmcnt(14)
    ds_write_b128 v14, v[68:71] offset:4608
    s_waitcnt vmcnt(13)
    ds_write_b128 v14, v[72:75] offset:9216
    s_waitcnt vmcnt(12)
    ds_write_b128 v14, v[76:79] offset:13824
    s_waitcnt vmcnt(11)
    ds_write_b128 v14, v[80:83] offset:18432
    s_waitcnt vmcnt(10)
    ds_write_b128 v14, v[84:87] offset:23040
    s_waitcnt vmcnt(9)
    ds_write_b128 v14, v[88:91] offset:27648
    s_waitcnt vmcnt(8)
    ds_write_b128 v14, v[92:95] offset:32256
    s_waitcnt lgkmcnt(0)
    s_barrier
    v_lshrrev_b32 v10, 2, v2
    v_lshl_add_u32 v10, v3, 3, v10
    v_mul_u32_u24 v10, 144, v10
    v_and_b32 v12, 3, v2
    v_lshl_add_u32 v10, v12, 3, v10
    ds_read_b64_tr_b16 v[64:65], v10 offset:0
    ds_read_b64_tr_b16 v[66:67], v10 offset:576
    ds_read_b64_tr_b16 v[68:69], v10 offset:4608
    ds_read_b64_tr_b16 v[70:71], v10 offset:5184
    ds_read_b64_tr_b16 v[72:73], v10 offset:9216
    ds_read_b64_tr_b16 v[74:75], v10 offset:9792
    ds_read_b64_tr_b16 v[76:77], v10 offset:13824
    ds_read_b64_tr_b16 v[78:79], v10 offset:14400
    ds_read_b64_tr_b16 v[80:81], v10 offset:18432
    ds_read_b64_tr_b16 v[82:83], v10 offset:19008
    ds_read_b64_tr_b16 v[84:85], v10 offset:23040
    ds_read_b64_tr_b16 v[86:87], v10 offset:23616
    ds_read_b64_tr_b16 v[88:89], v10 offset:27648
    ds_read_b64_tr_b16 v[90:91], v10 offset:28224
    ds_read_b64_tr_b16 v[92:93], v10 offset:32256
    ds_read_b64_tr_b16 v[94:95], v10 offset:32832
    s_waitcnt lgkmcnt(0)
    ds_read_b64_tr_b16 v[96:97], v10 offset:32
    ds_read_b64_tr_b16 v[98:99], v10 offset:608
    ds_read_b64_tr_b16 v[100:101], v10 offset:4640
    ds_read_b64_tr_b16 v[102:103], v10 offset:5216
    ds_read_b64_tr_b16 v[104:105], v10 offset:9248
    ds_read_b64_tr_b16 v[106:107], v10 offset:9824
    ds_read_b64_tr_b16 v[108:109], v10 offset:13856
    ds_read_b64_tr_b16 v[110:111], v10 offset:14432
    ds_read_b64_tr_b16 v[112:113], v10 offset:18464
    ds_read_b64_tr_b16 v[114:115], v10 offset:19040
    ds_read_b64_tr_b16 v[116:117], v10 offset:23072
    ds_read_b64_tr_b16 v[118:119], v10 offset:23648
    ds_read_b64_tr_b16 v[120:121], v10 offset:27680
    ds_read_b64_tr_b16 v[122:123], v10 offset:28256
    ds_read_b64_tr_b16 v[124:125], v10 offset:32288
    ds_read_b64_tr_b16 v[126:127], v10 offset:32864
    s_waitcnt lgkmcnt(0)
    ds_read_b64_tr_b16 v[128:129], v10 offset:64
    ds_read_b64_tr_b16 v[130:131], v10 offset:640
    ds_read_b64_tr_b16 v[132:133], v10 offset:4672
    ds_read_b64_tr_b16 v[134:135], v10 offset:5248
    ds_read_b64_tr_b16 v[136:137], v10 offset:9280
    ds_read_b64_tr_b16 v[138:139], v10 offset:9856
    ds_read_b64_tr_b16 v[140:141], v10 offset:13888
    ds_read_b64_tr_b16 v[142:143], v10 offset:14464
    ds_read_b64_tr_b16 v[144:145], v10 offset:18496
    ds_read_b64_tr_b16 v[146:147], v10 offset:19072
    ds_read_b64_tr_b16 v[148:149], v10 offset:23104
    ds_read_b64_tr_b16 v[150:151], v10 offset:23680
    ds_read_b64_tr_b16 v[152:153], v10 offset:27712
    ds_read_b64_tr_b16 v[154:155], v10 offset:28288
    ds_read_b64_tr_b16 v[156:157], v10 offset:32320
    ds_read_b64_tr_b16 v[158:159], v10 offset:32896
    s_waitcnt lgkmcnt(0)
    ds_read_b64_tr_b16 v[160:161], v10 offset:96
    ds_read_b64_tr_b16 v[162:163], v10 offset:672
    ds_read_b64_tr_b16 v[164:165], v10 offset:4704
    ds_read_b64_tr_b16 v[166:167], v10 offset:5280
    ds_read_b64_tr_b16 v[168:169], v10 offset:9312
    ds_read_b64_tr_b16 v[170:171], v10 offset:9888
    ds_read_b64_tr_b16 v[172:173], v10 offset:13920
    ds_read_b64_tr_b16 v[174:175], v10 offset:14496
    ds_read_b64_tr_b16 v[176:177], v10 offset:18528
    ds_read_b64_tr_b16 v[178:179], v10 offset:19104
    ds_read_b64_tr_b16 v[180:181], v10 offset:23136
    ds_read_b64_tr_b16 v[182:183], v10 offset:23712
    ds_read_b64_tr_b16 v[184:185], v10 offset:27744
    ds_read_b64_tr_b16 v[186:187], v10 offset:28320
    ds_read_b64_tr_b16 v[188:189], v10 offset:32352
    ds_read_b64_tr_b16 v[190:191], v10 offset:32928
    s_waitcnt lgkmcnt(0)
K1_AB_MAIN:
    s_lshl_b32 s63, s62, 14
    s_add_u32 s52, s52, s63
    s_waitcnt vmcnt(0)
    ds_write_b128 v4, v[192:195] offset:0
    ds_write_b128 v4, v[196:199] offset:1056
    ds_write_b128 v4, v[200:203] offset:2112
    ds_write_b128 v4, v[204:207] offset:3168
    ds_write_b128 v4, v[208:211] offset:4224
    ds_write_b128 v4, v[212:215] offset:5280
    ds_write_b128 v4, v[216:219] offset:6336
    ds_write_b128 v4, v[220:223] offset:7392
    s_nop 1
    s_mul_i32 s53, s62, 2097152
    s_add_u32 s53, s53, 524288
    buffer_load_dwordx4 v[192:195], v5, s[44:47], s53 offen offset:0
    s_add_u32 s53, s53, 16384
    buffer_load_dwordx4 v[196:199], v5, s[44:47], s53 offen
    s_add_u32 s53, s53, 16384
    buffer_load_dwordx4 v[200:203], v5, s[44:47], s53 offen
    s_add_u32 s53, s53, 16384
    buffer_load_dwordx4 v[204:207], v5, s[44:47], s53 offen
    s_add_u32 s53, s53, 16384
    buffer_load_dwordx4 v[208:211], v5, s[44:47], s53 offen
    s_add_u32 s53, s53, 16384
    buffer_load_dwordx4 v[212:215], v5, s[44:47], s53 offen
    s_add_u32 s53, s53, 16384
    buffer_load_dwordx4 v[216:219], v5, s[44:47], s53 offen
    s_add_u32 s53, s53, 16384
    buffer_load_dwordx4 v[220:223], v5, s[44:47], s53 offen
    ds_read_b128 v[224:227], v11 offset:0
    ds_read_b128 v[228:231], v11 offset:64
    ds_read_b128 v[232:235], v11 offset:128
    ds_read_b128 v[236:239], v11 offset:192
    ds_read_b128 v[240:243], v11 offset:256
    ds_read_b128 v[244:247], v11 offset:320
    ds_read_b128 v[248:251], v11 offset:384
    ds_read_b128 v[252:255], v11 offset:448
    s_waitcnt lgkmcnt(7)
    v_mfma_f32_16x16x32_bf16 v[32:35], v[224:227], v[64:67], 0
    v_mfma_f32_16x16x32_bf16 v[36:39], v[224:227], v[96:99], 0
    v_mfma_f32_16x16x32_bf16 v[40:43], v[224:227], v[128:131], 0
    v_mfma_f32_16x16x32_bf16 v[44:47], v[224:227], v[160:163], 0
    s_waitcnt lgkmcnt(6)
    v_mfma_f32_16x16x32_bf16 v[32:35], v[228:231], v[68:71], v[32:35]
    v_mfma_f32_16x16x32_bf16 v[36:39], v[228:231], v[100:103], v[36:39]
    v_mfma_f32_16x16x32_bf16 v[40:43], v[228:231], v[132:135], v[40:43]
    v_mfma_f32_16x16x32_bf16 v[44:47], v[228:231], v[164:167], v[44:47]
    s_waitcnt lgkmcnt(5)
    v_mfma_f32_16x16x32_bf16 v[32:35], v[232:235], v[72:75], v[32:35]
    v_mfma_f32_16x16x32_bf16 v[36:39], v[232:235], v[104:107], v[36:39]
    v_mfma_f32_16x16x32_bf16 v[40:43], v[232:235], v[136:139], v[40:43]
    v_mfma_f32_16x16x32_bf16 v[44:47], v[232:235], v[168:171], v[44:47]
    s_waitcnt lgkmcnt(4)
    v_mfma_f32_16x16x32_bf16 v[32:35], v[236:239], v[76:79], v[32:35]
    v_mfma_f32_16x16x32_bf16 v[36:39], v[236:239], v[108:111], v[36:39]
    v_mfma_f32_16x16x32_bf16 v[40:43], v[236:239], v[140:143], v[40:43]
    v_mfma_f32_16x16x32_bf16 v[44:47], v[236:239], v[172:175], v[44:47]
    s_waitcnt lgkmcnt(3)
    v_mfma_f32_16x16x32_bf16 v[32:35], v[240:243], v[80:83], v[32:35]
    v_mfma_f32_16x16x32_bf16 v[36:39], v[240:243], v[112:115], v[36:39]
    v_mfma_f32_16x16x32_bf16 v[40:43], v[240:243], v[144:147], v[40:43]
    v_mfma_f32_16x16x32_bf16 v[44:47], v[240:243], v[176:179], v[44:47]
    s_waitcnt lgkmcnt(2)
    v_mfma_f32_16x16x32_bf16 v[32:35], v[244:247], v[84:87], v[32:35]
    v_mfma_f32_16x16x32_bf16 v[36:39], v[244:247], v[116:119], v[36:39]
    v_mfma_f32_16x16x32_bf16 v[40:43], v[244:247], v[148:151], v[40:43]
    v_mfma_f32_16x16x32_bf16 v[44:47], v[244:247], v[180:183], v[44:47]
    s_waitcnt lgkmcnt(1)
    v_mfma_f32_16x16x32_bf16 v[32:35], v[248:251], v[88:91], v[32:35]
    v_mfma_f32_16x16x32_bf16 v[36:39], v[248:251], v[120:123], v[36:39]
    v_mfma_f32_16x16x32_bf16 v[40:43], v[248:251], v[152:155], v[40:43]
    v_mfma_f32_16x16x32_bf16 v[44:47], v[248:251], v[184:187], v[44:47]
    s_waitcnt lgkmcnt(0)
    v_mfma_f32_16x16x32_bf16 v[32:35], v[252:255], v[92:95], v[32:35]
    v_mfma_f32_16x16x32_bf16 v[36:39], v[252:255], v[124:127], v[36:39]
    v_mfma_f32_16x16x32_bf16 v[40:43], v[252:255], v[156:159], v[40:43]
    v_mfma_f32_16x16x32_bf16 v[44:47], v[252:255], v[188:191], v[44:47]
    s_nop 7
    v_mul_f32 v32, s49, v32
    v_mul_f32 v33, s49, v33
    v_mul_f32 v34, s49, v34
    v_mul_f32 v35, s49, v35
    v_cvt_pk_bf16_f32 v48, v32, v33
    v_cvt_pk_bf16_f32 v49, v34, v35
    v_mul_f32 v36, s49, v36
    v_mul_f32 v37, s49, v37
    v_mul_f32 v38, s49, v38
    v_mul_f32 v39, s49, v39
    v_cvt_pk_bf16_f32 v50, v36, v37
    v_cvt_pk_bf16_f32 v51, v38, v39
    v_mul_f32 v40, s49, v40
    v_mul_f32 v41, s49, v41
    v_mul_f32 v42, s49, v42
    v_mul_f32 v43, s49, v43
    v_cvt_pk_bf16_f32 v52, v40, v41
    v_cvt_pk_bf16_f32 v53, v42, v43
    v_mul_f32 v44, s49, v44
    v_mul_f32 v45, s49, v45
    v_mul_f32 v46, s49, v46
    v_mul_f32 v47, s49, v47
    v_cvt_pk_bf16_f32 v54, v44, v45
    v_cvt_pk_bf16_f32 v55, v46, v47
    s_add_u32 s53, s52, 0
    buffer_store_dwordx2 v[48:49], v6, s[36:39], s53 offen offset:0
    s_add_u32 s53, s52, 0
    buffer_store_dwordx2 v[50:51], v6, s[36:39], s53 offen offset:256
    s_add_u32 s53, s52, 28672
    buffer_store_dwordx2 v[52:53], v6, s[36:39], s53 offen offset:0
    s_add_u32 s53, s52, 28672
    buffer_store_dwordx2 v[54:55], v6, s[36:39], s53 offen offset:256
    s_waitcnt vmcnt(4)
    ds_write_b128 v4, v[192:195] offset:0
    ds_write_b128 v4, v[196:199] offset:1056
    ds_write_b128 v4, v[200:203] offset:2112
    ds_write_b128 v4, v[204:207] offset:3168
    ds_write_b128 v4, v[208:211] offset:4224
    ds_write_b128 v4, v[212:215] offset:5280
    ds_write_b128 v4, v[216:219] offset:6336
    ds_write_b128 v4, v[220:223] offset:7392
    s_nop 1
    s_mul_i32 s53, s62, 2097152
    s_add_u32 s53, s53, 1048576
    buffer_load_dwordx4 v[192:195], v5, s[44:47], s53 offen offset:0
    s_add_u32 s53, s53, 16384
    buffer_load_dwordx4 v[196:199], v5, s[44:47], s53 offen
    s_add_u32 s53, s53, 16384
    buffer_load_dwordx4 v[200:203], v5, s[44:47], s53 offen
    s_add_u32 s53, s53, 16384
    buffer_load_dwordx4 v[204:207], v5, s[44:47], s53 offen
    s_add_u32 s53, s53, 16384
    buffer_load_dwordx4 v[208:211], v5, s[44:47], s53 offen
    s_add_u32 s53, s53, 16384
    buffer_load_dwordx4 v[212:215], v5, s[44:47], s53 offen
    s_add_u32 s53, s53, 16384
    buffer_load_dwordx4 v[216:219], v5, s[44:47], s53 offen
    s_add_u32 s53, s53, 16384
    buffer_load_dwordx4 v[220:223], v5, s[44:47], s53 offen
    ds_read_b128 v[224:227], v11 offset:0
    ds_read_b128 v[228:231], v11 offset:64
    ds_read_b128 v[232:235], v11 offset:128
    ds_read_b128 v[236:239], v11 offset:192
    ds_read_b128 v[240:243], v11 offset:256
    ds_read_b128 v[244:247], v11 offset:320
    ds_read_b128 v[248:251], v11 offset:384
    ds_read_b128 v[252:255], v11 offset:448
    s_waitcnt lgkmcnt(7)
    v_mfma_f32_16x16x32_bf16 v[32:35], v[224:227], v[64:67], 0
    v_mfma_f32_16x16x32_bf16 v[36:39], v[224:227], v[96:99], 0
    v_mfma_f32_16x16x32_bf16 v[40:43], v[224:227], v[128:131], 0
    v_mfma_f32_16x16x32_bf16 v[44:47], v[224:227], v[160:163], 0
    s_waitcnt lgkmcnt(6)
    v_mfma_f32_16x16x32_bf16 v[32:35], v[228:231], v[68:71], v[32:35]
    v_mfma_f32_16x16x32_bf16 v[36:39], v[228:231], v[100:103], v[36:39]
    v_mfma_f32_16x16x32_bf16 v[40:43], v[228:231], v[132:135], v[40:43]
    v_mfma_f32_16x16x32_bf16 v[44:47], v[228:231], v[164:167], v[44:47]
    s_waitcnt lgkmcnt(5)
    v_mfma_f32_16x16x32_bf16 v[32:35], v[232:235], v[72:75], v[32:35]
    v_mfma_f32_16x16x32_bf16 v[36:39], v[232:235], v[104:107], v[36:39]
    v_mfma_f32_16x16x32_bf16 v[40:43], v[232:235], v[136:139], v[40:43]
    v_mfma_f32_16x16x32_bf16 v[44:47], v[232:235], v[168:171], v[44:47]
    s_waitcnt lgkmcnt(4)
    v_mfma_f32_16x16x32_bf16 v[32:35], v[236:239], v[76:79], v[32:35]
    v_mfma_f32_16x16x32_bf16 v[36:39], v[236:239], v[108:111], v[36:39]
    v_mfma_f32_16x16x32_bf16 v[40:43], v[236:239], v[140:143], v[40:43]
    v_mfma_f32_16x16x32_bf16 v[44:47], v[236:239], v[172:175], v[44:47]
    s_waitcnt lgkmcnt(3)
    v_mfma_f32_16x16x32_bf16 v[32:35], v[240:243], v[80:83], v[32:35]
    v_mfma_f32_16x16x32_bf16 v[36:39], v[240:243], v[112:115], v[36:39]
    v_mfma_f32_16x16x32_bf16 v[40:43], v[240:243], v[144:147], v[40:43]
    v_mfma_f32_16x16x32_bf16 v[44:47], v[240:243], v[176:179], v[44:47]
    s_waitcnt lgkmcnt(2)
    v_mfma_f32_16x16x32_bf16 v[32:35], v[244:247], v[84:87], v[32:35]
    v_mfma_f32_16x16x32_bf16 v[36:39], v[244:247], v[116:119], v[36:39]
    v_mfma_f32_16x16x32_bf16 v[40:43], v[244:247], v[148:151], v[40:43]
    v_mfma_f32_16x16x32_bf16 v[44:47], v[244:247], v[180:183], v[44:47]
    s_waitcnt lgkmcnt(1)
    v_mfma_f32_16x16x32_bf16 v[32:35], v[248:251], v[88:91], v[32:35]
    v_mfma_f32_16x16x32_bf16 v[36:39], v[248:251], v[120:123], v[36:39]
    v_mfma_f32_16x16x32_bf16 v[40:43], v[248:251], v[152:155], v[40:43]
    v_mfma_f32_16x16x32_bf16 v[44:47], v[248:251], v[184:187], v[44:47]
    s_waitcnt lgkmcnt(0)
    v_mfma_f32_16x16x32_bf16 v[32:35], v[252:255], v[92:95], v[32:35]
    v_mfma_f32_16x16x32_bf16 v[36:39], v[252:255], v[124:127], v[36:39]
    v_mfma_f32_16x16x32_bf16 v[40:43], v[252:255], v[156:159], v[40:43]
    v_mfma_f32_16x16x32_bf16 v[44:47], v[252:255], v[188:191], v[44:47]
    s_nop 7
    v_mul_f32 v32, s49, v32
    v_mul_f32 v33, s49, v33
    v_mul_f32 v34, s49, v34
    v_mul_f32 v35, s49, v35
    v_cvt_pk_bf16_f32 v48, v32, v33
    v_cvt_pk_bf16_f32 v49, v34, v35
    v_mul_f32 v36, s49, v36
    v_mul_f32 v37, s49, v37
    v_mul_f32 v38, s49, v38
    v_mul_f32 v39, s49, v39
    v_cvt_pk_bf16_f32 v50, v36, v37
    v_cvt_pk_bf16_f32 v51, v38, v39
    v_mul_f32 v40, s49, v40
    v_mul_f32 v41, s49, v41
    v_mul_f32 v42, s49, v42
    v_mul_f32 v43, s49, v43
    v_cvt_pk_bf16_f32 v52, v40, v41
    v_cvt_pk_bf16_f32 v53, v42, v43
    v_mul_f32 v44, s49, v44
    v_mul_f32 v45, s49, v45
    v_mul_f32 v46, s49, v46
    v_mul_f32 v47, s49, v47
    v_cvt_pk_bf16_f32 v54, v44, v45
    v_cvt_pk_bf16_f32 v55, v46, v47
    s_add_u32 s53, s52, 4096
    buffer_store_dwordx2 v[48:49], v6, s[36:39], s53 offen offset:0
    s_add_u32 s53, s52, 4096
    buffer_store_dwordx2 v[50:51], v6, s[36:39], s53 offen offset:256
    s_add_u32 s53, s52, 32768
    buffer_store_dwordx2 v[52:53], v6, s[36:39], s53 offen offset:0
    s_add_u32 s53, s52, 32768
    buffer_store_dwordx2 v[54:55], v6, s[36:39], s53 offen offset:256
    s_waitcnt vmcnt(4)
    ds_write_b128 v4, v[192:195] offset:0
    ds_write_b128 v4, v[196:199] offset:1056
    ds_write_b128 v4, v[200:203] offset:2112
    ds_write_b128 v4, v[204:207] offset:3168
    ds_write_b128 v4, v[208:211] offset:4224
    ds_write_b128 v4, v[212:215] offset:5280
    ds_write_b128 v4, v[216:219] offset:6336
    ds_write_b128 v4, v[220:223] offset:7392
    s_nop 1
    s_mul_i32 s53, s62, 2097152
    s_add_u32 s53, s53, 1572864
    buffer_load_dwordx4 v[192:195], v5, s[44:47], s53 offen offset:0
    s_add_u32 s53, s53, 16384
    buffer_load_dwordx4 v[196:199], v5, s[44:47], s53 offen
    s_add_u32 s53, s53, 16384
    buffer_load_dwordx4 v[200:203], v5, s[44:47], s53 offen
    s_add_u32 s53, s53, 16384
    buffer_load_dwordx4 v[204:207], v5, s[44:47], s53 offen
    s_add_u32 s53, s53, 16384
    buffer_load_dwordx4 v[208:211], v5, s[44:47], s53 offen
    s_add_u32 s53, s53, 16384
    buffer_load_dwordx4 v[212:215], v5, s[44:47], s53 offen
    s_add_u32 s53, s53, 16384
    buffer_load_dwordx4 v[216:219], v5, s[44:47], s53 offen
    s_add_u32 s53, s53, 16384
    buffer_load_dwordx4 v[220:223], v5, s[44:47], s53 offen
    ds_read_b128 v[224:227], v11 offset:0
    ds_read_b128 v[228:231], v11 offset:64
    ds_read_b128 v[232:235], v11 offset:128
    ds_read_b128 v[236:239], v11 offset:192
    ds_read_b128 v[240:243], v11 offset:256
    ds_read_b128 v[244:247], v11 offset:320
    ds_read_b128 v[248:251], v11 offset:384
    ds_read_b128 v[252:255], v11 offset:448
    s_waitcnt lgkmcnt(7)
    v_mfma_f32_16x16x32_bf16 v[32:35], v[224:227], v[64:67], 0
    v_mfma_f32_16x16x32_bf16 v[36:39], v[224:227], v[96:99], 0
    v_mfma_f32_16x16x32_bf16 v[40:43], v[224:227], v[128:131], 0
    v_mfma_f32_16x16x32_bf16 v[44:47], v[224:227], v[160:163], 0
    s_waitcnt lgkmcnt(6)
    v_mfma_f32_16x16x32_bf16 v[32:35], v[228:231], v[68:71], v[32:35]
    v_mfma_f32_16x16x32_bf16 v[36:39], v[228:231], v[100:103], v[36:39]
    v_mfma_f32_16x16x32_bf16 v[40:43], v[228:231], v[132:135], v[40:43]
    v_mfma_f32_16x16x32_bf16 v[44:47], v[228:231], v[164:167], v[44:47]
    s_waitcnt lgkmcnt(5)
    v_mfma_f32_16x16x32_bf16 v[32:35], v[232:235], v[72:75], v[32:35]
    v_mfma_f32_16x16x32_bf16 v[36:39], v[232:235], v[104:107], v[36:39]
    v_mfma_f32_16x16x32_bf16 v[40:43], v[232:235], v[136:139], v[40:43]
    v_mfma_f32_16x16x32_bf16 v[44:47], v[232:235], v[168:171], v[44:47]
    s_waitcnt lgkmcnt(4)
    v_mfma_f32_16x16x32_bf16 v[32:35], v[236:239], v[76:79], v[32:35]
    v_mfma_f32_16x16x32_bf16 v[36:39], v[236:239], v[108:111], v[36:39]
    v_mfma_f32_16x16x32_bf16 v[40:43], v[236:239], v[140:143], v[40:43]
    v_mfma_f32_16x16x32_bf16 v[44:47], v[236:239], v[172:175], v[44:47]
    s_waitcnt lgkmcnt(3)
    v_mfma_f32_16x16x32_bf16 v[32:35], v[240:243], v[80:83], v[32:35]
    v_mfma_f32_16x16x32_bf16 v[36:39], v[240:243], v[112:115], v[36:39]
    v_mfma_f32_16x16x32_bf16 v[40:43], v[240:243], v[144:147], v[40:43]
    v_mfma_f32_16x16x32_bf16 v[44:47], v[240:243], v[176:179], v[44:47]
    s_waitcnt lgkmcnt(2)
    v_mfma_f32_16x16x32_bf16 v[32:35], v[244:247], v[84:87], v[32:35]
    v_mfma_f32_16x16x32_bf16 v[36:39], v[244:247], v[116:119], v[36:39]
    v_mfma_f32_16x16x32_bf16 v[40:43], v[244:247], v[148:151], v[40:43]
    v_mfma_f32_16x16x32_bf16 v[44:47], v[244:247], v[180:183], v[44:47]
    s_waitcnt lgkmcnt(1)
    v_mfma_f32_16x16x32_bf16 v[32:35], v[248:251], v[88:91], v[32:35]
    v_mfma_f32_16x16x32_bf16 v[36:39], v[248:251], v[120:123], v[36:39]
    v_mfma_f32_16x16x32_bf16 v[40:43], v[248:251], v[152:155], v[40:43]
    v_mfma_f32_16x16x32_bf16 v[44:47], v[248:251], v[184:187], v[44:47]
    s_waitcnt lgkmcnt(0)
    v_mfma_f32_16x16x32_bf16 v[32:35], v[252:255], v[92:95], v[32:35]
    v_mfma_f32_16x16x32_bf16 v[36:39], v[252:255], v[124:127], v[36:39]
    v_mfma_f32_16x16x32_bf16 v[40:43], v[252:255], v[156:159], v[40:43]
    v_mfma_f32_16x16x32_bf16 v[44:47], v[252:255], v[188:191], v[44:47]
    s_nop 7
    v_mul_f32 v32, s49, v32
    v_mul_f32 v33, s49, v33
    v_mul_f32 v34, s49, v34
    v_mul_f32 v35, s49, v35
    v_cvt_pk_bf16_f32 v48, v32, v33
    v_cvt_pk_bf16_f32 v49, v34, v35
    v_mul_f32 v36, s49, v36
    v_mul_f32 v37, s49, v37
    v_mul_f32 v38, s49, v38
    v_mul_f32 v39, s49, v39
    v_cvt_pk_bf16_f32 v50, v36, v37
    v_cvt_pk_bf16_f32 v51, v38, v39
    v_mul_f32 v40, s49, v40
    v_mul_f32 v41, s49, v41
    v_mul_f32 v42, s49, v42
    v_mul_f32 v43, s49, v43
    v_cvt_pk_bf16_f32 v52, v40, v41
    v_cvt_pk_bf16_f32 v53, v42, v43
    v_mul_f32 v44, s49, v44
    v_mul_f32 v45, s49, v45
    v_mul_f32 v46, s49, v46
    v_mul_f32 v47, s49, v47
    v_cvt_pk_bf16_f32 v54, v44, v45
    v_cvt_pk_bf16_f32 v55, v46, v47
    s_add_u32 s53, s52, 8192
    buffer_store_dwordx2 v[48:49], v6, s[36:39], s53 offen offset:0
    s_add_u32 s53, s52, 8192
    buffer_store_dwordx2 v[50:51], v6, s[36:39], s53 offen offset:256
    s_add_u32 s53, s52, 36864
    buffer_store_dwordx2 v[52:53], v6, s[36:39], s53 offen offset:0
    s_add_u32 s53, s52, 36864
    buffer_store_dwordx2 v[54:55], v6, s[36:39], s53 offen offset:256
    s_cmp_eq_u32 s62, 0
    s_cbranch_scc0 K1_AB_END
    s_waitcnt vmcnt(4)
    ds_write_b128 v4, v[192:195] offset:0
    ds_write_b128 v4, v[196:199] offset:1056
    ds_write_b128 v4, v[200:203] offset:2112
    ds_write_b128 v4, v[204:207] offset:3168
    ds_write_b128 v4, v[208:211] offset:4224
    ds_write_b128 v4, v[212:215] offset:5280
    ds_write_b128 v4, v[216:219] offset:6336
    ds_write_b128 v4, v[220:223] offset:7392
    ds_read_b128 v[224:227], v11 offset:0
    ds_read_b128 v[228:231], v11 offset:64
    ds_read_b128 v[232:235], v11 offset:128
    ds_read_b128 v[236:239], v11 offset:192
    ds_read_b128 v[240:243], v11 offset:256
    ds_read_b128 v[244:247], v11 offset:320
    ds_read_b128 v[248:251], v11 offset:384
    ds_read_b128 v[252:255], v11 offset:448
    s_waitcnt lgkmcnt(7)
    v_mfma_f32_16x16x32_bf16 v[32:35], v[224:227], v[64:67], 0
    v_mfma_f32_16x16x32_bf16 v[36:39], v[224:227], v[96:99], 0
    v_mfma_f32_16x16x32_bf16 v[40:43], v[224:227], v[128:131], 0
    v_mfma_f32_16x16x32_bf16 v[44:47], v[224:227], v[160:163], 0
    s_waitcnt lgkmcnt(6)
    v_mfma_f32_16x16x32_bf16 v[32:35], v[228:231], v[68:71], v[32:35]
    v_mfma_f32_16x16x32_bf16 v[36:39], v[228:231], v[100:103], v[36:39]
    v_mfma_f32_16x16x32_bf16 v[40:43], v[228:231], v[132:135], v[40:43]
    v_mfma_f32_16x16x32_bf16 v[44:47], v[228:231], v[164:167], v[44:47]
    s_waitcnt lgkmcnt(5)
    v_mfma_f32_16x16x32_bf16 v[32:35], v[232:235], v[72:75], v[32:35]
    v_mfma_f32_16x16x32_bf16 v[36:39], v[232:235], v[104:107], v[36:39]
    v_mfma_f32_16x16x32_bf16 v[40:43], v[232:235], v[136:139], v[40:43]
    v_mfma_f32_16x16x32_bf16 v[44:47], v[232:235], v[168:171], v[44:47]
    s_waitcnt lgkmcnt(4)
    v_mfma_f32_16x16x32_bf16 v[32:35], v[236:239], v[76:79], v[32:35]
    v_mfma_f32_16x16x32_bf16 v[36:39], v[236:239], v[108:111], v[36:39]
    v_mfma_f32_16x16x32_bf16 v[40:43], v[236:239], v[140:143], v[40:43]
    v_mfma_f32_16x16x32_bf16 v[44:47], v[236:239], v[172:175], v[44:47]
    s_waitcnt lgkmcnt(3)
    v_mfma_f32_16x16x32_bf16 v[32:35], v[240:243], v[80:83], v[32:35]
    v_mfma_f32_16x16x32_bf16 v[36:39], v[240:243], v[112:115], v[36:39]
    v_mfma_f32_16x16x32_bf16 v[40:43], v[240:243], v[144:147], v[40:43]
    v_mfma_f32_16x16x32_bf16 v[44:47], v[240:243], v[176:179], v[44:47]
    s_waitcnt lgkmcnt(2)
    v_mfma_f32_16x16x32_bf16 v[32:35], v[244:247], v[84:87], v[32:35]
    v_mfma_f32_16x16x32_bf16 v[36:39], v[244:247], v[116:119], v[36:39]
    v_mfma_f32_16x16x32_bf16 v[40:43], v[244:247], v[148:151], v[40:43]
    v_mfma_f32_16x16x32_bf16 v[44:47], v[244:247], v[180:183], v[44:47]
    s_waitcnt lgkmcnt(1)
    v_mfma_f32_16x16x32_bf16 v[32:35], v[248:251], v[88:91], v[32:35]
    v_mfma_f32_16x16x32_bf16 v[36:39], v[248:251], v[120:123], v[36:39]
    v_mfma_f32_16x16x32_bf16 v[40:43], v[248:251], v[152:155], v[40:43]
    v_mfma_f32_16x16x32_bf16 v[44:47], v[248:251], v[184:187], v[44:47]
    s_waitcnt lgkmcnt(0)
    v_mfma_f32_16x16x32_bf16 v[32:35], v[252:255], v[92:95], v[32:35]
    v_mfma_f32_16x16x32_bf16 v[36:39], v[252:255], v[124:127], v[36:39]
    v_mfma_f32_16x16x32_bf16 v[40:43], v[252:255], v[156:159], v[40:43]
    v_mfma_f32_16x16x32_bf16 v[44:47], v[252:255], v[188:191], v[44:47]
    s_nop 7
    v_mul_f32 v32, s49, v32
    v_mul_f32 v33, s49, v33
    v_mul_f32 v34, s49, v34
    v_mul_f32 v35, s49, v35
    v_cvt_pk_bf16_f32 v48, v32, v33
    v_cvt_pk_bf16_f32 v49, v34, v35
    v_mul_f32 v36, s49, v36
    v_mul_f32 v37, s49, v37
    v_mul_f32 v38, s49, v38
    v_mul_f32 v39, s49, v39
    v_cvt_pk_bf16_f32 v50, v36, v37
    v_cvt_pk_bf16_f32 v51, v38, v39
    v_mul_f32 v40, s49, v40
    v_mul_f32 v41, s49, v41
    v_mul_f32 v42, s49, v42
    v_mul_f32 v43, s49, v43
    v_cvt_pk_bf16_f32 v52, v40, v41
    v_cvt_pk_bf16_f32 v53, v42, v43
    v_mul_f32 v44, s49, v44
    v_mul_f32 v45, s49, v45
    v_mul_f32 v46, s49, v46
    v_mul_f32 v47, s49, v47
    v_cvt_pk_bf16_f32 v54, v44, v45
    v_cvt_pk_bf16_f32 v55, v46, v47
    s_add_u32 s53, s52, 12288
    buffer_store_dwordx2 v[48:49], v6, s[36:39], s53 offen offset:0
    s_add_u32 s53, s52, 12288
    buffer_store_dwordx2 v[50:51], v6, s[36:39], s53 offen offset:256
    s_add_u32 s53, s52, 40960
    buffer_store_dwordx2 v[52:53], v6, s[36:39], s53 offen offset:0
    s_add_u32 s53, s52, 40960
    buffer_store_dwordx2 v[54:55], v6, s[36:39], s53 offen offset:256
K1_AB_END:
    s_endpgm
K1_LN:
    s_sub_u32 s41, s2, 448
    v_cmp_gt_u32 vcc, 56, v1
    s_and_saveexec_b64 s[60:61], vcc
    v_lshlrev_b32 v2, 4, v1
    v_lshrrev_b32 v3, 3, v1
    v_lshlrev_b32 v3, 7, v3
    v_and_b32 v4, 7, v1
    v_lshl_add_u32 v3, v4, 3, v3
    s_cmp_eq_u32 s41, 128
    s_cbranch_scc1 K1_MEM0
    s_mov_b32 s44, s8
    s_and_b32 s45, s9, 0xffff
    s_mov_b32 s46, 0x1c0000
    s_mov_b32 s47, 0x00020000
    s_lshl_b32 s42, s41, 4
    s_lshl_b32 s43, s40, 2
    s_add_u32 s42, s42, s43
    s_mul_i32 s42, s42, 896
    buffer_load_dwordx4 v[8:11], v2, s[44:47], s42 offen offset:0
    buffer_load_dwordx4 v[12:15], v2, s[44:47], s42 offen offset:896
    buffer_load_dwordx4 v[16:19], v2, s[44:47], s42 offen offset:1792
    buffer_load_dwordx4 v[20:23], v2, s[44:47], s42 offen offset:2688
    s_waitcnt vmcnt(3)
    v_lshlrev_b32 v32, 16, v8
    v_and_b32 v33, 0xffff0000, v8
    v_lshlrev_b32 v34, 16, v9
    v_and_b32 v35, 0xffff0000, v9
    v_lshlrev_b32 v36, 16, v10
    v_and_b32 v37, 0xffff0000, v10
    v_lshlrev_b32 v38, 16, v11
    v_and_b32 v39, 0xffff0000, v11
    v_add_f32 v24, v32, v33
    v_add_f32 v24, v24, v34
    v_add_f32 v24, v24, v35
    v_add_f32 v24, v24, v36
    v_add_f32 v24, v24, v37
    v_add_f32 v24, v24, v38
    v_add_f32 v24, v24, v39
    s_waitcnt vmcnt(2)
    v_lshlrev_b32 v40, 16, v12
    v_and_b32 v41, 0xffff0000, v12
    v_lshlrev_b32 v42, 16, v13
    v_and_b32 v43, 0xffff0000, v13
    v_lshlrev_b32 v44, 16, v14
    v_and_b32 v45, 0xffff0000, v14
    v_lshlrev_b32 v46, 16, v15
    v_and_b32 v47, 0xffff0000, v15
    v_add_f32 v25, v40, v41
    v_add_f32 v25, v25, v42
    v_add_f32 v25, v25, v43
    v_add_f32 v25, v25, v44
    v_add_f32 v25, v25, v45
    v_add_f32 v25, v25, v46
    v_add_f32 v25, v25, v47
    s_waitcnt vmcnt(1)
    v_lshlrev_b32 v48, 16, v16
    v_and_b32 v49, 0xffff0000, v16
    v_lshlrev_b32 v50, 16, v17
    v_and_b32 v51, 0xffff0000, v17
    v_lshlrev_b32 v52, 16, v18
    v_and_b32 v53, 0xffff0000, v18
    v_lshlrev_b32 v54, 16, v19
    v_and_b32 v55, 0xffff0000, v19
    v_add_f32 v26, v48, v49
    v_add_f32 v26, v26, v50
    v_add_f32 v26, v26, v51
    v_add_f32 v26, v26, v52
    v_add_f32 v26, v26, v53
    v_add_f32 v26, v26, v54
    v_add_f32 v26, v26, v55
    s_waitcnt vmcnt(0)
    v_lshlrev_b32 v56, 16, v20
    v_and_b32 v57, 0xffff0000, v20
    v_lshlrev_b32 v58, 16, v21
    v_and_b32 v59, 0xffff0000, v21
    v_lshlrev_b32 v60, 16, v22
    v_and_b32 v61, 0xffff0000, v22
    v_lshlrev_b32 v62, 16, v23
    v_and_b32 v63, 0xffff0000, v23
    v_add_f32 v27, v56, v57
    v_add_f32 v27, v27, v58
    v_add_f32 v27, v27, v59
    v_add_f32 v27, v27, v60
    v_add_f32 v27, v27, v61
    v_add_f32 v27, v27, v62
    v_add_f32 v27, v27, v63
    s_mov_b64 exec, s[60:61]
    v_cmp_gt_u32 vcc, 56, v1
    s_nop 1
    v_cndmask_b32 v24, 0, v24, vcc
    s_nop 1
    v_cndmask_b32 v25, 0, v25, vcc
    s_nop 1
    v_cndmask_b32 v26, 0, v26, vcc
    s_nop 1
    v_cndmask_b32 v27, 0, v27, vcc
    s_nop 1
    v_add_f32_dpp v24, v24, v24 row_shr:1 row_mask:0xf bank_mask:0xf bound_ctrl:0
    s_nop 1
    v_add_f32_dpp v24, v24, v24 row_shr:2 row_mask:0xf bank_mask:0xf bound_ctrl:0
    s_nop 1
    v_add_f32_dpp v24, v24, v24 row_shr:4 row_mask:0xf bank_mask:0xf bound_ctrl:0
    s_nop 1
    v_add_f32_dpp v24, v24, v24 row_shr:8 row_mask:0xf bank_mask:0xf bound_ctrl:0
    s_nop 1
    v_add_f32_dpp v24, v24, v24 row_bcast:15 row_mask:0xa bank_mask:0xf
    s_nop 1
    v_add_f32_dpp v24, v24, v24 row_bcast:31 row_mask:0xc bank_mask:0xf
    s_nop 1
    v_add_f32_dpp v25, v25, v25 row_shr:1 row_mask:0xf bank_mask:0xf bound_ctrl:0
    s_nop 1
    v_add_f32_dpp v25, v25, v25 row_shr:2 row_mask:0xf bank_mask:0xf bound_ctrl:0
    s_nop 1
    v_add_f32_dpp v25, v25, v25 row_shr:4 row_mask:0xf bank_mask:0xf bound_ctrl:0
    s_nop 1
    v_add_f32_dpp v25, v25, v25 row_shr:8 row_mask:0xf bank_mask:0xf bound_ctrl:0
    s_nop 1
    v_add_f32_dpp v25, v25, v25 row_bcast:15 row_mask:0xa bank_mask:0xf
    s_nop 1
    v_add_f32_dpp v25, v25, v25 row_bcast:31 row_mask:0xc bank_mask:0xf
    s_nop 1
    v_add_f32_dpp v26, v26, v26 row_shr:1 row_mask:0xf bank_mask:0xf bound_ctrl:0
    s_nop 1
    v_add_f32_dpp v26, v26, v26 row_shr:2 row_mask:0xf bank_mask:0xf bound_ctrl:0
    s_nop 1
    v_add_f32_dpp v26, v26, v26 row_shr:4 row_mask:0xf bank_mask:0xf bound_ctrl:0
    s_nop 1
    v_add_f32_dpp v26, v26, v26 row_shr:8 row_mask:0xf bank_mask:0xf bound_ctrl:0
    s_nop 1
    v_add_f32_dpp v26, v26, v26 row_bcast:15 row_mask:0xa bank_mask:0xf
    s_nop 1
    v_add_f32_dpp v26, v26, v26 row_bcast:31 row_mask:0xc bank_mask:0xf
    s_nop 1
    v_add_f32_dpp v27, v27, v27 row_shr:1 row_mask:0xf bank_mask:0xf bound_ctrl:0
    s_nop 1
    v_add_f32_dpp v27, v27, v27 row_shr:2 row_mask:0xf bank_mask:0xf bound_ctrl:0
    s_nop 1
    v_add_f32_dpp v27, v27, v27 row_shr:4 row_mask:0xf bank_mask:0xf bound_ctrl:0
    s_nop 1
    v_add_f32_dpp v27, v27, v27 row_shr:8 row_mask:0xf bank_mask:0xf bound_ctrl:0
    s_nop 1
    v_add_f32_dpp v27, v27, v27 row_bcast:15 row_mask:0xa bank_mask:0xf
    s_nop 1
    v_add_f32_dpp v27, v27, v27 row_bcast:31 row_mask:0xc bank_mask:0xf
    s_nop 1
    v_readlane_b32 s64, v24, 63
    v_readlane_b32 s65, v25, 63
    v_readlane_b32 s66, v26, 63
    v_readlane_b32 s67, v27, 63
    s_mov_b32 s70, 0x3b124925
    s_nop 1
    v_mov_b32 v28, s64
    v_mul_f32 v28, s70, v28
    v_mov_b32 v29, s65
    v_mul_f32 v29, s70, v29
    v_mov_b32 v30, s66
    v_mul_f32 v30, s70, v30
    v_mov_b32 v31, s67
    v_mul_f32 v31, s70, v31
    v_sub_f32 v5, v32, v28
    v_mul_f32 v24, v5, v5
    v_sub_f32 v5, v33, v28
    v_fmac_f32 v24, v5, v5
    v_sub_f32 v5, v34, v28
    v_fmac_f32 v24, v5, v5
    v_sub_f32 v5, v35, v28
    v_fmac_f32 v24, v5, v5
    v_sub_f32 v5, v36, v28
    v_fmac_f32 v24, v5, v5
    v_sub_f32 v5, v37, v28
    v_fmac_f32 v24, v5, v5
    v_sub_f32 v5, v38, v28
    v_fmac_f32 v24, v5, v5
    v_sub_f32 v5, v39, v28
    v_fmac_f32 v24, v5, v5
    v_cndmask_b32 v24, 0, v24, vcc
    v_sub_f32 v5, v40, v29
    v_mul_f32 v25, v5, v5
    v_sub_f32 v5, v41, v29
    v_fmac_f32 v25, v5, v5
    v_sub_f32 v5, v42, v29
    v_fmac_f32 v25, v5, v5
    v_sub_f32 v5, v43, v29
    v_fmac_f32 v25, v5, v5
    v_sub_f32 v5, v44, v29
    v_fmac_f32 v25, v5, v5
    v_sub_f32 v5, v45, v29
    v_fmac_f32 v25, v5, v5
    v_sub_f32 v5, v46, v29
    v_fmac_f32 v25, v5, v5
    v_sub_f32 v5, v47, v29
    v_fmac_f32 v25, v5, v5
    v_cndmask_b32 v25, 0, v25, vcc
    v_sub_f32 v5, v48, v30
    v_mul_f32 v26, v5, v5
    v_sub_f32 v5, v49, v30
    v_fmac_f32 v26, v5, v5
    v_sub_f32 v5, v50, v30
    v_fmac_f32 v26, v5, v5
    v_sub_f32 v5, v51, v30
    v_fmac_f32 v26, v5, v5
    v_sub_f32 v5, v52, v30
    v_fmac_f32 v26, v5, v5
    v_sub_f32 v5, v53, v30
    v_fmac_f32 v26, v5, v5
    v_sub_f32 v5, v54, v30
    v_fmac_f32 v26, v5, v5
    v_sub_f32 v5, v55, v30
    v_fmac_f32 v26, v5, v5
    v_cndmask_b32 v26, 0, v26, vcc
    v_sub_f32 v5, v56, v31
    v_mul_f32 v27, v5, v5
    v_sub_f32 v5, v57, v31
    v_fmac_f32 v27, v5, v5
    v_sub_f32 v5, v58, v31
    v_fmac_f32 v27, v5, v5
    v_sub_f32 v5, v59, v31
    v_fmac_f32 v27, v5, v5
    v_sub_f32 v5, v60, v31
    v_fmac_f32 v27, v5, v5
    v_sub_f32 v5, v61, v31
    v_fmac_f32 v27, v5, v5
    v_sub_f32 v5, v62, v31
    v_fmac_f32 v27, v5, v5
    v_sub_f32 v5, v63, v31
    v_fmac_f32 v27, v5, v5
    v_cndmask_b32 v27, 0, v27, vcc
    s_nop 1
    v_add_f32_dpp v24, v24, v24 row_shr:1 row_mask:0xf bank_mask:0xf bound_ctrl:0
    s_nop 1
    v_add_f32_dpp v24, v24, v24 row_shr:2 row_mask:0xf bank_mask:0xf bound_ctrl:0
    s_nop 1
    v_add_f32_dpp v24, v24, v24 row_shr:4 row_mask:0xf bank_mask:0xf bound_ctrl:0
    s_nop 1
    v_add_f32_dpp v24, v24, v24 row_shr:8 row_mask:0xf bank_mask:0xf bound_ctrl:0
    s_nop 1
    v_add_f32_dpp v24, v24, v24 row_bcast:15 row_mask:0xa bank_mask:0xf
    s_nop 1
    v_add_f32_dpp v24, v24, v24 row_bcast:31 row_mask:0xc bank_mask:0xf
    s_nop 1
    v_add_f32_dpp v25, v25, v25 row_shr:1 row_mask:0xf bank_mask:0xf bound_ctrl:0
    s_nop 1
    v_add_f32_dpp v25, v25, v25 row_shr:2 row_mask:0xf bank_mask:0xf bound_ctrl:0
    s_nop 1
    v_add_f32_dpp v25, v25, v25 row_shr:4 row_mask:0xf bank_mask:0xf bound_ctrl:0
    s_nop 1
    v_add_f32_dpp v25, v25, v25 row_shr:8 row_mask:0xf bank_mask:0xf bound_ctrl:0
    s_nop 1
    v_add_f32_dpp v25, v25, v25 row_bcast:15 row_mask:0xa bank_mask:0xf
    s_nop 1
    v_add_f32_dpp v25, v25, v25 row_bcast:31 row_mask:0xc bank_mask:0xf
    s_nop 1
    v_add_f32_dpp v26, v26, v26 row_shr:1 row_mask:0xf bank_mask:0xf bound_ctrl:0
    s_nop 1
    v_add_f32_dpp v26, v26, v26 row_shr:2 row_mask:0xf bank_mask:0xf bound_ctrl:0
    s_nop 1
    v_add_f32_dpp v26, v26, v26 row_shr:4 row_mask:0xf bank_mask:0xf bound_ctrl:0
    s_nop 1
    v_add_f32_dpp v26, v26, v26 row_shr:8 row_mask:0xf bank_mask:0xf bound_ctrl:0
    s_nop 1
    v_add_f32_dpp v26, v26, v26 row_bcast:15 row_mask:0xa bank_mask:0xf
    s_nop 1
    v_add_f32_dpp v26, v26, v26 row_bcast:31 row_mask:0xc bank_mask:0xf
    s_nop 1
    v_add_f32_dpp v27, v27, v27 row_shr:1 row_mask:0xf bank_mask:0xf bound_ctrl:0
    s_nop 1
    v_add_f32_dpp v27, v27, v27 row_shr:2 row_mask:0xf bank_mask:0xf bound_ctrl:0
    s_nop 1
    v_add_f32_dpp v27, v27, v27 row_shr:4 row_mask:0xf bank_mask:0xf bound_ctrl:0
    s_nop 1
    v_add_f32_dpp v27, v27, v27 row_shr:8 row_mask:0xf bank_mask:0xf bound_ctrl:0
    s_nop 1
    v_add_f32_dpp v27, v27, v27 row_bcast:15 row_mask:0xa bank_mask:0xf
    s_nop 1
    v_add_f32_dpp v27, v27, v27 row_bcast:31 row_mask:0xc bank_mask:0xf
    s_nop 1
    v_readlane_b32 s64, v24, 63
    v_readlane_b32 s65, v25, 63
    v_readlane_b32 s66, v26, 63
    v_readlane_b32 s67, v27, 63
    s_nop 1
    v_mov_b32 v24, s64
    v_mul_f32 v24, s70, v24
    v_cvt_pk_bf16_f32 v28, v28, v28
    v_and_b32 v28, 0xffff0000, v28
    v_cvt_pk_bf16_f32 v24, v24, v24
    v_and_b32 v24, 0xffff0000, v24
    v_add_f32 v24, 0x3727c5ac, v24
    v_cvt_pk_bf16_f32 v24, v24, v24
    v_and_b32 v24, 0xffff0000, v24
    v_sqrt_f32 v24, v24
    s_nop 0
    v_cvt_pk_bf16_f32 v24, v24, v24
    v_and_b32 v24, 0xffff0000, v24
    v_rcp_f32 v24, v24
    s_nop 0
    v_mov_b32 v25, s65
    v_mul_f32 v25, s70, v25
    v_cvt_pk_bf16_f32 v29, v29, v29
    v_and_b32 v29, 0xffff0000, v29
    v_cvt_pk_bf16_f32 v25, v25, v25
    v_and_b32 v25, 0xffff0000, v25
    v_add_f32 v25, 0x3727c5ac, v25
    v_cvt_pk_bf16_f32 v25, v25, v25
    v_and_b32 v25, 0xffff0000, v25
    v_sqrt_f32 v25, v25
    s_nop 0
    v_cvt_pk_bf16_f32 v25, v25, v25
    v_and_b32 v25, 0xffff0000, v25
    v_rcp_f32 v25, v25
    s_nop 0
    v_mov_b32 v26, s66
    v_mul_f32 v26, s70, v26
    v_cvt_pk_bf16_f32 v30, v30, v30
    v_and_b32 v30, 0xffff0000, v30
    v_cvt_pk_bf16_f32 v26, v26, v26
    v_and_b32 v26, 0xffff0000, v26
    v_add_f32 v26, 0x3727c5ac, v26
    v_cvt_pk_bf16_f32 v26, v26, v26
    v_and_b32 v26, 0xffff0000, v26
    v_sqrt_f32 v26, v26
    s_nop 0
    v_cvt_pk_bf16_f32 v26, v26, v26
    v_and_b32 v26, 0xffff0000, v26
    v_rcp_f32 v26, v26
    s_nop 0
    v_mov_b32 v27, s67
    v_mul_f32 v27, s70, v27
    v_cvt_pk_bf16_f32 v31, v31, v31
    v_and_b32 v31, 0xffff0000, v31
    v_cvt_pk_bf16_f32 v27, v27, v27
    v_and_b32 v27, 0xffff0000, v27
    v_add_f32 v27, 0x3727c5ac, v27
    v_cvt_pk_bf16_f32 v27, v27, v27
    v_and_b32 v27, 0xffff0000, v27
    v_sqrt_f32 v27, v27
    s_nop 0
    v_cvt_pk_bf16_f32 v27, v27, v27
    v_and_b32 v27, 0xffff0000, v27
    v_rcp_f32 v27, v27
    s_nop 0
    s_and_saveexec_b64 s[60:61], vcc
    s_lshr_b32 s43, s41, 1
    s_mul_i32 s43, s43, 28*1024
    s_and_b32 s48, s41, 1
    s_lshl_b32 s48, s48, 4
    s_lshl_b32 s49, s40, 2
    s_add_u32 s48, s48, s49
    s_lshl_b32 s48, s48, 4
    s_add_u32 s43, s43, s48
    s_add_u32 s43, s43, 0
    v_lshrrev_b32 v6, 1, v1
    v_lshlrev_b32 v6, 10, v6
    v_and_b32 v7, 1, v1
    v_lshl_add_u32 v6, v7, 9, v6
    s_mul_i32 s48, s41, 14*1024
    s_lshl_b32 s49, s40, 6
    s_add_u32 s48, s48, s49
    s_add_u32 s48, s48, 2097152
    v_lshrrev_b32 v3, 3, v1
    v_lshlrev_b32 v3, 11, v3
    v_bfe_u32 v4, v1, 1, 2
    v_lshl_add_u32 v3, v4, 8, v3
    v_lshl_add_u32 v3, v7, 3, v3
    v_sub_f32 v32, v32, v28
    v_sub_f32 v33, v33, v28
    v_cvt_pk_bf16_f32 v5, v32, v33
    v_lshlrev_b32 v32, 16, v5
    v_and_b32 v33, 0xffff0000, v5
    v_mul_f32 v32, v32, v24
    v_mul_f32 v33, v33, v24
    v_cvt_pk_bf16_f32 v8, v32, v33
    v_sub_f32 v34, v34, v28
    v_sub_f32 v35, v35, v28
    v_cvt_pk_bf16_f32 v5, v34, v35
    v_lshlrev_b32 v34, 16, v5
    v_and_b32 v35, 0xffff0000, v5
    v_mul_f32 v34, v34, v24
    v_mul_f32 v35, v35, v24
    v_cvt_pk_bf16_f32 v9, v34, v35
    v_sub_f32 v36, v36, v28
    v_sub_f32 v37, v37, v28
    v_cvt_pk_bf16_f32 v5, v36, v37
    v_lshlrev_b32 v36, 16, v5
    v_and_b32 v37, 0xffff0000, v5
    v_mul_f32 v36, v36, v24
    v_mul_f32 v37, v37, v24
    v_cvt_pk_bf16_f32 v10, v36, v37
    v_sub_f32 v38, v38, v28
    v_sub_f32 v39, v39, v28
    v_cvt_pk_bf16_f32 v5, v38, v39
    v_lshlrev_b32 v38, 16, v5
    v_and_b32 v39, 0xffff0000, v5
    v_mul_f32 v38, v38, v24
    v_mul_f32 v39, v39, v24
    v_cvt_pk_bf16_f32 v11, v38, v39
    buffer_store_dwordx4 v[8:11], v6, s[36:39], s43 offen offset:0
    v_mov_b32 v32, v8
    v_mov_b32 v33, v10
    v_mov_b32 v34, v9
    v_mov_b32 v35, v11
    buffer_store_dwordx2 v[32:33], v3, s[36:39], s48 offen offset:0
    buffer_store_dwordx2 v[34:35], v3, s[36:39], s48 offen offset:1024
    v_sub_f32 v40, v40, v29
    v_sub_f32 v41, v41, v29
    v_cvt_pk_bf16_f32 v5, v40, v41
    v_lshlrev_b32 v40, 16, v5
    v_and_b32 v41, 0xffff0000, v5
    v_mul_f32 v40, v40, v25
    v_mul_f32 v41, v41, v25
    v_cvt_pk_bf16_f32 v12, v40, v41
    v_sub_f32 v42, v42, v29
    v_sub_f32 v43, v43, v29
    v_cvt_pk_bf16_f32 v5, v42, v43
    v_lshlrev_b32 v42, 16, v5
    v_and_b32 v43, 0xffff0000, v5
    v_mul_f32 v42, v42, v25
    v_mul_f32 v43, v43, v25
    v_cvt_pk_bf16_f32 v13, v42, v43
    v_sub_f32 v44, v44, v29
    v_sub_f32 v45, v45, v29
    v_cvt_pk_bf16_f32 v5, v44, v45
    v_lshlrev_b32 v44, 16, v5
    v_and_b32 v45, 0xffff0000, v5
    v_mul_f32 v44, v44, v25
    v_mul_f32 v45, v45, v25
    v_cvt_pk_bf16_f32 v14, v44, v45
    v_sub_f32 v46, v46, v29
    v_sub_f32 v47, v47, v29
    v_cvt_pk_bf16_f32 v5, v46, v47
    v_lshlrev_b32 v46, 16, v5
    v_and_b32 v47, 0xffff0000, v5
    v_mul_f32 v46, v46, v25
    v_mul_f32 v47, v47, v25
    v_cvt_pk_bf16_f32 v15, v46, v47
    buffer_store_dwordx4 v[12:15], v6, s[36:39], s43 offen offset:16
    v_mov_b32 v40, v12
    v_mov_b32 v41, v14
    v_mov_b32 v42, v13
    v_mov_b32 v43, v15
    buffer_store_dwordx2 v[40:41], v3, s[36:39], s48 offen offset:16
    buffer_store_dwordx2 v[42:43], v3, s[36:39], s48 offen offset:1040
    v_sub_f32 v48, v48, v30
    v_sub_f32 v49, v49, v30
    v_cvt_pk_bf16_f32 v5, v48, v49
    v_lshlrev_b32 v48, 16, v5
    v_and_b32 v49, 0xffff0000, v5
    v_mul_f32 v48, v48, v26
    v_mul_f32 v49, v49, v26
    v_cvt_pk_bf16_f32 v16, v48, v49
    v_sub_f32 v50, v50, v30
    v_sub_f32 v51, v51, v30
    v_cvt_pk_bf16_f32 v5, v50, v51
    v_lshlrev_b32 v50, 16, v5
    v_and_b32 v51, 0xffff0000, v5
    v_mul_f32 v50, v50, v26
    v_mul_f32 v51, v51, v26
    v_cvt_pk_bf16_f32 v17, v50, v51
    v_sub_f32 v52, v52, v30
    v_sub_f32 v53, v53, v30
    v_cvt_pk_bf16_f32 v5, v52, v53
    v_lshlrev_b32 v52, 16, v5
    v_and_b32 v53, 0xffff0000, v5
    v_mul_f32 v52, v52, v26
    v_mul_f32 v53, v53, v26
    v_cvt_pk_bf16_f32 v18, v52, v53
    v_sub_f32 v54, v54, v30
    v_sub_f32 v55, v55, v30
    v_cvt_pk_bf16_f32 v5, v54, v55
    v_lshlrev_b32 v54, 16, v5
    v_and_b32 v55, 0xffff0000, v5
    v_mul_f32 v54, v54, v26
    v_mul_f32 v55, v55, v26
    v_cvt_pk_bf16_f32 v19, v54, v55
    buffer_store_dwordx4 v[16:19], v6, s[36:39], s43 offen offset:32
    v_mov_b32 v48, v16
    v_mov_b32 v49, v18
    v_mov_b32 v50, v17
    v_mov_b32 v51, v19
    buffer_store_dwordx2 v[48:49], v3, s[36:39], s48 offen offset:32
    buffer_store_dwordx2 v[50:51], v3, s[36:39], s48 offen offset:1056
    v_sub_f32 v56, v56, v31
    v_sub_f32 v57, v57, v31
    v_cvt_pk_bf16_f32 v5, v56, v57
    v_lshlrev_b32 v56, 16, v5
    v_and_b32 v57, 0xffff0000, v5
    v_mul_f32 v56, v56, v27
    v_mul_f32 v57, v57, v27
    v_cvt_pk_bf16_f32 v20, v56, v57
    v_sub_f32 v58, v58, v31
    v_sub_f32 v59, v59, v31
    v_cvt_pk_bf16_f32 v5, v58, v59
    v_lshlrev_b32 v58, 16, v5
    v_and_b32 v59, 0xffff0000, v5
    v_mul_f32 v58, v58, v27
    v_mul_f32 v59, v59, v27
    v_cvt_pk_bf16_f32 v21, v58, v59
    v_sub_f32 v60, v60, v31
    v_sub_f32 v61, v61, v31
    v_cvt_pk_bf16_f32 v5, v60, v61
    v_lshlrev_b32 v60, 16, v5
    v_and_b32 v61, 0xffff0000, v5
    v_mul_f32 v60, v60, v27
    v_mul_f32 v61, v61, v27
    v_cvt_pk_bf16_f32 v22, v60, v61
    v_sub_f32 v62, v62, v31
    v_sub_f32 v63, v63, v31
    v_cvt_pk_bf16_f32 v5, v62, v63
    v_lshlrev_b32 v62, 16, v5
    v_and_b32 v63, 0xffff0000, v5
    v_mul_f32 v62, v62, v27
    v_mul_f32 v63, v63, v27
    v_cvt_pk_bf16_f32 v23, v62, v63
    buffer_store_dwordx4 v[20:23], v6, s[36:39], s43 offen offset:48
    v_mov_b32 v56, v20
    v_mov_b32 v57, v22
    v_mov_b32 v58, v21
    v_mov_b32 v59, v23
    buffer_store_dwordx2 v[56:57], v3, s[36:39], s48 offen offset:48
    buffer_store_dwordx2 v[58:59], v3, s[36:39], s48 offen offset:1072
    s_endpgm
K1_MEM0:
    s_mov_b32 s44, s10
    s_and_b32 s45, s11, 0xffff
    s_mov_b32 s46, 0x1c00
    s_mov_b32 s47, 0x00020000
    s_mul_i32 s42, s40, 1792
    v_lshrrev_b32 v3, 3, v1
    v_lshlrev_b32 v3, 10, v3
    v_bfe_u32 v4, v1, 1, 2
    v_lshl_add_u32 v3, v4, 8, v3
    v_and_b32 v4, 1, v1
    v_lshl_add_u32 v3, v4, 3, v3
    s_lshl_b32 s49, s40, 5
    s_add_u32 s43, s49, 25690112
    s_add_u32 s48, s49, 25165824
    buffer_load_dwordx4 v[8:11], v2, s[44:47], s42 offen offset:0
    buffer_load_dwordx4 v[12:15], v2, s[44:47], s42 offen offset:896
    s_waitcnt vmcnt(1)
    v_mov_b32 v32, v8
    v_mov_b32 v33, v10
    v_mov_b32 v34, v9
    v_mov_b32 v35, v11
    buffer_store_dwordx2 v[32:33], v3, s[36:39], s48 offen offset:0
    buffer_store_dwordx2 v[34:35], v3, s[36:39], s48 offen offset:128
    buffer_store_dwordx2 v[32:33], v3, s[36:39], s43 offen offset:0
    buffer_store_dwordx2 v[34:35], v3, s[36:39], s43 offen offset:128
    s_waitcnt vmcnt(4)
    v_mov_b32 v40, v12
    v_mov_b32 v41, v14
    v_mov_b32 v42, v13
    v_mov_b32 v43, v15
    buffer_store_dwordx2 v[40:41], v3, s[36:39], s48 offen offset:16
    buffer_store_dwordx2 v[42:43], v3, s[36:39], s48 offen offset:144
    buffer_store_dwordx2 v[40:41], v3, s[36:39], s43 offen offset:16
    buffer_store_dwordx2 v[42:43], v3, s[36:39], s43 offen offset:144
    s_endpgm
K1_INIT:
    s_sub_u32 s41, s2, 577
    v_mov_b32 v4, -1
    v_mov_b32 v5, -1
    v_mov_b32 v6, -1
    v_mov_b32 v7, -1
    v_lshlrev_b32 v2, 4, v0
    s_mul_i32 s42, s41, 28672
    s_add_u32 s42, s42, 25172992
    buffer_store_dwordx4 v[4:7], v2, s[36:39], s42 offen
    s_add_u32 s42, s42, 4096
    buffer_store_dwordx4 v[4:7], v2, s[36:39], s42 offen
    s_add_u32 s42, s42, 4096
    buffer_store_dwordx4 v[4:7], v2, s[36:39], s42 offen
    s_add_u32 s42, s42, 4096
    buffer_store_dwordx4 v[4:7], v2, s[36:39], s42 offen
    s_add_u32 s42, s42, 4096
    buffer_store_dwordx4 v[4:7], v2, s[36:39], s42 offen
    s_add_u32 s42, s42, 4096
    buffer_store_dwordx4 v[4:7], v2, s[36:39], s42 offen
    s_add_u32 s42, s42, 4096
    buffer_store_dwordx4 v[4:7], v2, s[36:39], s42 offen
    s_add_u32 s42, s42, 4096
    s_mul_i32 s42, s41, 40960
    s_add_u32 s42, s42, 26214400
    buffer_store_dwordx4 v[4:7], v2, s[36:39], s42 offen
    s_add_u32 s42, s42, 4096
    buffer_store_dwordx4 v[4:7], v2, s[36:39], s42 offen
    s_add_u32 s42, s42, 4096
    buffer_store_dwordx4 v[4:7], v2, s[36:39], s42 offen
    s_add_u32 s42, s42, 4096
    buffer_store_dwordx4 v[4:7], v2, s[36:39], s42 offen
    s_add_u32 s42, s42, 4096
    buffer_store_dwordx4 v[4:7], v2, s[36:39], s42 offen
    s_add_u32 s42, s42, 4096
    buffer_store_dwordx4 v[4:7], v2, s[36:39], s42 offen
    s_add_u32 s42, s42, 4096
    buffer_store_dwordx4 v[4:7], v2, s[36:39], s42 offen
    s_add_u32 s42, s42, 4096
    buffer_store_dwordx4 v[4:7], v2, s[36:39], s42 offen
    s_add_u32 s42, s42, 4096
    buffer_store_dwordx4 v[4:7], v2, s[36:39], s42 offen
    s_add_u32 s42, s42, 4096
    buffer_store_dwordx4 v[4:7], v2, s[36:39], s42 offen
    s_add_u32 s42, s42, 4096
    v_mov_b32 v8, 0
    v_mov_b32 v9, 0
    v_mov_b32 v10, 0
    v_mov_b32 v11, 0
    s_lshl_b32 s42, s41, 12
    s_add_u32 s42, s42, 24182784
    v_add_u32 v12, s42, v2
    v_cmp_eq_u32 vcc, 24233984, v12
    s_nop 1
    v_cndmask_b32 v8, 0, 1, vcc
    buffer_store_dwordx4 v[8:11], v2, s[36:39], s42 offen
    s_endpgm
.globl k2_kernel
.p2align 8
.type k2_kernel,@function
k2_kernel:
    s_cmp_ge_u32 s2, 256
    s_cbranch_scc1 K2_EXIT
    s_load_dwordx16 s[8:23], s[0:1], 0
    s_load_dwordx8 s[24:31], s[0:1], 64
    s_load_dwordx4 s[32:35], s[0:1], 96
    v_lshrrev_b32 v2, 6, v0
    v_and_b32 v1, 63, v0
    s_nop 0
    v_readfirstlane_b32 s40, v2
    s_waitcnt lgkmcnt(0)
    s_mov_b32 s36, s34
    s_and_b32 s37, s35, 0xffff
    s_mov_b32 s38, 0x10000000
    s_mov_b32 s39, 0x00020000
    s_mov_b32 s44, s32
    s_and_b32 s45, s33, 0xffff
    s_mov_b32 s46, 0x100
    s_mov_b32 s47, 0x00020000
    s_mov_b32 s99, 3000000
    s_getreg_b32 s41, hwreg(HW_REG_XCC_ID)
    s_and_b32 s41, s41, 7
    s_cmp_eq_u32 s40, 0
    s_cbranch_scc0 K2_WAITROLE
    s_mov_b64 exec, 1
    s_lshl_b32 s48, s41, 7
    s_add_u32 s48, s48, 24196864
    s_mov_b32 s49, 24198144
    v_mov_b32 v2, 0
    v_mov_b32 v3, 1
    buffer_atomic_add v3, v2, s[36:39], s48 offen sc0
    s_waitcnt vmcnt(0)
    v_cmp_eq_u32 vcc, 31, v3
    s_cbranch_vccz K2_POLLCH
    v_mov_b32 v4, s41
    v_add_u32 v4, 1, v4
    v_mov_b32 v5, 0
    buffer_atomic_cmpswap v[4:5], v2, s[36:39], s49 offen
    s_waitcnt vmcnt(0)
K2_POLLCH:
    s_sub_u32 s99, s99, 1
    s_cbranch_scc1 K2_ABORT
    buffer_load_dword v4, v2, s[36:39], s49 offen sc1
    s_waitcnt vmcnt(0)
    v_cmp_eq_u32 vcc, 0, v4
    s_cbranch_vccnz K2_POLLCH
    v_mov_b32 v2, 0
    v_mov_b32 v6, v3
    v_mov_b32 v7, v4
    ds_write_b64 v2, v[6:7]
    s_waitcnt lgkmcnt(0)
    s_mov_b64 exec, -1
K2_WAITROLE:
    s_barrier
    v_mov_b32 v2, 0
    ds_read_b64 v[4:5], v2
    s_waitcnt lgkmcnt(0)
    v_readfirstlane_b32 s42, v4
    v_readfirstlane_b32 s43, v5
    s_barrier
    s_sub_u32 s43, s43, 1
    s_cmp_eq_u32 s41, s43
    s_cbranch_scc0 K2_WORKER
    s_cmp_lt_u32 s42, 16
    s_cbranch_scc1 K2_SCORE
    s_cmp_lt_u32 s42, 30
    s_cbranch_scc0 K2_H0
    s_sub_u32 s42, s42, 16
    s_branch K2_VALUE
K2_H0:
    s_cmp_lt_u32 s42, 32
    s_cbranch_scc0 K2_WORKER
    s_sub_u32 s42, s42, 30
    s_branch K2_HELPER
K2_EXIT:
    s_endpgm
K2_ABORT:
    s_mov_b32 s44, s32
    s_and_b32 s45, s33, 0xffff
    s_mov_b32 s46, 0x100
    s_mov_b32 s47, 0x00020000
    s_mov_b64 exec, 1
    v_mov_b32 v2, 60
    v_mov_b32 v3, 1
    buffer_atomic_add v3, v2, s[44:47], 0 offen
    s_endpgm
K2_SCORE:
    v_and_b32 v2, 15, v1
    v_lshrrev_b32 v3, 4, v1
    v_lshlrev_b32 v4, 4, v1
    v_lshlrev_b32 v5, 4, v0
    v_add_u32 v6, 4096, v5
    v_cmp_gt_u32 vcc, 192, v0
    s_nop 1
    v_cndmask_b32 v6, v5, v6, vcc
    v_mov_b32 v44, 0x4444
    v_mov_b32 v9, 0xeeee
    v_cmp_gt_u32 vcc, 8, v2
    s_nop 1
    v_cndmask_b32 v44, v9, v44, vcc
    s_mul_i32 s48, s40, 112
    s_and_b32 s49, s40, 1
    s_lshl_b32 s50, s49, 4
    s_add_u32 s50, s48, s50
    s_cmp_eq_u32 s49, 0
    s_cselect_b32 s51, 96, 0
    s_add_u32 s51, s48, s51
    s_mul_i32 s52, s42, 14*28*1024
    s_add_u32 s52, s52, 4194304
    v_lshrrev_b32 v9, 1, v3
    v_lshlrev_b32 v9, 10, v9
    v_and_b32 v10, 1, v3
    v_lshl_add_u32 v9, v10, 9, v9
    v_lshl_add_u32 v9, v2, 4, v9
    s_mul_i32 s53, s40, 14336
    s_add_u32 s53, s53, 38976
    v_add_u32 v12, s53, v4
    s_add_u32 s54, s50, 0
    s_lshr_b32 s55, s54, 5
    s_mul_i32 s55, s55, 28*1024
    s_and_b32 s56, s54, 31
    s_lshl_b32 s56, s56, 4
    s_add_u32 s55, s55, s56
    s_add_u32 s55, s55, s52
    s_add_u32 s60, s55, 0
    buffer_load_dwordx4 a[0:3], v9, s[36:39], s60 offen
    buffer_load_dwordx4 a[4:7], v9, s[36:39], s60 offen offset:2048
    s_add_u32 s60, s55, 4096
    buffer_load_dwordx4 a[8:11], v9, s[36:39], s60 offen
    buffer_load_dwordx4 a[12:15], v9, s[36:39], s60 offen offset:2048
    s_add_u32 s60, s55, 8192
    buffer_load_dwordx4 a[16:19], v9, s[36:39], s60 offen
    buffer_load_dwordx4 a[20:23], v9, s[36:39], s60 offen offset:2048
    s_add_u32 s60, s55, 12288
    buffer_load_dwordx4 a[24:27], v9, s[36:39], s60 offen
    buffer_load_dwordx4 a[28:31], v9, s[36:39], s60 offen offset:2048
    s_add_u32 s60, s55, 16384
    buffer_load_dwordx4 a[32:35], v9, s[36:39], s60 offen
    buffer_load_dwordx4 a[36:39], v9, s[36:39], s60 offen offset:2048
    s_add_u32 s60, s55, 20480
    buffer_load_dwordx4 a[40:43], v9, s[36:39], s60 offen
    buffer_load_dwordx4 a[44:47], v9, s[36:39], s60 offen offset:2048
    s_add_u32 s60, s55, 24576
    buffer_load_dwordx4 a[48:51], v9, s[36:39], s60 offen
    buffer_load_dwordx4 a[52:55], v9, s[36:39], s60 offen offset:2048
    s_add_u32 s54, s50, 16
    s_lshr_b32 s55, s54, 5
    s_mul_i32 s55, s55, 28*1024
    s_and_b32 s56, s54, 31
    s_lshl_b32 s56, s56, 4
    s_add_u32 s55, s55, s56
    s_add_u32 s55, s55, s52
    s_add_u32 s60, s55, 0
    buffer_load_dwordx4 a[56:59], v9, s[36:39], s60 offen
    buffer_load_dwordx4 a[60:63], v9, s[36:39], s60 offen offset:2048
    s_add_u32 s60, s55, 4096
    buffer_load_dwordx4 a[64:67], v9, s[36:39], s60 offen
    buffer_load_dwordx4 a[68:71], v9, s[36:39], s60 offen offset:2048
    s_add_u32 s60, s55, 8192
    buffer_load_dwordx4 a[72:75], v9, s[36:39], s60 offen
    buffer_load_dwordx4 a[76:79], v9, s[36:39], s60 offen offset:2048
    s_add_u32 s60, s55, 12288
    buffer_load_dwordx4 a[80:83], v9, s[36:39], s60 offen
    buffer_load_dwordx4 a[84:87], v9, s[36:39], s60 offen offset:2048
    s_add_u32 s60, s55, 16384
    buffer_load_dwordx4 a[88:91], v9, s[36:39], s60 offen
    buffer_load_dwordx4 a[92:95], v9, s[36:39], s60 offen offset:2048
    s_add_u32 s60, s55, 20480
    buffer_load_dwordx4 a[96:99], v9, s[36:39], s60 offen
    buffer_load_dwordx4 a[100:103], v9, s[36:39], s60 offen offset:2048
    s_add_u32 s60, s55, 24576
    buffer_load_dwordx4 a[104:107], v9, s[36:39], s60 offen
    buffer_load_dwordx4 a[108:111], v9, s[36:39], s60 offen offset:2048
    s_add_u32 s54, s50, 32
    s_lshr_b32 s55, s54, 5
    s_mul_i32 s55, s55, 28*1024
    s_and_b32 s56, s54, 31
    s_lshl_b32 s56, s56, 4
    s_add_u32 s55, s55, s56
    s_add_u32 s55, s55, s52
    s_add_u32 s60, s55, 0
    buffer_load_dwordx4 a[112:115], v9, s[36:39], s60 offen
    buffer_load_dwordx4 a[116:119], v9, s[36:39], s60 offen offset:2048
    s_add_u32 s60, s55, 4096
    buffer_load_dwordx4 a[120:123], v9, s[36:39], s60 offen
    buffer_load_dwordx4 a[124:127], v9, s[36:39], s60 offen offset:2048
    s_add_u32 s60, s55, 8192
    buffer_load_dwordx4 a[128:131], v9, s[36:39], s60 offen
    buffer_load_dwordx4 a[132:135], v9, s[36:39], s60 offen offset:2048
    s_add_u32 s60, s55, 12288
    buffer_load_dwordx4 a[136:139], v9, s[36:39], s60 offen
    buffer_load_dwordx4 a[140:143], v9, s[36:39], s60 offen offset:2048
    s_add_u32 s60, s55, 16384
    buffer_load_dwordx4 a[144:147], v9, s[36:39], s60 offen
    buffer_load_dwordx4 a[148:151], v9, s[36:39], s60 offen offset:2048
    s_add_u32 s60, s55, 20480
    buffer_load_dwordx4 a[152:155], v9, s[36:39], s60 offen
    buffer_load_dwordx4 a[156:159], v9, s[36:39], s60 offen offset:2048
    s_add_u32 s60, s55, 24576
    buffer_load_dwordx4 a[160:163], v9, s[36:39], s60 offen
    buffer_load_dwordx4 a[164:167], v9, s[36:39], s60 offen offset:2048
    s_add_u32 s54, s50, 48
    s_lshr_b32 s55, s54, 5
    s_mul_i32 s55, s55, 28*1024
    s_and_b32 s56, s54, 31
    s_lshl_b32 s56, s56, 4
    s_add_u32 s55, s55, s56
    s_add_u32 s55, s55, s52
    s_add_u32 s60, s55, 0
    buffer_load_dwordx4 a[168:171], v9, s[36:39], s60 offen
    buffer_load_dwordx4 a[172:175], v9, s[36:39], s60 offen offset:2048
    s_add_u32 s60, s55, 4096
    buffer_load_dwordx4 a[176:179], v9, s[36:39], s60 offen
    buffer_load_dwordx4 a[180:183], v9, s[36:39], s60 offen offset:2048
    s_add_u32 s60, s55, 8192
    buffer_load_dwordx4 a[184:187], v9, s[36:39], s60 offen
    buffer_load_dwordx4 a[188:191], v9, s[36:39], s60 offen offset:2048
    s_add_u32 s60, s55, 12288
    buffer_load_dwordx4 a[192:195], v9, s[36:39], s60 offen
    buffer_load_dwordx4 a[196:199], v9, s[36:39], s60 offen offset:2048
    s_add_u32 s60, s55, 16384
    buffer_load_dwordx4 a[200:203], v9, s[36:39], s60 offen
    buffer_load_dwordx4 a[204:207], v9, s[36:39], s60 offen offset:2048
    s_add_u32 s60, s55, 20480
    buffer_load_dwordx4 a[208:211], v9, s[36:39], s60 offen
    buffer_load_dwordx4 a[212:215], v9, s[36:39], s60 offen offset:2048
    s_add_u32 s60, s55, 24576
    buffer_load_dwordx4 a[216:219], v9, s[36:39], s60 offen
    buffer_load_dwordx4 a[220:223], v9, s[36:39], s60 offen offset:2048
    s_add_u32 s54, s50, 64
    s_lshr_b32 s55, s54, 5
    s_mul_i32 s55, s55, 28*1024
    s_and_b32 s56, s54, 31
    s_lshl_b32 s56, s56, 4
    s_add_u32 s55, s55, s56
    s_add_u32 s55, s55, s52
    s_add_u32 s60, s55, 0
    buffer_load_dwordx4 a[224:227], v9, s[36:39], s60 offen
    buffer_load_dwordx4 a[228:231], v9, s[36:39], s60 offen offset:2048
    s_add_u32 s60, s55, 4096
    buffer_load_dwordx4 a[232:235], v9, s[36:39], s60 offen
    buffer_load_dwordx4 a[236:239], v9, s[36:39], s60 offen offset:2048
    s_add_u32 s60, s55, 8192
    buffer_load_dwordx4 a[240:243], v9, s[36:39], s60 offen
    buffer_load_dwordx4 a[244:247], v9, s[36:39], s60 offen offset:2048
    s_add_u32 s60, s55, 12288
    buffer_load_dwordx4 a[248:251], v9, s[36:39], s60 offen
    buffer_load_dwordx4 a[252:255], v9, s[36:39], s60 offen offset:2048
    s_add_u32 s60, s55, 16384
    buffer_load_dwordx4 v[176:179], v9, s[36:39], s60 offen
    buffer_load_dwordx4 v[180:183], v9, s[36:39], s60 offen offset:2048
    s_add_u32 s60, s55, 20480
    buffer_load_dwordx4 v[184:187], v9, s[36:39], s60 offen
    buffer_load_dwordx4 v[188:191], v9, s[36:39], s60 offen offset:2048
    s_add_u32 s60, s55, 24576
    buffer_load_dwordx4 v[192:195], v9, s[36:39], s60 offen
    buffer_load_dwordx4 v[196:199], v9, s[36:39], s60 offen offset:2048
    s_add_u32 s54, s50, 80
    s_lshr_b32 s55, s54, 5
    s_mul_i32 s55, s55, 28*1024
    s_and_b32 s56, s54, 31
    s_lshl_b32 s56, s56, 4
    s_add_u32 s55, s55, s56
    s_add_u32 s55, s55, s52
    s_add_u32 s60, s55, 0
    buffer_load_dwordx4 v[200:203], v9, s[36:39], s60 offen
    buffer_load_dwordx4 v[204:207], v9, s[36:39], s60 offen offset:2048
    s_add_u32 s60, s55, 4096
    buffer_load_dwordx4 v[208:211], v9, s[36:39], s60 offen
    buffer_load_dwordx4 v[212:215], v9, s[36:39], s60 offen offset:2048
    s_add_u32 s60, s55, 8192
    buffer_load_dwordx4 v[216:219], v9, s[36:39], s60 offen
    buffer_load_dwordx4 v[220:223], v9, s[36:39], s60 offen offset:2048
    s_add_u32 s60, s55, 12288
    buffer_load_dwordx4 v[224:227], v9, s[36:39], s60 offen
    buffer_load_dwordx4 v[228:231], v9, s[36:39], s60 offen offset:2048
    s_add_u32 s60, s55, 16384
    buffer_load_dwordx4 v[232:235], v9, s[36:39], s60 offen
    buffer_load_dwordx4 v[236:239], v9, s[36:39], s60 offen offset:2048
    s_add_u32 s60, s55, 20480
    buffer_load_dwordx4 v[240:243], v9, s[36:39], s60 offen
    buffer_load_dwordx4 v[244:247], v9, s[36:39], s60 offen offset:2048
    s_add_u32 s60, s55, 24576
    buffer_load_dwordx4 v[248:251], v9, s[36:39], s60 offen
    buffer_load_dwordx4 v[252:255], v9, s[36:39], s60 offen offset:2048
    s_mov_b32 s54, s51
    s_lshr_b32 s55, s54, 5
    s_mul_i32 s55, s55, 28*1024
    s_and_b32 s56, s54, 31
    s_lshl_b32 s56, s56, 4
    s_add_u32 s55, s55, s56
    s_add_u32 s55, s55, s52
    s_add_u32 s60, s55, 0
    buffer_load_dwordx4 v[48:51], v9, s[36:39], s60 offen
    buffer_load_dwordx4 v[52:55], v9, s[36:39], s60 offen offset:2048
    s_add_u32 s60, s55, 4096
    buffer_load_dwordx4 v[56:59], v9, s[36:39], s60 offen
    buffer_load_dwordx4 v[60:63], v9, s[36:39], s60 offen offset:2048
    s_add_u32 s60, s55, 8192
    buffer_load_dwordx4 v[64:67], v9, s[36:39], s60 offen
    buffer_load_dwordx4 v[68:71], v9, s[36:39], s60 offen offset:2048
    s_add_u32 s60, s55, 12288
    buffer_load_dwordx4 v[72:75], v9, s[36:39], s60 offen
    buffer_load_dwordx4 v[76:79], v9, s[36:39], s60 offen offset:2048
    s_add_u32 s60, s55, 16384
    buffer_load_dwordx4 v[80:83], v9, s[36:39], s60 offen
    buffer_load_dwordx4 v[84:87], v9, s[36:39], s60 offen offset:2048
    s_add_u32 s60, s55, 20480
    buffer_load_dwordx4 v[88:91], v9, s[36:39], s60 offen
    buffer_load_dwordx4 v[92:95], v9, s[36:39], s60 offen offset:2048
    s_add_u32 s60, s55, 24576
    buffer_load_dwordx4 v[96:99], v9, s[36:39], s60 offen
    buffer_load_dwordx4 v[100:103], v9, s[36:39], s60 offen offset:2048
    s_waitcnt vmcnt(0)
    ds_write_b128 v12, v[48:51] offset:0
    ds_write_b128 v12, v[52:55] offset:1024
    ds_write_b128 v12, v[56:59] offset:2048
    ds_write_b128 v12, v[60:63] offset:3072
    ds_write_b128 v12, v[64:67] offset:4096
    ds_write_b128 v12, v[68:71] offset:5120
    ds_write_b128 v12, v[72:75] offset:6144
    ds_write_b128 v12, v[76:79] offset:7168
    ds_write_b128 v12, v[80:83] offset:8192
    ds_write_b128 v12, v[84:87] offset:9216
    ds_write_b128 v12, v[88:91] offset:10240
    ds_write_b128 v12, v[92:95] offset:11264
    ds_write_b128 v12, v[96:99] offset:12288
    ds_write_b128 v12, v[100:103] offset:13312
    s_waitcnt lgkmcnt(0)
    s_mul_i32 s53, s40, 3584
    s_add_u32 s53, s53, 7168
    v_and_b32 v10, 1, v3
    v_lshlrev_b32 v10, 1, v10
    v_lshrrev_b32 v11, 1, v3
    v_add_u32 v10, v10, v11
    v_lshlrev_b32 v13, 4, v2
    v_lshl_add_u32 v13, v10, 2, v13
    v_add_u32 v13, s53, v13
    v_lshrrev_b32 v10, 2, v2
    v_and_b32 v11, 1, v2
    v_lshl_add_u32 v15, v3, 3, v10
    v_lshlrev_b32 v15, 4, v15
    v_lshl_add_u32 v15, v11, 3, v15
    v_add_u32 v15, s53, v15
    v_add_u32 v14, 64, v15
    s_lshl_b32 s53, s49, 8
    v_subrev_u32 v160, s53, v15
    v_subrev_u32 v161, s53, v14
    v_lshrrev_b32 v10, 1, v3
    v_cmp_eq_u32 s[64:65], s49, v10
    s_nop 1
    v_cndmask_b32 v160, v15, v160, s[64:65]
    v_cndmask_b32 v161, v14, v161, s[64:65]
    v_cndmask_b32 v45, 0, -1, s[64:65]
    v_and_b32 v10, 7, v2
    v_lshl_add_u32 v10, v3, 4, v10
    v_lshlrev_b32 v10, 4, v10
    s_lshr_b32 s53, s50, 5
    s_add_u32 s53, s53, 0
    s_lshr_b32 s54, s53, 1
    s_lshl_b32 s54, s54, 10
    s_and_b32 s55, s53, 1
    s_lshl_b32 s55, s55, 7
    s_add_u32 s54, s54, s55
    v_add_u32 v162, s54, v10
    s_lshr_b32 s53, s50, 5
    s_add_u32 s53, s53, 1
    s_lshr_b32 s54, s53, 1
    s_lshl_b32 s54, s54, 10
    s_and_b32 s55, s53, 1
    s_lshl_b32 s55, s55, 7
    s_add_u32 s54, s54, s55
    v_add_u32 v163, s54, v10
    s_lshr_b32 s53, s50, 5
    s_add_u32 s53, s53, 2
    s_lshr_b32 s54, s53, 1
    s_lshl_b32 s54, s54, 10
    s_and_b32 s55, s53, 1
    s_lshl_b32 s55, s55, 7
    s_add_u32 s54, s54, s55
    v_add_u32 v164, s54, v10
    s_lshr_b32 s53, s51, 5
    s_lshr_b32 s54, s53, 1
    s_lshl_b32 s54, s54, 10
    s_and_b32 s55, s53, 1
    s_lshl_b32 s55, s55, 7
    s_add_u32 s54, s54, s55
    v_add_u32 v165, s54, v10
    s_lshr_b32 s53, s50, 5
    s_lshl_b32 s53, s53, 10
    v_add_u32 v166, s53, v4
    s_lshr_b32 s53, s51, 5
    s_lshl_b32 s53, s53, 10
    v_add_u32 v167, s53, v4
    s_mul_i32 s53, s40, 4352
    s_add_u32 s53, s53, 21504
    v_mul_u32_u24 v168, 272, v2
    v_lshl_add_u32 v168, v3, 4, v168
    v_add_u32 v168, s53, v168
    v_add_u32 v10, 2, v2
    v_cmp_gt_u32 vcc, 2, v2
    s_nop 1
    v_cndmask_b32 v10, v10, v2, vcc
    v_min_u32 v10, 11, v10
    v_and_b32 v11, 1, v3
    s_lshl_b32 s53, s40, 1
    v_add_u32 v11, s53, v11
    v_mul_u32_u24 v169, 272, v11
    v_lshl_add_u32 v169, v10, 4, v169
    v_add_u32 v169, 21504, v169
    v_subrev_u32 v10, 2, v2
    v_lshrrev_b32 v170, 1, v10
    v_lshlrev_b32 v170, 7, v170
    v_lshl_add_u32 v170, v11, 4, v170
    v_and_b32 v10, 1, v10
    v_lshl_add_u32 v170, v10, 3, v170
    v_lshlrev_b32 v10, 6, v2
    v_lshl_add_u32 v10, v11, 3, v10
    v_add_u32 v10, 512, v10
    v_cmp_gt_u32 vcc, 2, v2
    s_nop 1
    v_cndmask_b32 v170, v170, v10, vcc
    s_mul_i32 s53, s42, 640
    v_add_u32 v170, s53, v170
    v_cmp_gt_u32 s[62:63], 10, v2
    v_cmp_gt_u32 vcc, 32, v1
    s_and_b64 s[62:63], s[62:63], vcc
    v_mov_b32 v46, 0xff7fffff
    s_mov_b32 s68, 0x3fb8aa3b
    s_lshl_b32 s76, s40, 13
    s_add_u32 s76, s76, 96320
    v_add_u32 v171, s76, v4
    s_mov_b32 s56, 2097152
    s_mov_b32 s57, 25165824
    s_mov_b32 s58, 26214400
    s_mov_b32 s59, 0
    s_add_u32 m0, s76, 0
    s_add_u32 s61, s56, 0
    buffer_load_dwordx4 v166, s[36:39], s61 offen offset:0 lds
    s_add_u32 m0, s76, 0
    s_add_u32 s61, s56, 0
    buffer_load_dwordx4 v166, s[36:39], s61 offen offset:1024 lds
    s_add_u32 m0, s76, 0
    s_add_u32 s61, s56, 0
    buffer_load_dwordx4 v166, s[36:39], s61 offen offset:2048 lds
    s_add_u32 m0, s76, 3072
    s_add_u32 s61, s56, 0
    buffer_load_dwordx4 v167, s[36:39], s61 offen lds
    s_add_u32 m0, s76, 4096
    s_add_u32 s61, s56, 14336
    buffer_load_dwordx4 v166, s[36:39], s61 offen offset:0 lds
    s_add_u32 m0, s76, 4096
    s_add_u32 s61, s56, 14336
    buffer_load_dwordx4 v166, s[36:39], s61 offen offset:1024 lds
    s_add_u32 m0, s76, 4096
    s_add_u32 s61, s56, 14336
    buffer_load_dwordx4 v166, s[36:39], s61 offen offset:2048 lds
    s_add_u32 m0, s76, 7168
    s_add_u32 s61, s56, 14336
    buffer_load_dwordx4 v167, s[36:39], s61 offen lds
    s_waitcnt vmcnt(0)
    ds_read_b128 v[76:79], v171 offset:0
    ds_read_b128 v[80:83], v171 offset:1024
    ds_read_b128 v[84:87], v171 offset:2048
    ds_read_b128 v[88:91], v171 offset:3072
    ds_read_b128 v[92:95], v171 offset:4096
    ds_read_b128 v[96:99], v171 offset:5120
    ds_read_b128 v[100:103], v171 offset:6144
    ds_read_b128 v[104:107], v171 offset:7168
    s_waitcnt lgkmcnt(0)
    s_add_u32 s56, s56, 28672
    s_add_u32 m0, s76, 0
    s_add_u32 s61, s56, 0
    buffer_load_dwordx4 v166, s[36:39], s61 offen offset:0 lds
    s_add_u32 m0, s76, 0
    s_add_u32 s61, s56, 0
    buffer_load_dwordx4 v166, s[36:39], s61 offen offset:1024 lds
    s_add_u32 m0, s76, 0
    s_add_u32 s61, s56, 0
    buffer_load_dwordx4 v166, s[36:39], s61 offen offset:2048 lds
    s_add_u32 m0, s76, 3072
    s_add_u32 s61, s56, 0
    buffer_load_dwordx4 v167, s[36:39], s61 offen lds
    s_add_u32 m0, s76, 4096
    s_add_u32 s61, s56, 14336
    buffer_load_dwordx4 v166, s[36:39], s61 offen offset:0 lds
    s_add_u32 m0, s76, 4096
    s_add_u32 s61, s56, 14336
    buffer_load_dwordx4 v166, s[36:39], s61 offen offset:1024 lds
    s_add_u32 m0, s76, 4096
    s_add_u32 s61, s56, 14336
    buffer_load_dwordx4 v166, s[36:39], s61 offen offset:2048 lds
    s_add_u32 m0, s76, 7168
    s_add_u32 s61, s56, 14336
    buffer_load_dwordx4 v167, s[36:39], s61 offen lds
    s_barrier
SC_LOOP:
    ds_read_b128 v[144:147], v12 offset:0
    ds_read_b128 v[148:151], v12 offset:1024
    ds_read_b128 v[152:155], v12 offset:2048
    ds_read_b128 v[156:159], v12 offset:3072
    v_mov_b32 v48, 0
    v_mov_b32 v49, 0
    v_mov_b32 v50, 0
    v_mov_b32 v51, 0
    v_mov_b32 v52, 0
    v_mov_b32 v53, 0
    v_mov_b32 v54, 0
    v_mov_b32 v55, 0
    v_mov_b32 v56, 0
    v_mov_b32 v57, 0
    v_mov_b32 v58, 0
    v_mov_b32 v59, 0
    v_mov_b32 v60, 0
    v_mov_b32 v61, 0
    v_mov_b32 v62, 0
    v_mov_b32 v63, 0
    v_mov_b32 v64, 0
    v_mov_b32 v65, 0
    v_mov_b32 v66, 0
    v_mov_b32 v67, 0
    v_mov_b32 v68, 0
    v_mov_b32 v69, 0
    v_mov_b32 v70, 0
    v_mov_b32 v71, 0
    v_mov_b32 v72, 0
    v_mov_b32 v73, 0
    v_mov_b32 v74, 0
    v_mov_b32 v75, 0
    buffer_load_dwordx4 v[108:111], v5, s[36:39], s57 offen sc1
    buffer_load_dwordx4 v[112:115], v6, s[36:39], s57 offen sc1
    s_nop 15
    s_nop 15
    buffer_load_dwordx4 v[116:119], v5, s[36:39], s57 offen sc1
    buffer_load_dwordx4 v[120:123], v6, s[36:39], s57 offen sc1
SC_POLL:
    s_sub_u32 s99, s99, 1
    s_cbranch_scc1 K2_ABORT
    s_waitcnt vmcnt(2)
    v_max3_u32 v47, v108, v109, v110
    v_max3_u32 v47, v47, v111, v112
    v_max3_u32 v47, v47, v113, v114
    v_max_u32 v47, v47, v115
    v_cmp_eq_u32 vcc, -1, v47
    s_cbranch_vccz SC_POLL_D0
    buffer_load_dwordx4 v[108:111], v5, s[36:39], s57 offen sc1
    buffer_load_dwordx4 v[112:115], v6, s[36:39], s57 offen sc1
    s_waitcnt vmcnt(2)
    v_max3_u32 v47, v116, v117, v118
    v_max3_u32 v47, v47, v119, v120
    v_max3_u32 v47, v47, v121, v122
    v_max_u32 v47, v47, v123
    v_cmp_eq_u32 vcc, -1, v47
    s_cbranch_vccz SC_POLL_D1
    buffer_load_dwordx4 v[116:119], v5, s[36:39], s57 offen sc1
    buffer_load_dwordx4 v[120:123], v6, s[36:39], s57 offen sc1
    s_branch SC_POLL
SC_POLL_D0:
    ds_write_b128 v5, v[108:111] offset:0
    ds_write_b128 v6, v[112:115] offset:0
    s_branch SC_POLL_J
SC_POLL_D1:
    ds_write_b128 v5, v[116:119] offset:0
    ds_write_b128 v6, v[120:123] offset:0
SC_POLL_J:
    s_waitcnt lgkmcnt(0)
    s_barrier
    ds_read_b128 v[16:19], v4 offset:0
    ds_read_b128 v[20:23], v4 offset:1024
    ds_read_b128 v[24:27], v4 offset:2048
    ds_read_b128 v[28:31], v4 offset:3072
    ds_read_b128 v[32:35], v4 offset:4096
    ds_read_b128 v[36:39], v4 offset:5120
    ds_read_b128 v[40:43], v4 offset:6144
    s_waitcnt lgkmcnt(6)
    v_smfmac_f32_16x16x64_bf16 v[48:51], v[16:19], a[0:7], v44
    v_smfmac_f32_16x16x64_bf16 v[52:55], v[16:19], a[56:63], v44
    v_smfmac_f32_16x16x64_bf16 v[56:59], v[16:19], a[112:119], v44
    v_smfmac_f32_16x16x64_bf16 v[60:63], v[16:19], a[168:175], v44
    v_smfmac_f32_16x16x64_bf16 v[72:75], v[16:19], v[144:151], v44
    ds_read_b128 v[144:147], v12 offset:4096
    ds_read_b128 v[148:151], v12 offset:5120
    v_smfmac_f32_16x16x64_bf16 v[64:67], v[16:19], a[224:231], v44
    v_smfmac_f32_16x16x64_bf16 v[68:71], v[16:19], v[200:207], v44
    s_waitcnt lgkmcnt(7)
    v_smfmac_f32_16x16x64_bf16 v[48:51], v[20:23], a[8:15], v44
    v_smfmac_f32_16x16x64_bf16 v[52:55], v[20:23], a[64:71], v44
    v_smfmac_f32_16x16x64_bf16 v[72:75], v[20:23], v[152:159], v44
    ds_read_b128 v[152:155], v12 offset:6144
    ds_read_b128 v[156:159], v12 offset:7168
    v_smfmac_f32_16x16x64_bf16 v[56:59], v[20:23], a[120:127], v44
    s_waitcnt vmcnt(0)
    ds_read_b128 v[108:111], v162 offset:0
    ds_read_b128 v[112:115], v163 offset:0
    ds_read_b128 v[116:119], v164 offset:0
    ds_read_b128 v[120:123], v165 offset:0
    v_smfmac_f32_16x16x64_bf16 v[60:63], v[20:23], a[176:183], v44
    v_smfmac_f32_16x16x64_bf16 v[64:67], v[20:23], a[232:239], v44
    v_smfmac_f32_16x16x64_bf16 v[68:71], v[20:23], v[208:215], v44
    s_waitcnt lgkmcnt(6)
    v_smfmac_f32_16x16x64_bf16 v[72:75], v[24:27], v[144:151], v44
    ds_read_b128 v[144:147], v12 offset:8192
    ds_read_b128 v[148:151], v12 offset:9216
    v_smfmac_f32_16x16x64_bf16 v[48:51], v[24:27], a[16:23], v44
    v_smfmac_f32_16x16x64_bf16 v[48:51], v[28:31], a[24:31], v44
    v_smfmac_f32_16x16x64_bf16 v[48:51], v[32:35], a[32:39], v44
    v_smfmac_f32_16x16x64_bf16 v[48:51], v[36:39], a[40:47], v44
    s_waitcnt lgkmcnt(6)
    v_smfmac_f32_16x16x64_bf16 v[72:75], v[28:31], v[152:159], v44
    ds_read_b128 v[152:155], v12 offset:10240
    ds_read_b128 v[156:159], v12 offset:11264
    v_smfmac_f32_16x16x64_bf16 v[48:51], v[40:43], a[48:55], v44
    v_smfmac_f32_16x16x64_bf16 v[52:55], v[24:27], a[72:79], v44
    v_smfmac_f32_16x16x64_bf16 v[52:55], v[28:31], a[80:87], v44
    v_smfmac_f32_16x16x64_bf16 v[52:55], v[32:35], a[88:95], v44
    v_permlane32_swap_b32 v48, v50
    v_permlane32_swap_b32 v49, v51
    s_nop 0
    v_add_f32 v48, v48, v50
    v_add_f32 v49, v49, v51
    v_cvt_pk_bf16_f32 v48, v48, v49
    ds_write_b32 v13, v48 offset:0
    s_waitcnt lgkmcnt(3)
    v_smfmac_f32_16x16x64_bf16 v[72:75], v[32:35], v[144:151], v44
    ds_read_b128 v[144:147], v12 offset:12288
    ds_read_b128 v[148:151], v12 offset:13312
    v_smfmac_f32_16x16x64_bf16 v[52:55], v[36:39], a[96:103], v44
    v_smfmac_f32_16x16x64_bf16 v[52:55], v[40:43], a[104:111], v44
    v_smfmac_f32_16x16x64_bf16 v[56:59], v[24:27], a[128:135], v44
    v_smfmac_f32_16x16x64_bf16 v[56:59], v[28:31], a[136:143], v44
    s_waitcnt lgkmcnt(3)
    v_smfmac_f32_16x16x64_bf16 v[72:75], v[36:39], v[152:159], v44
    v_permlane32_swap_b32 v52, v54
    v_permlane32_swap_b32 v53, v55
    s_nop 0
    v_add_f32 v52, v52, v54
    v_add_f32 v53, v53, v55
    v_cvt_pk_bf16_f32 v52, v52, v53
    ds_write_b32 v13, v52 offset:256
    v_smfmac_f32_16x16x64_bf16 v[56:59], v[32:35], a[144:151], v44
    ds_read_b64_tr_b16 v[124:125], v15 offset:0
    ds_read_b64_tr_b16 v[126:127], v14 offset:0
    v_smfmac_f32_16x16x64_bf16 v[56:59], v[36:39], a[152:159], v44
    v_smfmac_f32_16x16x64_bf16 v[56:59], v[40:43], a[160:167], v44
    v_smfmac_f32_16x16x64_bf16 v[60:63], v[24:27], a[184:191], v44
    s_waitcnt lgkmcnt(3)
    v_smfmac_f32_16x16x64_bf16 v[72:75], v[40:43], v[144:151], v44
    v_smfmac_f32_16x16x64_bf16 v[60:63], v[28:31], a[192:199], v44
    v_permlane32_swap_b32 v56, v58
    v_permlane32_swap_b32 v57, v59
    s_nop 0
    v_add_f32 v56, v56, v58
    v_add_f32 v57, v57, v59
    v_cvt_pk_bf16_f32 v56, v56, v57
    ds_write_b32 v13, v56 offset:512
    s_waitcnt lgkmcnt(1)
    v_mfma_f32_16x16x32_bf16 v[132:135], v[108:111], v[124:127], 0
    v_mfma_f32_16x16x32_bf16 v[136:139], v[76:79], v[124:127], 0
    v_mfma_f32_16x16x32_bf16 v[140:143], v[92:95], v[124:127], 0
    v_smfmac_f32_16x16x64_bf16 v[60:63], v[32:35], a[200:207], v44
    v_smfmac_f32_16x16x64_bf16 v[60:63], v[36:39], a[208:215], v44
    v_permlane32_swap_b32 v72, v74
    v_permlane32_swap_b32 v73, v75
    s_nop 0
    v_add_f32 v72, v72, v74
    v_add_f32 v73, v73, v75
    v_cvt_pk_bf16_f32 v72, v72, v73
    ds_write_b32 v13, v72 offset:1536
    v_smfmac_f32_16x16x64_bf16 v[60:63], v[40:43], a[216:223], v44
    ds_read_b64_tr_b16 v[172:173], v160 offset:1536
    ds_read_b64_tr_b16 v[174:175], v161 offset:1536
    v_smfmac_f32_16x16x64_bf16 v[64:67], v[24:27], a[240:247], v44
    v_smfmac_f32_16x16x64_bf16 v[64:67], v[28:31], a[248:255], v44
    v_smfmac_f32_16x16x64_bf16 v[64:67], v[32:35], v[176:183], v44
    v_permlane32_swap_b32 v60, v62
    v_permlane32_swap_b32 v61, v63
    s_nop 0
    v_add_f32 v60, v60, v62
    v_add_f32 v61, v61, v63
    v_cvt_pk_bf16_f32 v60, v60, v61
    ds_write_b32 v13, v60 offset:768
    v_smfmac_f32_16x16x64_bf16 v[64:67], v[36:39], v[184:191], v44
    ds_read_b64_tr_b16 v[128:129], v15 offset:512
    ds_read_b64_tr_b16 v[130:131], v14 offset:512
    v_smfmac_f32_16x16x64_bf16 v[64:67], v[40:43], v[192:199], v44
    v_smfmac_f32_16x16x64_bf16 v[68:71], v[24:27], v[216:223], v44
    s_waitcnt lgkmcnt(3)
    v_and_b32 v172, v45, v172
    v_and_b32 v173, v45, v173
    v_and_b32 v174, v45, v174
    v_and_b32 v175, v45, v175
    v_smfmac_f32_16x16x64_bf16 v[68:71], v[28:31], v[224:231], v44
    v_smfmac_f32_16x16x64_bf16 v[68:71], v[32:35], v[232:239], v44
    v_permlane32_swap_b32 v64, v66
    v_permlane32_swap_b32 v65, v67
    s_nop 0
    v_add_f32 v64, v64, v66
    v_add_f32 v65, v65, v67
    v_cvt_pk_bf16_f32 v64, v64, v65
    ds_write_b32 v13, v64 offset:1024
    v_mfma_f32_16x16x32_bf16 v[132:135], v[120:123], v[172:175], v[132:135]
    v_mfma_f32_16x16x32_bf16 v[136:139], v[88:91], v[172:175], v[136:139]
    v_mfma_f32_16x16x32_bf16 v[140:143], v[104:107], v[172:175], v[140:143]
    v_smfmac_f32_16x16x64_bf16 v[68:71], v[36:39], v[240:247], v44
    s_waitcnt lgkmcnt(1)
    v_mfma_f32_16x16x32_bf16 v[132:135], v[112:115], v[128:131], v[132:135]
    v_mfma_f32_16x16x32_bf16 v[136:139], v[80:83], v[128:131], v[136:139]
    v_mfma_f32_16x16x32_bf16 v[140:143], v[96:99], v[128:131], v[140:143]
    v_smfmac_f32_16x16x64_bf16 v[68:71], v[40:43], v[248:255], v44
    s_add_u32 s56, s56, 28672
    s_nop 6
    v_permlane32_swap_b32 v68, v70
    v_permlane32_swap_b32 v69, v71
    s_nop 0
    v_add_f32 v68, v68, v70
    v_add_f32 v69, v69, v71
    v_cvt_pk_bf16_f32 v68, v68, v69
    ds_write_b32 v13, v68 offset:1280
    ds_read_b64_tr_b16 v[124:125], v15 offset:1024
    ds_read_b64_tr_b16 v[126:127], v14 offset:1024
    s_waitcnt lgkmcnt(0)
    v_mfma_f32_16x16x32_bf16 v[132:135], v[116:119], v[124:127], v[132:135]
    v_mfma_f32_16x16x32_bf16 v[136:139], v[84:87], v[124:127], v[136:139]
    v_mfma_f32_16x16x32_bf16 v[140:143], v[100:103], v[124:127], v[140:143]
    s_nop 7
    ds_write_b128 v168, v[132:135] offset:0
    ds_write_b128 v168, v[136:139] offset:64
    ds_write_b128 v168, v[140:143] offset:128
    s_waitcnt lgkmcnt(0)
    s_barrier
    ds_read_b128 v[48:51], v169 offset:0
    ds_read_b128 v[52:55], v169 offset:4352
    ds_read_b128 v[56:59], v169 offset:8704
    ds_read_b128 v[60:63], v169 offset:13056
    s_waitcnt lgkmcnt(2)
    v_pk_add_f32 v[48:49], v[48:49], v[52:53]
    v_pk_add_f32 v[50:51], v[50:51], v[54:55]
    s_waitcnt lgkmcnt(0)
    v_pk_add_f32 v[56:57], v[56:57], v[60:61]
    v_pk_add_f32 v[58:59], v[58:59], v[62:63]
    v_pk_add_f32 v[48:49], v[48:49], v[56:57]
    v_pk_add_f32 v[50:51], v[50:51], v[58:59]
    v_max3_f32 v52, v48, v49, v50
    v_max_f32 v52, v52, v51
    v_cndmask_b32 v52, v46, v52, s[62:63]
    s_nop 1
    v_max_f32_dpp v52, v52, v52 row_ror:1 row_mask:0xf bank_mask:0xf
    s_nop 1
    v_max_f32_dpp v52, v52, v52 row_ror:2 row_mask:0xf bank_mask:0xf
    s_nop 1
    v_max_f32_dpp v52, v52, v52 row_ror:4 row_mask:0xf bank_mask:0xf
    s_nop 1
    v_max_f32_dpp v52, v52, v52 row_ror:8 row_mask:0xf bank_mask:0xf
    v_mul_f32 v52, s68, v52
    v_fma_f32 v48, v48, s68, -v52
    v_fma_f32 v49, v49, s68, -v52
    v_fma_f32 v50, v50, s68, -v52
    v_fma_f32 v51, v51, s68, -v52
    v_exp_f32 v48, v48
    v_exp_f32 v49, v49
    v_exp_f32 v50, v50
    v_exp_f32 v51, v51
    s_nop 0
    v_add_f32 v53, v48, v49
    v_add_f32 v54, v50, v51
    v_add_f32 v53, v53, v54
    v_cndmask_b32 v53, 0, v53, s[62:63]
    s_nop 1
    v_add_f32_dpp v53, v53, v53 row_ror:1 row_mask:0xf bank_mask:0xf
    s_nop 1
    v_add_f32_dpp v53, v53, v53 row_ror:2 row_mask:0xf bank_mask:0xf
    s_nop 1
    v_add_f32_dpp v53, v53, v53 row_ror:4 row_mask:0xf bank_mask:0xf
    s_nop 1
    v_add_f32_dpp v53, v53, v53 row_ror:8 row_mask:0xf bank_mask:0xf
    v_rcp_f32 v53, v53
    s_nop 0
    v_mul_f32 v48, v48, v53
    v_mul_f32 v49, v49, v53
    v_mul_f32 v50, v50, v53
    v_mul_f32 v51, v51, v53
    v_cvt_pk_bf16_f32 v54, v48, v49
    v_cvt_pk_bf16_f32 v55, v50, v51
    v_min_u32 v54, 0xfffffffe, v54
    v_min_u32 v55, 0xfffffffe, v55
    s_mov_b64 exec, s[62:63]
    buffer_store_dwordx2 v[54:55], v170, s[36:39], s58 offen
    s_mov_b64 exec, -1
    s_waitcnt vmcnt(1)
    ds_read_b128 v[76:79], v171 offset:0
    ds_read_b128 v[80:83], v171 offset:1024
    ds_read_b128 v[84:87], v171 offset:2048
    ds_read_b128 v[88:91], v171 offset:3072
    ds_read_b128 v[92:95], v171 offset:4096
    ds_read_b128 v[96:99], v171 offset:5120
    ds_read_b128 v[100:103], v171 offset:6144
    ds_read_b128 v[104:107], v171 offset:7168
    s_waitcnt lgkmcnt(0)
    s_add_u32 m0, s76, 0
    s_add_u32 s61, s56, 0
    buffer_load_dwordx4 v166, s[36:39], s61 offen offset:0 lds
    s_add_u32 m0, s76, 0
    s_add_u32 s61, s56, 0
    buffer_load_dwordx4 v166, s[36:39], s61 offen offset:1024 lds
    s_add_u32 m0, s76, 0
    s_add_u32 s61, s56, 0
    buffer_load_dwordx4 v166, s[36:39], s61 offen offset:2048 lds
    s_add_u32 m0, s76, 3072
    s_add_u32 s61, s56, 0
    buffer_load_dwordx4 v167, s[36:39], s61 offen lds
    s_add_u32 m0, s76, 4096
    s_add_u32 s61, s56, 14336
    buffer_load_dwordx4 v166, s[36:39], s61 offen offset:0 lds
    s_add_u32 m0, s76, 4096
    s_add_u32 s61, s56, 14336
    buffer_load_dwordx4 v166, s[36:39], s61 offen offset:1024 lds
    s_add_u32 m0, s76, 4096
    s_add_u32 s61, s56, 14336
    buffer_load_dwordx4 v166, s[36:39], s61 offen offset:2048 lds
    s_add_u32 m0, s76, 7168
    s_add_u32 s61, s56, 14336
    buffer_load_dwordx4 v167, s[36:39], s61 offen lds
    s_add_u32 s57, s57, 7168
    s_add_u32 s58, s58, 10240
    s_add_u32 s59, s59, 1
    s_cmp_lt_u32 s59, 63
    s_cbranch_scc1 SC_LOOP
    s_endpgm
K2_VALUE:
    v_and_b32 v2, 15, v1
    v_lshrrev_b32 v3, 4, v1
    v_lshlrev_b32 v4, 4, v1
    v_lshlrev_b32 v5, 4, v0
    v_add_u32 v6, 4096, v5
    v_cmp_gt_u32 vcc, 192, v0
    s_nop 1
    v_cndmask_b32 v6, v5, v6, vcc
    v_mov_b32 v44, 0x4444
    v_mov_b32 v9, 0xeeee
    v_cmp_gt_u32 vcc, 8, v2
    s_nop 1
    v_cndmask_b32 v44, v9, v44, vcc
    v_lshrrev_b32 v9, 1, v3
    v_lshlrev_b32 v9, 10, v9
    v_and_b32 v10, 1, v3
    v_lshl_add_u32 v9, v10, 9, v9
    v_lshl_add_u32 v9, v2, 4, v9
    s_mul_i32 s53, s40, 28672
    s_add_u32 s53, s53, 14912
    v_add_u32 v12, s53, v4
    s_lshl_b32 s54, s40, 2
    s_add_u32 s54, s54, 0
    s_mul_i32 s54, s54, 14
    s_add_u32 s54, s54, s42
    s_mul_i32 s55, s54, 28*1024
    s_add_u32 s55, s55, 10616832
    s_add_u32 s60, s55, 0
    buffer_load_dwordx4 a[0:3], v9, s[36:39], s60 offen
    buffer_load_dwordx4 a[4:7], v9, s[36:39], s60 offen offset:2048
    s_add_u32 s60, s55, 4096
    buffer_load_dwordx4 a[8:11], v9, s[36:39], s60 offen
    buffer_load_dwordx4 a[12:15], v9, s[36:39], s60 offen offset:2048
    s_add_u32 s60, s55, 8192
    buffer_load_dwordx4 a[16:19], v9, s[36:39], s60 offen
    buffer_load_dwordx4 a[20:23], v9, s[36:39], s60 offen offset:2048
    s_add_u32 s60, s55, 12288
    buffer_load_dwordx4 a[24:27], v9, s[36:39], s60 offen
    buffer_load_dwordx4 a[28:31], v9, s[36:39], s60 offen offset:2048
    s_add_u32 s60, s55, 16384
    buffer_load_dwordx4 a[32:35], v9, s[36:39], s60 offen
    buffer_load_dwordx4 a[36:39], v9, s[36:39], s60 offen offset:2048
    s_add_u32 s60, s55, 20480
    buffer_load_dwordx4 a[40:43], v9, s[36:39], s60 offen
    buffer_load_dwordx4 a[44:47], v9, s[36:39], s60 offen offset:2048
    s_add_u32 s60, s55, 24576
    buffer_load_dwordx4 a[48:51], v9, s[36:39], s60 offen
    buffer_load_dwordx4 a[52:55], v9, s[36:39], s60 offen offset:2048
    s_lshl_b32 s54, s40, 2
    s_add_u32 s54, s54, 0
    s_mul_i32 s54, s54, 14
    s_add_u32 s54, s54, s42
    s_mul_i32 s55, s54, 28*1024
    s_add_u32 s55, s55, 10617088
    s_add_u32 s60, s55, 0
    buffer_load_dwordx4 a[56:59], v9, s[36:39], s60 offen
    buffer_load_dwordx4 a[60:63], v9, s[36:39], s60 offen offset:2048
    s_add_u32 s60, s55, 4096
    buffer_load_dwordx4 a[64:67], v9, s[36:39], s60 offen
    buffer_load_dwordx4 a[68:71], v9, s[36:39], s60 offen offset:2048
    s_add_u32 s60, s55, 8192
    buffer_load_dwordx4 a[72:75], v9, s[36:39], s60 offen
    buffer_load_dwordx4 a[76:79], v9, s[36:39], s60 offen offset:2048
    s_add_u32 s60, s55, 12288
    buffer_load_dwordx4 a[80:83], v9, s[36:39], s60 offen
    buffer_load_dwordx4 a[84:87], v9, s[36:39], s60 offen offset:2048
    s_add_u32 s60, s55, 16384
    buffer_load_dwordx4 a[88:91], v9, s[36:39], s60 offen
    buffer_load_dwordx4 a[92:95], v9, s[36:39], s60 offen offset:2048
    s_add_u32 s60, s55, 20480
    buffer_load_dwordx4 a[96:99], v9, s[36:39], s60 offen
    buffer_load_dwordx4 a[100:103], v9, s[36:39], s60 offen offset:2048
    s_add_u32 s60, s55, 24576
    buffer_load_dwordx4 a[104:107], v9, s[36:39], s60 offen
    buffer_load_dwordx4 a[108:111], v9, s[36:39], s60 offen offset:2048
    s_lshl_b32 s54, s40, 2
    s_add_u32 s54, s54, 1
    s_mul_i32 s54, s54, 14
    s_add_u32 s54, s54, s42
    s_mul_i32 s55, s54, 28*1024
    s_add_u32 s55, s55, 10616832
    s_add_u32 s60, s55, 0
    buffer_load_dwordx4 a[112:115], v9, s[36:39], s60 offen
    buffer_load_dwordx4 a[116:119], v9, s[36:39], s60 offen offset:2048
    s_add_u32 s60, s55, 4096
    buffer_load_dwordx4 a[120:123], v9, s[36:39], s60 offen
    buffer_load_dwordx4 a[124:127], v9, s[36:39], s60 offen offset:2048
    s_add_u32 s60, s55, 8192
    buffer_load_dwordx4 a[128:131], v9, s[36:39], s60 offen
    buffer_load_dwordx4 a[132:135], v9, s[36:39], s60 offen offset:2048
    s_add_u32 s60, s55, 12288
    buffer_load_dwordx4 a[136:139], v9, s[36:39], s60 offen
    buffer_load_dwordx4 a[140:143], v9, s[36:39], s60 offen offset:2048
    s_add_u32 s60, s55, 16384
    buffer_load_dwordx4 a[144:147], v9, s[36:39], s60 offen
    buffer_load_dwordx4 a[148:151], v9, s[36:39], s60 offen offset:2048
    s_add_u32 s60, s55, 20480
    buffer_load_dwordx4 a[152:155], v9, s[36:39], s60 offen
    buffer_load_dwordx4 a[156:159], v9, s[36:39], s60 offen offset:2048
    s_add_u32 s60, s55, 24576
    buffer_load_dwordx4 a[160:163], v9, s[36:39], s60 offen
    buffer_load_dwordx4 a[164:167], v9, s[36:39], s60 offen offset:2048
    s_lshl_b32 s54, s40, 2
    s_add_u32 s54, s54, 1
    s_mul_i32 s54, s54, 14
    s_add_u32 s54, s54, s42
    s_mul_i32 s55, s54, 28*1024
    s_add_u32 s55, s55, 10617088
    s_add_u32 s60, s55, 0
    buffer_load_dwordx4 a[168:171], v9, s[36:39], s60 offen
    buffer_load_dwordx4 a[172:175], v9, s[36:39], s60 offen offset:2048
    s_add_u32 s60, s55, 4096
    buffer_load_dwordx4 a[176:179], v9, s[36:39], s60 offen
    buffer_load_dwordx4 a[180:183], v9, s[36:39], s60 offen offset:2048
    s_add_u32 s60, s55, 8192
    buffer_load_dwordx4 a[184:187], v9, s[36:39], s60 offen
    buffer_load_dwordx4 a[188:191], v9, s[36:39], s60 offen offset:2048
    s_add_u32 s60, s55, 12288
    buffer_load_dwordx4 a[192:195], v9, s[36:39], s60 offen
    buffer_load_dwordx4 a[196:199], v9, s[36:39], s60 offen offset:2048
    s_add_u32 s60, s55, 16384
    buffer_load_dwordx4 a[200:203], v9, s[36:39], s60 offen
    buffer_load_dwordx4 a[204:207], v9, s[36:39], s60 offen offset:2048
    s_add_u32 s60, s55, 20480
    buffer_load_dwordx4 a[208:211], v9, s[36:39], s60 offen
    buffer_load_dwordx4 a[212:215], v9, s[36:39], s60 offen offset:2048
    s_add_u32 s60, s55, 24576
    buffer_load_dwordx4 a[216:219], v9, s[36:39], s60 offen
    buffer_load_dwordx4 a[220:223], v9, s[36:39], s60 offen offset:2048
    s_lshl_b32 s54, s40, 2
    s_add_u32 s54, s54, 2
    s_mul_i32 s54, s54, 14
    s_add_u32 s54, s54, s42
    s_mul_i32 s55, s54, 28*1024
    s_add_u32 s55, s55, 10616832
    s_add_u32 s60, s55, 0
    buffer_load_dwordx4 a[224:227], v9, s[36:39], s60 offen
    buffer_load_dwordx4 a[228:231], v9, s[36:39], s60 offen offset:2048
    s_add_u32 s60, s55, 4096
    buffer_load_dwordx4 a[232:235], v9, s[36:39], s60 offen
    buffer_load_dwordx4 a[236:239], v9, s[36:39], s60 offen offset:2048
    s_add_u32 s60, s55, 8192
    buffer_load_dwordx4 a[240:243], v9, s[36:39], s60 offen
    buffer_load_dwordx4 a[244:247], v9, s[36:39], s60 offen offset:2048
    s_add_u32 s60, s55, 12288
    buffer_load_dwordx4 a[248:251], v9, s[36:39], s60 offen
    buffer_load_dwordx4 a[252:255], v9, s[36:39], s60 offen offset:2048
    s_add_u32 s60, s55, 16384
    buffer_load_dwordx4 v[176:179], v9, s[36:39], s60 offen
    buffer_load_dwordx4 v[180:183], v9, s[36:39], s60 offen offset:2048
    s_add_u32 s60, s55, 20480
    buffer_load_dwordx4 v[184:187], v9, s[36:39], s60 offen
    buffer_load_dwordx4 v[188:191], v9, s[36:39], s60 offen offset:2048
    s_add_u32 s60, s55, 24576
    buffer_load_dwordx4 v[192:195], v9, s[36:39], s60 offen
    buffer_load_dwordx4 v[196:199], v9, s[36:39], s60 offen offset:2048
    s_lshl_b32 s54, s40, 2
    s_add_u32 s54, s54, 2
    s_mul_i32 s54, s54, 14
    s_add_u32 s54, s54, s42
    s_mul_i32 s55, s54, 28*1024
    s_add_u32 s55, s55, 10617088
    s_add_u32 s60, s55, 0
    buffer_load_dwordx4 v[200:203], v9, s[36:39], s60 offen
    buffer_load_dwordx4 v[204:207], v9, s[36:39], s60 offen offset:2048
    s_add_u32 s60, s55, 4096
    buffer_load_dwordx4 v[208:211], v9, s[36:39], s60 offen
    buffer_load_dwordx4 v[212:215], v9, s[36:39], s60 offen offset:2048
    s_add_u32 s60, s55, 8192
    buffer_load_dwordx4 v[216:219], v9, s[36:39], s60 offen
    buffer_load_dwordx4 v[220:223], v9, s[36:39], s60 offen offset:2048
    s_add_u32 s60, s55, 12288
    buffer_load_dwordx4 v[224:227], v9, s[36:39], s60 offen
    buffer_load_dwordx4 v[228:231], v9, s[36:39], s60 offen offset:2048
    s_add_u32 s60, s55, 16384
    buffer_load_dwordx4 v[232:235], v9, s[36:39], s60 offen
    buffer_load_dwordx4 v[236:239], v9, s[36:39], s60 offen offset:2048
    s_add_u32 s60, s55, 20480
    buffer_load_dwordx4 v[240:243], v9, s[36:39], s60 offen
    buffer_load_dwordx4 v[244:247], v9, s[36:39], s60 offen offset:2048
    s_add_u32 s60, s55, 24576
    buffer_load_dwordx4 v[248:251], v9, s[36:39], s60 offen
    buffer_load_dwordx4 v[252:255], v9, s[36:39], s60 offen offset:2048
    s_lshl_b32 s54, s40, 2
    s_add_u32 s54, s54, 3
    s_mul_i32 s54, s54, 14
    s_add_u32 s54, s54, s42
    s_mul_i32 s55, s54, 28*1024
    s_add_u32 s55, s55, 10616832
    s_add_u32 s60, s55, 0
    buffer_load_dwordx4 v[48:51], v9, s[36:39], s60 offen
    buffer_load_dwordx4 v[52:55], v9, s[36:39], s60 offen offset:2048
    s_add_u32 s60, s55, 4096
    buffer_load_dwordx4 v[56:59], v9, s[36:39], s60 offen
    buffer_load_dwordx4 v[60:63], v9, s[36:39], s60 offen offset:2048
    s_add_u32 s60, s55, 8192
    buffer_load_dwordx4 v[64:67], v9, s[36:39], s60 offen
    buffer_load_dwordx4 v[68:71], v9, s[36:39], s60 offen offset:2048
    s_add_u32 s60, s55, 12288
    buffer_load_dwordx4 v[72:75], v9, s[36:39], s60 offen
    buffer_load_dwordx4 v[76:79], v9, s[36:39], s60 offen offset:2048
    s_add_u32 s60, s55, 16384
    buffer_load_dwordx4 v[80:83], v9, s[36:39], s60 offen
    buffer_load_dwordx4 v[84:87], v9, s[36:39], s60 offen offset:2048
    s_add_u32 s60, s55, 20480
    buffer_load_dwordx4 v[88:91], v9, s[36:39], s60 offen
    buffer_load_dwordx4 v[92:95], v9, s[36:39], s60 offen offset:2048
    s_add_u32 s60, s55, 24576
    buffer_load_dwordx4 v[96:99], v9, s[36:39], s60 offen
    buffer_load_dwordx4 v[100:103], v9, s[36:39], s60 offen offset:2048
    s_waitcnt vmcnt(0)
    ds_write_b128 v12, v[48:51] offset:0
    ds_write_b128 v12, v[52:55] offset:1024
    ds_write_b128 v12, v[56:59] offset:2048
    ds_write_b128 v12, v[60:63] offset:3072
    ds_write_b128 v12, v[64:67] offset:4096
    ds_write_b128 v12, v[68:71] offset:5120
    ds_write_b128 v12, v[72:75] offset:6144
    ds_write_b128 v12, v[76:79] offset:7168
    ds_write_b128 v12, v[80:83] offset:8192
    ds_write_b128 v12, v[84:87] offset:9216
    ds_write_b128 v12, v[88:91] offset:10240
    ds_write_b128 v12, v[92:95] offset:11264
    ds_write_b128 v12, v[96:99] offset:12288
    ds_write_b128 v12, v[100:103] offset:13312
    s_waitcnt lgkmcnt(0)
    s_lshl_b32 s54, s40, 2
    s_add_u32 s54, s54, 3
    s_mul_i32 s54, s54, 14
    s_add_u32 s54, s54, s42
    s_mul_i32 s55, s54, 28*1024
    s_add_u32 s55, s55, 10617088
    s_add_u32 s60, s55, 0
    buffer_load_dwordx4 v[48:51], v9, s[36:39], s60 offen
    buffer_load_dwordx4 v[52:55], v9, s[36:39], s60 offen offset:2048
    s_add_u32 s60, s55, 4096
    buffer_load_dwordx4 v[56:59], v9, s[36:39], s60 offen
    buffer_load_dwordx4 v[60:63], v9, s[36:39], s60 offen offset:2048
    s_add_u32 s60, s55, 8192
    buffer_load_dwordx4 v[64:67], v9, s[36:39], s60 offen
    buffer_load_dwordx4 v[68:71], v9, s[36:39], s60 offen offset:2048
    s_add_u32 s60, s55, 12288
    buffer_load_dwordx4 v[72:75], v9, s[36:39], s60 offen
    buffer_load_dwordx4 v[76:79], v9, s[36:39], s60 offen offset:2048
    s_add_u32 s60, s55, 16384
    buffer_load_dwordx4 v[80:83], v9, s[36:39], s60 offen
    buffer_load_dwordx4 v[84:87], v9, s[36:39], s60 offen offset:2048
    s_add_u32 s60, s55, 20480
    buffer_load_dwordx4 v[88:91], v9, s[36:39], s60 offen
    buffer_load_dwordx4 v[92:95], v9, s[36:39], s60 offen offset:2048
    s_add_u32 s60, s55, 24576
    buffer_load_dwordx4 v[96:99], v9, s[36:39], s60 offen
    buffer_load_dwordx4 v[100:103], v9, s[36:39], s60 offen offset:2048
    s_waitcnt vmcnt(0)
    ds_write_b128 v12, v[48:51] offset:14336
    ds_write_b128 v12, v[52:55] offset:15360
    ds_write_b128 v12, v[56:59] offset:16384
    ds_write_b128 v12, v[60:63] offset:17408
    ds_write_b128 v12, v[64:67] offset:18432
    ds_write_b128 v12, v[68:71] offset:19456
    ds_write_b128 v12, v[72:75] offset:20480
    ds_write_b128 v12, v[76:79] offset:21504
    ds_write_b128 v12, v[80:83] offset:22528
    ds_write_b128 v12, v[84:87] offset:23552
    ds_write_b128 v12, v[88:91] offset:24576
    ds_write_b128 v12, v[92:95] offset:25600
    ds_write_b128 v12, v[96:99] offset:26624
    ds_write_b128 v12, v[100:103] offset:27648
    s_waitcnt lgkmcnt(0)
    v_and_b32 v10, 7, v2
    s_mul_i32 s53, s40, 2560
    v_lshlrev_b32 v13, 7, v3
    v_lshl_add_u32 v13, v10, 4, v13
    v_add_u32 v13, s53, v13
    v_and_b32 v11, 1, v3
    v_lshlrev_b32 v14, 6, v11
    v_lshl_add_u32 v14, v10, 3, v14
    v_add_u32 v14, s53, v14
    v_add_u32 v14, 512, v14
    v_add_u32 v7, 8192, v5
    v_cmp_gt_u32 vcc, 128, v0
    s_nop 1
    v_cndmask_b32 v7, v5, v7, vcc
    v_add_u32 v8, 4096, v5
    v_and_b32 v10, 7, v2
    v_mul_u32_u24 v160, 144, v10
    v_lshl_add_u32 v160, v3, 4, v160
    s_mul_i32 s53, s40, 1152
    s_add_u32 s53, s53, 10240
    v_add_u32 v160, s53, v160
    v_cmp_gt_u32 s[64:65], 8, v2
    v_and_b32 v10, 1, v3
    s_lshl_b32 s53, s40, 1
    v_add_u32 v10, s53, v10
    v_mul_u32_u24 v161, 144, v10
    v_lshl_add_u32 v161, v2, 3, v161
    v_add_u32 v161, 10240, v161
    v_and_b32 v11, 1, v2
    v_lshl_add_u32 v162, v11, 3, v10
    v_lshrrev_b32 v11, 3, v2
    v_lshl_add_u32 v162, v11, 4, v162
    v_lshlrev_b32 v162, 4, v162
    v_bfe_u32 v11, v2, 1, 2
    v_lshl_add_u32 v162, v11, 2, v162
    s_lshr_b32 s53, s42, 1
    s_lshl_b32 s53, s53, 10
    s_and_b32 s54, s42, 1
    s_lshl_b32 s54, s54, 9
    s_add_u32 s53, s53, s54
    v_add_u32 v162, s53, v162
    v_cmp_gt_u32 s[62:63], 32, v1
    v_lshlrev_b32 v163, 4, v2
    v_and_b32 v11, 1, v3
    v_lshl_add_u32 v163, v11, 3, v163
    v_lshrrev_b32 v11, 1, v3
    v_lshl_add_u32 v163, v11, 2, v163
    s_mul_i32 s66, s40, 28*1024
    s_lshl_b32 s53, s42, 11
    s_add_u32 s66, s66, s53
    s_add_u32 s66, s66, 117440512
    s_lshl_b32 s53, s40, 2
    s_mul_i32 s56, s53, 28*1024
    s_lshl_b32 s53, s42, 11
    s_add_u32 s56, s56, s53
    s_add_u32 s56, s56, 83886080
    s_mov_b32 s57, 25165824
    s_mov_b32 s58, 26214400
    s_mov_b32 s59, 0
    s_mov_b32 s67, 24182784
    v_mov_b32 v164, 0
    s_lshl_b32 s76, s40, 13
    s_add_u32 s76, s76, 129600
    v_add_u32 v166, s76, v4
    s_mul_i32 s53, s40, 1152
    s_add_u32 s53, s53, 10240
    v_add_u32 v10, s53, v163
    v_mov_b32 v15, v10
    v_add_u32 v11, s53, v4
    v_mov_b32 v9, v11
VA_WVO0:
    s_sub_u32 s99, s99, 1
    s_cbranch_scc1 K2_ABORT
    buffer_load_dword v167, v164, s[36:39], s67 offen sc1
    s_waitcnt vmcnt(0)
    v_cmp_gt_u32 vcc, 224, v167
    s_cbranch_vccnz VA_WVO0
    s_add_u32 s67, s67, 128
    s_add_u32 m0, s76, 0
    s_add_u32 s61, s56, 0
    buffer_load_dwordx4 v4, s[36:39], s61 offen offset:0 lds
    s_add_u32 m0, s76, 0
    s_add_u32 s61, s56, 0
    buffer_load_dwordx4 v4, s[36:39], s61 offen offset:1024 lds
    s_add_u32 m0, s76, 2048
    s_add_u32 s61, s56, 28672
    buffer_load_dwordx4 v4, s[36:39], s61 offen offset:0 lds
    s_add_u32 m0, s76, 2048
    s_add_u32 s61, s56, 28672
    buffer_load_dwordx4 v4, s[36:39], s61 offen offset:1024 lds
    s_add_u32 m0, s76, 4096
    s_add_u32 s61, s56, 57344
    buffer_load_dwordx4 v4, s[36:39], s61 offen offset:0 lds
    s_add_u32 m0, s76, 4096
    s_add_u32 s61, s56, 57344
    buffer_load_dwordx4 v4, s[36:39], s61 offen offset:1024 lds
    s_add_u32 m0, s76, 6144
    s_add_u32 s61, s56, 86016
    buffer_load_dwordx4 v4, s[36:39], s61 offen offset:0 lds
    s_add_u32 m0, s76, 6144
    s_add_u32 s61, s56, 86016
    buffer_load_dwordx4 v4, s[36:39], s61 offen offset:1024 lds
    s_waitcnt vmcnt(0)
    ds_read_b128 v[80:83], v166 offset:0
    ds_read_b128 v[84:87], v166 offset:1024
    ds_read_b128 v[88:91], v166 offset:2048
    ds_read_b128 v[92:95], v166 offset:3072
    ds_read_b128 v[96:99], v166 offset:4096
    ds_read_b128 v[100:103], v166 offset:5120
    ds_read_b128 v[104:107], v166 offset:6144
    ds_read_b128 v[108:111], v166 offset:7168
    s_waitcnt lgkmcnt(0)
    s_add_u32 s56, s56, 458752
    s_barrier
    v_and_b32 v10, 7, v2
    v_lshrrev_b32 v11, 3, v2
    v_lshrrev_b32 v16, 2, v10
    v_and_b32 v17, 1, v3
    v_cmp_eq_u32 vcc, v16, v17
    v_and_b32 v16, 3, v10
    v_lshl_add_u32 v16, v11, 2, v16
    v_and_b32 v17, 1, v16
    v_lshlrev_b32 v17, 4, v17
    v_mov_b32 v18, 0x3f80
    v_lshlrev_b32 v18, v17, v18
    v_cndmask_b32 v18, 0, v18, vcc
    v_lshrrev_b32 v16, 1, v16
    v_cmp_eq_u32 vcc, 0, v16
    s_nop 1
    v_cndmask_b32 v172, 0, v18, vcc
    v_cmp_eq_u32 vcc, 1, v16
    s_nop 1
    v_cndmask_b32 v173, 0, v18, vcc
    v_cmp_eq_u32 vcc, 2, v16
    s_nop 1
    v_cndmask_b32 v174, 0, v18, vcc
    v_cmp_eq_u32 vcc, 3, v16
    s_nop 1
    v_cndmask_b32 v175, 0, v18, vcc
    v_lshrrev_b32 v10, 1, v3
    v_lshl_add_u32 v10, v10, 4, v2
    v_lshlrev_b32 v10, 4, v10
    v_and_b32 v11, 1, v3
    v_lshl_add_u32 v163, v11, 3, v10
VA_LOOP:
    ds_read_b128 v[144:147], v12 offset:0
    ds_read_b128 v[148:151], v12 offset:1024
    ds_read_b128 v[152:155], v12 offset:2048
    ds_read_b128 v[156:159], v12 offset:3072
    v_mov_b32 v48, 0
    v_mov_b32 v49, 0
    v_mov_b32 v50, 0
    v_mov_b32 v51, 0
    v_mov_b32 v52, 0
    v_mov_b32 v53, 0
    v_mov_b32 v54, 0
    v_mov_b32 v55, 0
    v_mov_b32 v56, 0
    v_mov_b32 v57, 0
    v_mov_b32 v58, 0
    v_mov_b32 v59, 0
    v_mov_b32 v60, 0
    v_mov_b32 v61, 0
    v_mov_b32 v62, 0
    v_mov_b32 v63, 0
    v_mov_b32 v64, 0
    v_mov_b32 v65, 0
    v_mov_b32 v66, 0
    v_mov_b32 v67, 0
    v_mov_b32 v68, 0
    v_mov_b32 v69, 0
    v_mov_b32 v70, 0
    v_mov_b32 v71, 0
    v_mov_b32 v72, 0
    v_mov_b32 v73, 0
    v_mov_b32 v74, 0
    v_mov_b32 v75, 0
    v_mov_b32 v76, 0
    v_mov_b32 v77, 0
    v_mov_b32 v78, 0
    v_mov_b32 v79, 0
    buffer_load_dwordx4 v[112:115], v5, s[36:39], s57 offen sc1
    buffer_load_dwordx4 v[116:119], v6, s[36:39], s57 offen sc1
    s_nop 15
    s_nop 15
    buffer_load_dwordx4 v[120:123], v5, s[36:39], s57 offen sc1
    buffer_load_dwordx4 v[124:127], v6, s[36:39], s57 offen sc1
VA_POLL:
    s_sub_u32 s99, s99, 1
    s_cbranch_scc1 K2_ABORT
    s_waitcnt vmcnt(2)
    v_max3_u32 v167, v112, v113, v114
    v_max3_u32 v167, v167, v115, v116
    v_max3_u32 v167, v167, v117, v118
    v_max_u32 v167, v167, v119
    v_cmp_eq_u32 vcc, -1, v167
    s_cbranch_vccz VA_POLL_D0
    buffer_load_dwordx4 v[112:115], v5, s[36:39], s57 offen sc1
    buffer_load_dwordx4 v[116:119], v6, s[36:39], s57 offen sc1
    s_waitcnt vmcnt(2)
    v_max3_u32 v167, v120, v121, v122
    v_max3_u32 v167, v167, v123, v124
    v_max3_u32 v167, v167, v125, v126
    v_max_u32 v167, v167, v127
    v_cmp_eq_u32 vcc, -1, v167
    s_cbranch_vccz VA_POLL_D1
    buffer_load_dwordx4 v[120:123], v5, s[36:39], s57 offen sc1
    buffer_load_dwordx4 v[124:127], v6, s[36:39], s57 offen sc1
    s_branch VA_POLL
VA_POLL_D0:
    ds_write_b128 v5, v[112:115] offset:0
    ds_write_b128 v6, v[116:119] offset:0
    s_branch VA_POLL_J
VA_POLL_D1:
    ds_write_b128 v5, v[120:123] offset:0
    ds_write_b128 v6, v[124:127] offset:0
VA_POLL_J:
    s_waitcnt lgkmcnt(0)
    s_barrier
    ds_read_b128 v[16:19], v4 offset:0
    ds_read_b128 v[20:23], v4 offset:1024
    ds_read_b128 v[24:27], v4 offset:2048
    ds_read_b128 v[28:31], v4 offset:3072
    ds_read_b128 v[32:35], v4 offset:4096
    ds_read_b128 v[36:39], v4 offset:5120
    ds_read_b128 v[40:43], v4 offset:6144
    s_and_b32 s60, s59, 3
    s_cmp_eq_u32 s60, 3
    s_cbranch_scc0 VA_NOW
    s_cmp_ge_u32 s59, 60
    s_cbranch_scc1 VA_NOW
VA_WVO:
    s_sub_u32 s99, s99, 1
    s_cbranch_scc1 K2_ABORT
    buffer_load_dword v167, v164, s[36:39], s67 offen sc1
    s_waitcnt vmcnt(0)
    v_cmp_gt_u32 vcc, 224, v167
    s_cbranch_vccnz VA_WVO
    s_add_u32 s67, s67, 128
VA_NOW:
    s_waitcnt lgkmcnt(6)
    v_smfmac_f32_16x16x64_bf16 v[48:51], v[16:19], a[0:7], v44
    s_waitcnt lgkmcnt(5)
    v_smfmac_f32_16x16x64_bf16 v[48:51], v[20:23], a[8:15], v44
    s_add_u32 m0, s76, 0
    s_add_u32 s61, s56, 0
    buffer_load_dwordx4 v4, s[36:39], s61 offen offset:0 lds
    s_waitcnt lgkmcnt(4)
    v_smfmac_f32_16x16x64_bf16 v[48:51], v[24:27], a[16:23], v44
    v_smfmac_f32_16x16x64_bf16 v[72:75], v[16:19], v[144:151], v44
    ds_read_b128 v[144:147], v12 offset:4096
    ds_read_b128 v[148:151], v12 offset:5120
    s_waitcnt lgkmcnt(5)
    v_smfmac_f32_16x16x64_bf16 v[48:51], v[28:31], a[24:31], v44
    s_waitcnt lgkmcnt(4)
    v_smfmac_f32_16x16x64_bf16 v[48:51], v[32:35], a[32:39], v44
    s_waitcnt lgkmcnt(3)
    v_smfmac_f32_16x16x64_bf16 v[48:51], v[36:39], a[40:47], v44
    s_add_u32 m0, s76, 0
    s_add_u32 s61, s56, 0
    buffer_load_dwordx4 v4, s[36:39], s61 offen offset:1024 lds
    v_smfmac_f32_16x16x64_bf16 v[72:75], v[20:23], v[152:159], v44
    ds_read_b128 v[152:155], v12 offset:6144
    ds_read_b128 v[156:159], v12 offset:7168
    s_waitcnt lgkmcnt(4)
    v_smfmac_f32_16x16x64_bf16 v[48:51], v[40:43], a[48:55], v44
    v_smfmac_f32_16x16x64_bf16 v[52:55], v[16:19], a[56:63], v44
    v_smfmac_f32_16x16x64_bf16 v[52:55], v[20:23], a[64:71], v44
    s_waitcnt lgkmcnt(2)
    v_smfmac_f32_16x16x64_bf16 v[72:75], v[24:27], v[144:151], v44
    ds_read_b128 v[144:147], v12 offset:8192
    ds_read_b128 v[148:151], v12 offset:9216
    v_smfmac_f32_16x16x64_bf16 v[52:55], v[24:27], a[72:79], v44
    s_add_u32 m0, s76, 2048
    s_add_u32 s61, s56, 28672
    buffer_load_dwordx4 v4, s[36:39], s61 offen offset:0 lds
    v_smfmac_f32_16x16x64_bf16 v[52:55], v[28:31], a[80:87], v44
    v_smfmac_f32_16x16x64_bf16 v[52:55], v[32:35], a[88:95], v44
    s_waitcnt lgkmcnt(2)
    v_smfmac_f32_16x16x64_bf16 v[72:75], v[28:31], v[152:159], v44
    ds_read_b128 v[152:155], v12 offset:10240
    ds_read_b128 v[156:159], v12 offset:11264
    v_smfmac_f32_16x16x64_bf16 v[52:55], v[36:39], a[96:103], v44
    v_smfmac_f32_16x16x64_bf16 v[52:55], v[40:43], a[104:111], v44
    s_add_u32 m0, s76, 2048
    s_add_u32 s61, s56, 28672
    buffer_load_dwordx4 v4, s[36:39], s61 offen offset:1024 lds
    v_smfmac_f32_16x16x64_bf16 v[56:59], v[16:19], a[112:119], v44
    s_waitcnt lgkmcnt(2)
    v_smfmac_f32_16x16x64_bf16 v[72:75], v[32:35], v[144:151], v44
    ds_read_b128 v[144:147], v12 offset:12288
    ds_read_b128 v[148:151], v12 offset:13312
    v_smfmac_f32_16x16x64_bf16 v[56:59], v[20:23], a[120:127], v44
    v_smfmac_f32_16x16x64_bf16 v[56:59], v[24:27], a[128:135], v44
    v_smfmac_f32_16x16x64_bf16 v[56:59], v[28:31], a[136:143], v44
    s_add_u32 m0, s76, 4096
    s_add_u32 s61, s56, 57344
    buffer_load_dwordx4 v4, s[36:39], s61 offen offset:0 lds
    s_waitcnt lgkmcnt(2)
    v_smfmac_f32_16x16x64_bf16 v[72:75], v[36:39], v[152:159], v44
    ds_read_b128 v[152:155], v12 offset:14336
    ds_read_b128 v[156:159], v12 offset:15360
    v_smfmac_f32_16x16x64_bf16 v[56:59], v[32:35], a[144:151], v44
    v_smfmac_f32_16x16x64_bf16 v[56:59], v[36:39], a[152:159], v44
    v_smfmac_f32_16x16x64_bf16 v[56:59], v[40:43], a[160:167], v44
    s_waitcnt lgkmcnt(2)
    v_smfmac_f32_16x16x64_bf16 v[72:75], v[40:43], v[144:151], v44
    ds_read_b128 v[144:147], v12 offset:16384
    ds_read_b128 v[148:151], v12 offset:17408
    v_smfmac_f32_16x16x64_bf16 v[60:63], v[16:19], a[168:175], v44
    s_add_u32 m0, s76, 4096
    s_add_u32 s61, s56, 57344
    buffer_load_dwordx4 v4, s[36:39], s61 offen offset:1024 lds
    v_smfmac_f32_16x16x64_bf16 v[60:63], v[20:23], a[176:183], v44
    v_smfmac_f32_16x16x64_bf16 v[60:63], v[24:27], a[184:191], v44
    s_waitcnt lgkmcnt(2)
    v_smfmac_f32_16x16x64_bf16 v[76:79], v[16:19], v[152:159], v44
    ds_read_b128 v[152:155], v12 offset:18432
    ds_read_b128 v[156:159], v12 offset:19456
    v_smfmac_f32_16x16x64_bf16 v[60:63], v[28:31], a[192:199], v44
    v_smfmac_f32_16x16x64_bf16 v[60:63], v[32:35], a[200:207], v44
    s_add_u32 m0, s76, 6144
    s_add_u32 s61, s56, 86016
    buffer_load_dwordx4 v4, s[36:39], s61 offen offset:0 lds
    v_smfmac_f32_16x16x64_bf16 v[60:63], v[36:39], a[208:215], v44
    s_waitcnt lgkmcnt(2)
    v_smfmac_f32_16x16x64_bf16 v[76:79], v[20:23], v[144:151], v44
    ds_read_b128 v[144:147], v12 offset:20480
    ds_read_b128 v[148:151], v12 offset:21504
    v_smfmac_f32_16x16x64_bf16 v[60:63], v[40:43], a[216:223], v44
    v_smfmac_f32_16x16x64_bf16 v[64:67], v[16:19], a[224:231], v44
    v_smfmac_f32_16x16x64_bf16 v[64:67], v[20:23], a[232:239], v44
    s_add_u32 m0, s76, 6144
    s_add_u32 s61, s56, 86016
    buffer_load_dwordx4 v4, s[36:39], s61 offen offset:1024 lds
    s_waitcnt lgkmcnt(2)
    v_smfmac_f32_16x16x64_bf16 v[76:79], v[24:27], v[152:159], v44
    ds_read_b128 v[152:155], v12 offset:22528
    ds_read_b128 v[156:159], v12 offset:23552
    v_smfmac_f32_16x16x64_bf16 v[64:67], v[24:27], a[240:247], v44
    v_smfmac_f32_16x16x64_bf16 v[64:67], v[28:31], a[248:255], v44
    v_smfmac_f32_16x16x64_bf16 v[64:67], v[32:35], v[176:183], v44
    s_waitcnt lgkmcnt(2)
    v_smfmac_f32_16x16x64_bf16 v[76:79], v[28:31], v[144:151], v44
    ds_read_b128 v[144:147], v12 offset:24576
    ds_read_b128 v[148:151], v12 offset:25600
    v_smfmac_f32_16x16x64_bf16 v[64:67], v[36:39], v[184:191], v44
    v_smfmac_f32_16x16x64_bf16 v[64:67], v[40:43], v[192:199], v44
    v_smfmac_f32_16x16x64_bf16 v[68:71], v[16:19], v[200:207], v44
    s_waitcnt lgkmcnt(2)
    v_smfmac_f32_16x16x64_bf16 v[76:79], v[32:35], v[152:159], v44
    ds_read_b128 v[152:155], v12 offset:26624
    ds_read_b128 v[156:159], v12 offset:27648
    v_smfmac_f32_16x16x64_bf16 v[68:71], v[20:23], v[208:215], v44
    v_smfmac_f32_16x16x64_bf16 v[68:71], v[24:27], v[216:223], v44
    v_smfmac_f32_16x16x64_bf16 v[68:71], v[28:31], v[224:231], v44
    s_waitcnt lgkmcnt(2)
    v_smfmac_f32_16x16x64_bf16 v[76:79], v[36:39], v[144:151], v44
    v_smfmac_f32_16x16x64_bf16 v[68:71], v[32:35], v[232:239], v44
    v_smfmac_f32_16x16x64_bf16 v[68:71], v[36:39], v[240:247], v44
    v_smfmac_f32_16x16x64_bf16 v[68:71], v[40:43], v[248:255], v44
    s_waitcnt lgkmcnt(0)
    v_smfmac_f32_16x16x64_bf16 v[76:79], v[40:43], v[152:159], v44
    s_nop 7
    v_cvt_pk_bf16_f32 v48, v48, v49
    v_cvt_pk_bf16_f32 v49, v50, v51
    v_cvt_pk_bf16_f32 v50, v56, v57
    v_cvt_pk_bf16_f32 v51, v58, v59
    v_cvt_pk_bf16_f32 v52, v52, v53
    v_cvt_pk_bf16_f32 v53, v54, v55
    v_cvt_pk_bf16_f32 v54, v60, v61
    v_cvt_pk_bf16_f32 v55, v62, v63
    v_cvt_pk_bf16_f32 v64, v64, v65
    v_cvt_pk_bf16_f32 v65, v66, v67
    v_cvt_pk_bf16_f32 v66, v72, v73
    v_cvt_pk_bf16_f32 v67, v74, v75
    v_cvt_pk_bf16_f32 v68, v68, v69
    v_cvt_pk_bf16_f32 v69, v70, v71
    v_cvt_pk_bf16_f32 v70, v76, v77
    v_cvt_pk_bf16_f32 v71, v78, v79
    s_nop 1
    v_mfma_f32_16x16x32_bf16 v[56:59], v[172:175], v[48:51], 0
    v_mfma_f32_16x16x32_bf16 v[60:63], v[172:175], v[52:55], 0
    v_mfma_f32_16x16x32_bf16 v[72:75], v[172:175], v[64:67], 0
    v_mfma_f32_16x16x32_bf16 v[76:79], v[172:175], v[68:71], 0
    s_nop 4
    v_cvt_pk_bf16_f32 v56, v56, v57
    v_cvt_pk_bf16_f32 v57, v58, v59
    v_cvt_pk_bf16_f32 v60, v60, v61
    v_cvt_pk_bf16_f32 v61, v62, v63
    v_cvt_pk_bf16_f32 v72, v72, v73
    v_cvt_pk_bf16_f32 v73, v74, v75
    v_cvt_pk_bf16_f32 v76, v76, v77
    v_cvt_pk_bf16_f32 v77, v78, v79
    s_cmp_eq_u32 s59, 63
    s_cbranch_scc1 VA_LASTX
    buffer_store_dwordx2 v[56:57], v163, s[36:39], s66 offen offset:0
    buffer_store_dwordx2 v[60:61], v163, s[36:39], s66 offen offset:1024
    buffer_store_dwordx2 v[72:73], v163, s[36:39], s66 offen offset:512
    buffer_store_dwordx2 v[76:77], v163, s[36:39], s66 offen offset:1536
    s_add_u32 s66, s66, 114688
    s_barrier
    buffer_load_dwordx4 v[112:115], v5, s[36:39], s58 offen sc1
    buffer_load_dwordx4 v[116:119], v8, s[36:39], s58 offen sc1
    buffer_load_dwordx4 v[120:123], v7, s[36:39], s58 offen sc1
    s_nop 15
    s_nop 15
    buffer_load_dwordx4 v[16:19], v5, s[36:39], s58 offen sc1
    buffer_load_dwordx4 v[20:23], v8, s[36:39], s58 offen sc1
    buffer_load_dwordx4 v[24:27], v7, s[36:39], s58 offen sc1
VA_POLLP:
    s_sub_u32 s99, s99, 1
    s_cbranch_scc1 K2_ABORT
    s_waitcnt vmcnt(3)
    v_max3_u32 v167, v112, v113, v114
    v_max3_u32 v167, v167, v115, v116
    v_max3_u32 v167, v167, v117, v118
    v_max3_u32 v167, v167, v119, v120
    v_max3_u32 v167, v167, v121, v122
    v_max_u32 v167, v167, v123
    v_cmp_eq_u32 vcc, -1, v167
    s_cbranch_vccz VA_POLLP_D0
    buffer_load_dwordx4 v[112:115], v5, s[36:39], s58 offen sc1
    buffer_load_dwordx4 v[116:119], v8, s[36:39], s58 offen sc1
    buffer_load_dwordx4 v[120:123], v7, s[36:39], s58 offen sc1
    s_waitcnt vmcnt(3)
    v_max3_u32 v167, v16, v17, v18
    v_max3_u32 v167, v167, v19, v20
    v_max3_u32 v167, v167, v21, v22
    v_max3_u32 v167, v167, v23, v24
    v_max3_u32 v167, v167, v25, v26
    v_max_u32 v167, v167, v27
    v_cmp_eq_u32 vcc, -1, v167
    s_cbranch_vccz VA_POLLP_D1
    buffer_load_dwordx4 v[16:19], v5, s[36:39], s58 offen sc1
    buffer_load_dwordx4 v[20:23], v8, s[36:39], s58 offen sc1
    buffer_load_dwordx4 v[24:27], v7, s[36:39], s58 offen sc1
    s_branch VA_POLLP
VA_POLLP_D0:
    ds_write_b128 v5, v[112:115] offset:0
    ds_write_b128 v8, v[116:119] offset:0
    ds_write_b128 v7, v[120:123] offset:0
    s_branch VA_POLLP_J
VA_POLLP_D1:
    ds_write_b128 v5, v[16:19] offset:0
    ds_write_b128 v8, v[20:23] offset:0
    ds_write_b128 v7, v[24:27] offset:0
VA_POLLP_J:
    s_waitcnt lgkmcnt(0)
    s_barrier
    s_waitcnt vmcnt(3)
    ds_read_b128 v[144:147], v13 offset:0
    ds_read_b64 v[128:129], v14 offset:0
    ds_read_b128 v[148:151], v13 offset:640
    ds_read_b64 v[130:131], v14 offset:640
    ds_read_b128 v[152:155], v13 offset:1280
    ds_read_b64 v[132:133], v14 offset:1280
    ds_read_b128 v[156:159], v13 offset:1920
    ds_read_b64 v[134:135], v14 offset:1920
    s_waitcnt lgkmcnt(6)
    v_mfma_f32_16x16x32_bf16 v[136:139], v[80:83], v[144:147], 0
    v_mfma_f32_16x16x32_bf16 v[140:143], v[84:87], v[144:147], 0
    s_waitcnt lgkmcnt(4)
    v_mfma_f32_16x16x32_bf16 v[136:139], v[88:91], v[148:151], v[136:139]
    v_mfma_f32_16x16x32_bf16 v[140:143], v[92:95], v[148:151], v[140:143]
    s_waitcnt lgkmcnt(2)
    v_mfma_f32_16x16x32_bf16 v[136:139], v[96:99], v[152:155], v[136:139]
    v_mfma_f32_16x16x32_bf16 v[140:143], v[100:103], v[152:155], v[140:143]
    s_waitcnt lgkmcnt(0)
    v_mfma_f32_16x16x32_bf16 v[136:139], v[104:107], v[156:159], v[136:139]
    v_mfma_f32_16x16x32_bf16 v[140:143], v[108:111], v[156:159], v[140:143]
    v_mfma_f32_16x16x32_bf16 v[136:139], v[48:51], v[128:131], v[136:139]
    v_mfma_f32_16x16x32_bf16 v[140:143], v[52:55], v[128:131], v[140:143]
    v_mfma_f32_16x16x32_bf16 v[136:139], v[64:67], v[132:135], v[136:139]
    v_mfma_f32_16x16x32_bf16 v[140:143], v[68:71], v[132:135], v[140:143]
VA_PJ:
    s_add_u32 s57, s57, 7168
    s_add_u32 s56, s56, 458752
    s_add_u32 s58, s58, 10240
    s_add_u32 s59, s59, 1
    s_mov_b64 exec, s[64:65]
    s_nop 2
    ds_write_b128 v160, v[136:139] offset:0
    ds_write_b128 v160, v[140:143] offset:64
    s_mov_b64 exec, -1
    s_waitcnt lgkmcnt(0)
    s_barrier
    ds_read_b64 v[80:81], v161 offset:0
    ds_read_b64 v[82:83], v161 offset:1152
    ds_read_b64 v[84:85], v161 offset:2304
    ds_read_b64 v[86:87], v161 offset:3456
    s_waitcnt lgkmcnt(2)
    v_pk_add_f32 v[80:81], v[80:81], v[82:83]
    s_waitcnt lgkmcnt(0)
    v_pk_add_f32 v[84:85], v[84:85], v[86:87]
    v_pk_add_f32 v[80:81], v[80:81], v[84:85]
    v_cvt_pk_bf16_f32 v165, v80, v81
    v_min_u32 v165, 0xfffffffe, v165
    s_mov_b64 exec, s[62:63]
    buffer_store_dword v165, v162, s[36:39], s57 offen
    s_mov_b64 exec, -1
    s_waitcnt vmcnt(1)
    ds_read_b128 v[80:83], v166 offset:0
    ds_read_b128 v[84:87], v166 offset:1024
    ds_read_b128 v[88:91], v166 offset:2048
    ds_read_b128 v[92:95], v166 offset:3072
    ds_read_b128 v[96:99], v166 offset:4096
    ds_read_b128 v[100:103], v166 offset:5120
    ds_read_b128 v[104:107], v166 offset:6144
    ds_read_b128 v[108:111], v166 offset:7168
    s_branch VA_LOOP
VA_LASTX:
    s_add_u32 s66, s66, -90177536
    buffer_store_dwordx2 v[56:57], v163, s[36:39], s66 offen offset:0 sc1
    buffer_store_dwordx2 v[60:61], v163, s[36:39], s66 offen offset:1024 sc1
    buffer_store_dwordx2 v[72:73], v163, s[36:39], s66 offen offset:512 sc1
    buffer_store_dwordx2 v[76:77], v163, s[36:39], s66 offen offset:1536 sc1
    s_waitcnt vmcnt(0)
    s_barrier
    s_cmp_eq_u32 s40, 0
    s_cbranch_scc0 VA_END
    s_mov_b64 exec, 1
    v_mov_b32 v10, 0
    v_mov_b32 v11, 1
    s_mov_b32 s60, 24194944
    buffer_atomic_add v11, v10, s[36:39], s60 offen
    s_mov_b64 exec, -1
VA_END:
    s_endpgm
K2_HELPER:
    v_lshlrev_b32 v5, 4, v0
    v_add_u32 v6, 4096, v5
    v_cmp_gt_u32 vcc, 192, v0
    s_nop 1
    v_cndmask_b32 v6, v5, v6, vcc
    v_lshlrev_b32 v4, 4, v1
    s_mul_i32 s48, s40, 28672
    s_mul_i32 s49, s42, 114688
    s_add_u32 s48, s48, s49
    s_add_u32 s56, s48, 117440512
    s_add_u32 s58, s48, 27262976
    s_mul_i32 s49, s42, 7168
    s_add_u32 s57, s49, 25172992
    s_mov_b32 s59, s42
    s_lshl_b32 s49, s42, 7
    s_add_u32 s67, s49, 24186880
    v_mov_b32 v7, 0
    v_mov_b32 v8, 1
HE_LOOP:
HE_POLL:
    s_sub_u32 s99, s99, 1
    s_cbranch_scc1 K2_ABORT
    buffer_load_dwordx4 v[16:19], v5, s[36:39], s57 offen sc1
    buffer_load_dwordx4 v[20:23], v6, s[36:39], s57 offen sc1
    s_waitcnt vmcnt(0)
    v_max3_u32 v9, v16, v17, v18
    v_max3_u32 v9, v9, v19, v20
    v_max3_u32 v9, v9, v21, v22
    v_max_u32 v9, v9, v23
    v_cmp_eq_u32 vcc, -1, v9
    s_cbranch_vccz HE_POK
    s_sleep 6
    s_branch HE_POLL
HE_POK:
    s_barrier
    s_add_u32 s61, s57, 524288
    buffer_store_dwordx4 v[16:19], v5, s[36:39], s61 offen sc1
    buffer_store_dwordx4 v[20:23], v6, s[36:39], s61 offen sc1
    s_add_u32 s60, s56, 0
    buffer_load_dwordx4 v[32:35], v4, s[36:39], s60 offen offset:0 sc1
    s_add_u32 s60, s56, 0
    buffer_load_dwordx4 v[36:39], v4, s[36:39], s60 offen offset:1024 sc1
    s_add_u32 s60, s56, 0
    buffer_load_dwordx4 v[40:43], v4, s[36:39], s60 offen offset:2048 sc1
    s_add_u32 s60, s56, 0
    buffer_load_dwordx4 v[44:47], v4, s[36:39], s60 offen offset:3072 sc1
    s_add_u32 s60, s56, 4096
    buffer_load_dwordx4 v[48:51], v4, s[36:39], s60 offen offset:0 sc1
    s_add_u32 s60, s56, 4096
    buffer_load_dwordx4 v[52:55], v4, s[36:39], s60 offen offset:1024 sc1
    s_add_u32 s60, s56, 4096
    buffer_load_dwordx4 v[56:59], v4, s[36:39], s60 offen offset:2048 sc1
    s_add_u32 s60, s56, 4096
    buffer_load_dwordx4 v[60:63], v4, s[36:39], s60 offen offset:3072 sc1
    s_add_u32 s60, s56, 8192
    buffer_load_dwordx4 v[64:67], v4, s[36:39], s60 offen offset:0 sc1
    s_add_u32 s60, s56, 8192
    buffer_load_dwordx4 v[68:71], v4, s[36:39], s60 offen offset:1024 sc1
    s_add_u32 s60, s56, 8192
    buffer_load_dwordx4 v[72:75], v4, s[36:39], s60 offen offset:2048 sc1
    s_add_u32 s60, s56, 8192
    buffer_load_dwordx4 v[76:79], v4, s[36:39], s60 offen offset:3072 sc1
    s_add_u32 s60, s56, 12288
    buffer_load_dwordx4 v[80:83], v4, s[36:39], s60 offen offset:0 sc1
    s_add_u32 s60, s56, 12288
    buffer_load_dwordx4 v[84:87], v4, s[36:39], s60 offen offset:1024 sc1
    s_add_u32 s60, s56, 12288
    buffer_load_dwordx4 v[88:91], v4, s[36:39], s60 offen offset:2048 sc1
    s_add_u32 s60, s56, 12288
    buffer_load_dwordx4 v[92:95], v4, s[36:39], s60 offen offset:3072 sc1
    s_add_u32 s60, s56, 16384
    buffer_load_dwordx4 v[96:99], v4, s[36:39], s60 offen offset:0 sc1
    s_add_u32 s60, s56, 16384
    buffer_load_dwordx4 v[100:103], v4, s[36:39], s60 offen offset:1024 sc1
    s_add_u32 s60, s56, 16384
    buffer_load_dwordx4 v[104:107], v4, s[36:39], s60 offen offset:2048 sc1
    s_add_u32 s60, s56, 16384
    buffer_load_dwordx4 v[108:111], v4, s[36:39], s60 offen offset:3072 sc1
    s_add_u32 s60, s56, 20480
    buffer_load_dwordx4 v[112:115], v4, s[36:39], s60 offen offset:0 sc1
    s_add_u32 s60, s56, 20480
    buffer_load_dwordx4 v[116:119], v4, s[36:39], s60 offen offset:1024 sc1
    s_add_u32 s60, s56, 20480
    buffer_load_dwordx4 v[120:123], v4, s[36:39], s60 offen offset:2048 sc1
    s_add_u32 s60, s56, 20480
    buffer_load_dwordx4 v[124:127], v4, s[36:39], s60 offen offset:3072 sc1
    s_add_u32 s60, s56, 24576
    buffer_load_dwordx4 v[128:131], v4, s[36:39], s60 offen offset:0 sc1
    s_add_u32 s60, s56, 24576
    buffer_load_dwordx4 v[132:135], v4, s[36:39], s60 offen offset:1024 sc1
    s_add_u32 s60, s56, 24576
    buffer_load_dwordx4 v[136:139], v4, s[36:39], s60 offen offset:2048 sc1
    s_add_u32 s60, s56, 24576
    buffer_load_dwordx4 v[140:143], v4, s[36:39], s60 offen offset:3072 sc1
    s_waitcnt vmcnt(28)
    s_barrier
    s_cmp_eq_u32 s40, 0
    s_cbranch_scc0 HE_NOM
    s_mov_b64 exec, 1
    s_add_u32 s60, s67, 47232
    buffer_atomic_add v8, v7, s[36:39], s60 offen
    s_mov_b64 exec, -1
HE_NOM:
    s_waitcnt vmcnt(27)
    s_add_u32 s60, s58, 0
    buffer_store_dwordx4 v[32:35], v4, s[36:39], s60 offen offset:0 sc1
    s_waitcnt vmcnt(27)
    s_add_u32 s60, s58, 0
    buffer_store_dwordx4 v[36:39], v4, s[36:39], s60 offen offset:1024 sc1
    s_waitcnt vmcnt(27)
    s_add_u32 s60, s58, 0
    buffer_store_dwordx4 v[40:43], v4, s[36:39], s60 offen offset:2048 sc1
    s_waitcnt vmcnt(27)
    s_add_u32 s60, s58, 0
    buffer_store_dwordx4 v[44:47], v4, s[36:39], s60 offen offset:3072 sc1
    s_waitcnt vmcnt(27)
    s_add_u32 s60, s58, 4096
    buffer_store_dwordx4 v[48:51], v4, s[36:39], s60 offen offset:0 sc1
    s_waitcnt vmcnt(27)
    s_add_u32 s60, s58, 4096
    buffer_store_dwordx4 v[52:55], v4, s[36:39], s60 offen offset:1024 sc1
    s_waitcnt vmcnt(27)
    s_add_u32 s60, s58, 4096
    buffer_store_dwordx4 v[56:59], v4, s[36:39], s60 offen offset:2048 sc1
    s_waitcnt vmcnt(27)
    s_add_u32 s60, s58, 4096
    buffer_store_dwordx4 v[60:63], v4, s[36:39], s60 offen offset:3072 sc1
    s_waitcnt vmcnt(27)
    s_add_u32 s60, s58, 8192
    buffer_store_dwordx4 v[64:67], v4, s[36:39], s60 offen offset:0 sc1
    s_waitcnt vmcnt(27)
    s_add_u32 s60, s58, 8192
    buffer_store_dwordx4 v[68:71], v4, s[36:39], s60 offen offset:1024 sc1
    s_waitcnt vmcnt(27)
    s_add_u32 s60, s58, 8192
    buffer_store_dwordx4 v[72:75], v4, s[36:39], s60 offen offset:2048 sc1
    s_waitcnt vmcnt(27)
    s_add_u32 s60, s58, 8192
    buffer_store_dwordx4 v[76:79], v4, s[36:39], s60 offen offset:3072 sc1
    s_waitcnt vmcnt(27)
    s_add_u32 s60, s58, 12288
    buffer_store_dwordx4 v[80:83], v4, s[36:39], s60 offen offset:0 sc1
    s_waitcnt vmcnt(27)
    s_add_u32 s60, s58, 12288
    buffer_store_dwordx4 v[84:87], v4, s[36:39], s60 offen offset:1024 sc1
    s_waitcnt vmcnt(27)
    s_add_u32 s60, s58, 12288
    buffer_store_dwordx4 v[88:91], v4, s[36:39], s60 offen offset:2048 sc1
    s_waitcnt vmcnt(27)
    s_add_u32 s60, s58, 12288
    buffer_store_dwordx4 v[92:95], v4, s[36:39], s60 offen offset:3072 sc1
    s_waitcnt vmcnt(27)
    s_add_u32 s60, s58, 16384
    buffer_store_dwordx4 v[96:99], v4, s[36:39], s60 offen offset:0 sc1
    s_waitcnt vmcnt(27)
    s_add_u32 s60, s58, 16384
    buffer_store_dwordx4 v[100:103], v4, s[36:39], s60 offen offset:1024 sc1
    s_waitcnt vmcnt(27)
    s_add_u32 s60, s58, 16384
    buffer_store_dwordx4 v[104:107], v4, s[36:39], s60 offen offset:2048 sc1
    s_waitcnt vmcnt(27)
    s_add_u32 s60, s58, 16384
    buffer_store_dwordx4 v[108:111], v4, s[36:39], s60 offen offset:3072 sc1
    s_waitcnt vmcnt(27)
    s_add_u32 s60, s58, 20480
    buffer_store_dwordx4 v[112:115], v4, s[36:39], s60 offen offset:0 sc1
    s_waitcnt vmcnt(27)
    s_add_u32 s60, s58, 20480
    buffer_store_dwordx4 v[116:119], v4, s[36:39], s60 offen offset:1024 sc1
    s_waitcnt vmcnt(27)
    s_add_u32 s60, s58, 20480
    buffer_store_dwordx4 v[120:123], v4, s[36:39], s60 offen offset:2048 sc1
    s_waitcnt vmcnt(27)
    s_add_u32 s60, s58, 20480
    buffer_store_dwordx4 v[124:127], v4, s[36:39], s60 offen offset:3072 sc1
    s_waitcnt vmcnt(27)
    s_add_u32 s60, s58, 24576
    buffer_store_dwordx4 v[128:131], v4, s[36:39], s60 offen offset:0 sc1
    s_waitcnt vmcnt(27)
    s_add_u32 s60, s58, 24576
    buffer_store_dwordx4 v[132:135], v4, s[36:39], s60 offen offset:1024 sc1
    s_waitcnt vmcnt(27)
    s_add_u32 s60, s58, 24576
    buffer_store_dwordx4 v[136:139], v4, s[36:39], s60 offen offset:2048 sc1
    s_waitcnt vmcnt(27)
    s_add_u32 s60, s58, 24576
    buffer_store_dwordx4 v[140:143], v4, s[36:39], s60 offen offset:3072 sc1
    s_waitcnt vmcnt(0)
    s_barrier
    s_cmp_eq_u32 s40, 0
    s_cbranch_scc0 HE_NOF
    s_mov_b64 exec, 1
    buffer_atomic_add v8, v7, s[36:39], s67 offen
    s_mov_b64 exec, -1
HE_NOF:
    s_add_u32 s56, s56, 229376
    s_add_u32 s58, s58, 229376
    s_add_u32 s57, s57, 14336
    s_add_u32 s67, s67, 256
    s_add_u32 s59, s59, 2
    s_cmp_lt_u32 s59, 63
    s_cbranch_scc1 HE_LOOP
    s_endpgm
K2_WORKER:
    s_cmp_gt_u32 s41, s43
    s_cselect_b32 s90, 1, 0
    s_sub_u32 s90, s41, s90
    s_min_u32 s90, s90, 6
    s_mov_b32 s91, 0
    v_lshlrev_b32 v4, 4, v1
    v_and_b32 v2, 31, v1
    v_lshrrev_b32 v3, 5, v1
    v_lshrrev_b32 v5, 4, v2
    v_and_b32 v6, 15, v2
    v_lshlrev_b32 v6, 4, v6
    v_lshl_add_u32 v6, v3, 3, v6
W_NEXT:
    v_lshlrev_b32 v4, 4, v1
    v_and_b32 v2, 31, v1
    v_lshrrev_b32 v3, 5, v1
    v_lshrrev_b32 v5, 4, v2
    v_and_b32 v6, 15, v2
    v_lshlrev_b32 v6, 4, v6
    v_lshl_add_u32 v6, v3, 3, v6
    s_cmp_eq_u32 s40, 0
    s_cbranch_scc0 W_BC
    s_mov_b64 exec, 1
    s_lshl_b32 s50, s90, 7
    s_add_u32 s50, s50, 24195584
    v_mov_b32 v8, 0
    v_mov_b32 v9, 117
    s_cmp_eq_u32 s91, 0
    s_cbranch_scc1 W_ATOM
    buffer_load_dword v9, v8, s[36:39], s50 offen sc1
    s_waitcnt vmcnt(0)
    v_readfirstlane_b32 s51, v9
    s_cmp_lt_u32 s51, 117
    s_cbranch_scc0 W_WR
W_ATOM:
    v_mov_b32 v9, 1
    buffer_atomic_add v9, v8, s[36:39], s50 offen sc0
    s_waitcnt vmcnt(0)
W_WR:
    v_mov_b32 v8, 140000
    ds_write_b32 v8, v9
    s_waitcnt lgkmcnt(0)
    s_mov_b64 exec, -1
W_BC:
    s_barrier
    v_mov_b32 v8, 140000
    ds_read_b32 v9, v8
    s_waitcnt lgkmcnt(0)
    v_readfirstlane_b32 s51, v9
    s_barrier
    s_cmp_lt_u32 s51, 117
    s_cbranch_scc1 W_GOT
    s_add_u32 s90, s90, 1
    s_cmp_ge_u32 s90, 7
    s_cselect_b32 s90, 0, s90
    s_add_u32 s91, s91, 1
    s_cmp_lt_u32 s91, 7
    s_cbranch_scc1 W_NEXT
    s_branch W_TOK
W_GOT:
    s_cmp_lt_u32 s51, 32
    s_cbranch_scc1 W_VS
    s_cmp_lt_u32 s51, 61
    s_cbranch_scc1 W_PREP
    s_sub_u32 s51, s51, 29
    s_sub_u32 s53, s51, 24
    s_mov_b32 s52, 0
    s_cmp_lt_u32 s51, 56
    s_cbranch_scc1 W_DEC
    s_sub_u32 s53, s51, 56
    s_mov_b32 s52, 1
W_DEC:
    s_lshr_b32 s54, s53, 2
    s_and_b32 s53, s53, 3
    s_lshl_b32 s55, s90, 2
    s_add_u32 s55, s55, s53
    s_mul_i32 s56, s54, 8*28*1024
    s_add_u32 s56, s56, 0
    s_mul_i32 s57, s55, 8*28*1024
    s_cmp_eq_u32 s52, 0
    s_cbranch_scc0 W_T
    s_add_u32 s57, s57, 10616832
    s_mul_i32 s62, s40, 57344
    s_add_u32 s62, s62, s56
    s_mul_i32 s63, s40, 57344
    s_add_u32 s63, s63, s57
    s_mul_i32 s64, s40, 8192
    s_add_u32 s64, s64, 0
    s_mul_i32 s65, s40, 8192
    s_add_u32 s65, s65, 32768
    s_lshr_b32 s60, s40, 1
    s_mul_i32 s60, s60, 16384
    s_add_u32 s60, s60, 0
    v_add_u32 v12, s60, v4
    s_and_b32 s60, s40, 1
    s_mul_i32 s60, s60, 16384
    s_add_u32 s60, s60, 32768
    v_add_u32 v13, s60, v4
    v_add_u32 v14, 65536, v12
    v_add_u32 v15, 65536, v13
    s_barrier
    s_add_u32 m0, s64, 0
    s_add_u32 s60, s62, 0
    buffer_load_dwordx4 v4, s[36:39], s60 offen offset:0 lds
    buffer_load_dwordx4 v4, s[36:39], s60 offen offset:1024 lds
    buffer_load_dwordx4 v4, s[36:39], s60 offen offset:2048 lds
    buffer_load_dwordx4 v4, s[36:39], s60 offen offset:3072 lds
    s_add_u32 m0, s64, 4096
    s_add_u32 s60, s62, 28672
    buffer_load_dwordx4 v4, s[36:39], s60 offen offset:0 lds
    buffer_load_dwordx4 v4, s[36:39], s60 offen offset:1024 lds
    buffer_load_dwordx4 v4, s[36:39], s60 offen offset:2048 lds
    buffer_load_dwordx4 v4, s[36:39], s60 offen offset:3072 lds
    s_add_u32 m0, s65, 0
    s_add_u32 s60, s63, 0
    buffer_load_dwordx4 v4, s[36:39], s60 offen offset:0 lds
    buffer_load_dwordx4 v4, s[36:39], s60 offen offset:1024 lds
    buffer_load_dwordx4 v4, s[36:39], s60 offen offset:2048 lds
    buffer_load_dwordx4 v4, s[36:39], s60 offen offset:3072 lds
    s_add_u32 m0, s65, 4096
    s_add_u32 s60, s63, 28672
    buffer_load_dwordx4 v4, s[36:39], s60 offen offset:0 lds
    buffer_load_dwordx4 v4, s[36:39], s60 offen offset:1024 lds
    buffer_load_dwordx4 v4, s[36:39], s60 offen offset:2048 lds
    buffer_load_dwordx4 v4, s[36:39], s60 offen offset:3072 lds
    s_waitcnt vmcnt(0)
    s_barrier
    ds_read_b128 v[16:19], v12 offset:0
    ds_read_b128 v[20:23], v12 offset:4096
    ds_read_b128 v[24:27], v12 offset:8192
    ds_read_b128 v[28:31], v12 offset:12288
    ds_read_b128 v[48:51], v13 offset:0
    ds_read_b128 v[52:55], v13 offset:4096
    ds_read_b128 v[56:59], v13 offset:8192
    ds_read_b128 v[60:63], v13 offset:12288
    s_add_u32 m0, s64, 65536
    s_add_u32 s60, s62, 4096
    buffer_load_dwordx4 v4, s[36:39], s60 offen offset:0 lds
    buffer_load_dwordx4 v4, s[36:39], s60 offen offset:1024 lds
    buffer_load_dwordx4 v4, s[36:39], s60 offen offset:2048 lds
    buffer_load_dwordx4 v4, s[36:39], s60 offen offset:3072 lds
    s_add_u32 m0, s64, 69632
    s_add_u32 s60, s62, 32768
    buffer_load_dwordx4 v4, s[36:39], s60 offen offset:0 lds
    buffer_load_dwordx4 v4, s[36:39], s60 offen offset:1024 lds
    buffer_load_dwordx4 v4, s[36:39], s60 offen offset:2048 lds
    buffer_load_dwordx4 v4, s[36:39], s60 offen offset:3072 lds
    s_add_u32 m0, s65, 65536
    s_add_u32 s60, s63, 4096
    buffer_load_dwordx4 v4, s[36:39], s60 offen offset:0 lds
    buffer_load_dwordx4 v4, s[36:39], s60 offen offset:1024 lds
    buffer_load_dwordx4 v4, s[36:39], s60 offen offset:2048 lds
    buffer_load_dwordx4 v4, s[36:39], s60 offen offset:3072 lds
    s_add_u32 m0, s65, 69632
    s_add_u32 s60, s63, 32768
    buffer_load_dwordx4 v4, s[36:39], s60 offen offset:0 lds
    buffer_load_dwordx4 v4, s[36:39], s60 offen offset:1024 lds
    buffer_load_dwordx4 v4, s[36:39], s60 offen offset:2048 lds
    buffer_load_dwordx4 v4, s[36:39], s60 offen offset:3072 lds
    ds_read_b128 v[32:35], v12 offset:1024
    ds_read_b128 v[36:39], v12 offset:5120
    ds_read_b128 v[40:43], v12 offset:9216
    ds_read_b128 v[44:47], v12 offset:13312
    ds_read_b128 v[64:67], v13 offset:1024
    ds_read_b128 v[68:71], v13 offset:5120
    ds_read_b128 v[72:75], v13 offset:9216
    ds_read_b128 v[76:79], v13 offset:13312
    s_waitcnt lgkmcnt(8)
    v_mfma_f32_32x32x16_bf16 a[0:15], v[16:19], v[48:51], 0
    v_mfma_f32_32x32x16_bf16 a[16:31], v[16:19], v[52:55], 0
    v_mfma_f32_32x32x16_bf16 a[32:47], v[16:19], v[56:59], 0
    v_mfma_f32_32x32x16_bf16 a[48:63], v[16:19], v[60:63], 0
    v_mfma_f32_32x32x16_bf16 a[64:79], v[20:23], v[48:51], 0
    v_mfma_f32_32x32x16_bf16 a[80:95], v[20:23], v[52:55], 0
    v_mfma_f32_32x32x16_bf16 a[96:111], v[20:23], v[56:59], 0
    v_mfma_f32_32x32x16_bf16 a[112:127], v[20:23], v[60:63], 0
    v_mfma_f32_32x32x16_bf16 a[128:143], v[24:27], v[48:51], 0
    v_mfma_f32_32x32x16_bf16 a[144:159], v[24:27], v[52:55], 0
    v_mfma_f32_32x32x16_bf16 a[160:175], v[24:27], v[56:59], 0
    v_mfma_f32_32x32x16_bf16 a[176:191], v[24:27], v[60:63], 0
    v_mfma_f32_32x32x16_bf16 a[192:207], v[28:31], v[48:51], 0
    v_mfma_f32_32x32x16_bf16 a[208:223], v[28:31], v[52:55], 0
    v_mfma_f32_32x32x16_bf16 a[224:239], v[28:31], v[56:59], 0
    v_mfma_f32_32x32x16_bf16 a[240:255], v[28:31], v[60:63], 0
    ds_read_b128 v[16:19], v12 offset:2048
    ds_read_b128 v[20:23], v12 offset:6144
    ds_read_b128 v[24:27], v12 offset:10240
    ds_read_b128 v[28:31], v12 offset:14336
    ds_read_b128 v[48:51], v13 offset:2048
    ds_read_b128 v[52:55], v13 offset:6144
    ds_read_b128 v[56:59], v13 offset:10240
    ds_read_b128 v[60:63], v13 offset:14336
    s_waitcnt lgkmcnt(8)
    v_mfma_f32_32x32x16_bf16 a[0:15], v[32:35], v[64:67], a[0:15]
    v_mfma_f32_32x32x16_bf16 a[16:31], v[32:35], v[68:71], a[16:31]
    v_mfma_f32_32x32x16_bf16 a[32:47], v[32:35], v[72:75], a[32:47]
    v_mfma_f32_32x32x16_bf16 a[48:63], v[32:35], v[76:79], a[48:63]
    v_mfma_f32_32x32x16_bf16 a[64:79], v[36:39], v[64:67], a[64:79]
    v_mfma_f32_32x32x16_bf16 a[80:95], v[36:39], v[68:71], a[80:95]
    v_mfma_f32_32x32x16_bf16 a[96:111], v[36:39], v[72:75], a[96:111]
    v_mfma_f32_32x32x16_bf16 a[112:127], v[36:39], v[76:79], a[112:127]
    v_mfma_f32_32x32x16_bf16 a[128:143], v[40:43], v[64:67], a[128:143]
    v_mfma_f32_32x32x16_bf16 a[144:159], v[40:43], v[68:71], a[144:159]
    v_mfma_f32_32x32x16_bf16 a[160:175], v[40:43], v[72:75], a[160:175]
    v_mfma_f32_32x32x16_bf16 a[176:191], v[40:43], v[76:79], a[176:191]
    v_mfma_f32_32x32x16_bf16 a[192:207], v[44:47], v[64:67], a[192:207]
    v_mfma_f32_32x32x16_bf16 a[208:223], v[44:47], v[68:71], a[208:223]
    v_mfma_f32_32x32x16_bf16 a[224:239], v[44:47], v[72:75], a[224:239]
    v_mfma_f32_32x32x16_bf16 a[240:255], v[44:47], v[76:79], a[240:255]
    ds_read_b128 v[32:35], v12 offset:3072
    ds_read_b128 v[36:39], v12 offset:7168
    ds_read_b128 v[40:43], v12 offset:11264
    ds_read_b128 v[44:47], v12 offset:15360
    ds_read_b128 v[64:67], v13 offset:3072
    ds_read_b128 v[68:71], v13 offset:7168
    ds_read_b128 v[72:75], v13 offset:11264
    ds_read_b128 v[76:79], v13 offset:15360
    s_waitcnt lgkmcnt(8)
    v_mfma_f32_32x32x16_bf16 a[0:15], v[16:19], v[48:51], a[0:15]
    v_mfma_f32_32x32x16_bf16 a[16:31], v[16:19], v[52:55], a[16:31]
    v_mfma_f32_32x32x16_bf16 a[32:47], v[16:19], v[56:59], a[32:47]
    v_mfma_f32_32x32x16_bf16 a[48:63], v[16:19], v[60:63], a[48:63]
    v_mfma_f32_32x32x16_bf16 a[64:79], v[20:23], v[48:51], a[64:79]
    v_mfma_f32_32x32x16_bf16 a[80:95], v[20:23], v[52:55], a[80:95]
    v_mfma_f32_32x32x16_bf16 a[96:111], v[20:23], v[56:59], a[96:111]
    v_mfma_f32_32x32x16_bf16 a[112:127], v[20:23], v[60:63], a[112:127]
    v_mfma_f32_32x32x16_bf16 a[128:143], v[24:27], v[48:51], a[128:143]
    v_mfma_f32_32x32x16_bf16 a[144:159], v[24:27], v[52:55], a[144:159]
    v_mfma_f32_32x32x16_bf16 a[160:175], v[24:27], v[56:59], a[160:175]
    v_mfma_f32_32x32x16_bf16 a[176:191], v[24:27], v[60:63], a[176:191]
    v_mfma_f32_32x32x16_bf16 a[192:207], v[28:31], v[48:51], a[192:207]
    v_mfma_f32_32x32x16_bf16 a[208:223], v[28:31], v[52:55], a[208:223]
    v_mfma_f32_32x32x16_bf16 a[224:239], v[28:31], v[56:59], a[224:239]
    v_mfma_f32_32x32x16_bf16 a[240:255], v[28:31], v[60:63], a[240:255]
    s_waitcnt lgkmcnt(0)
    v_mfma_f32_32x32x16_bf16 a[0:15], v[32:35], v[64:67], a[0:15]
    v_mfma_f32_32x32x16_bf16 a[16:31], v[32:35], v[68:71], a[16:31]
    v_mfma_f32_32x32x16_bf16 a[32:47], v[32:35], v[72:75], a[32:47]
    v_mfma_f32_32x32x16_bf16 a[48:63], v[32:35], v[76:79], a[48:63]
    v_mfma_f32_32x32x16_bf16 a[64:79], v[36:39], v[64:67], a[64:79]
    v_mfma_f32_32x32x16_bf16 a[80:95], v[36:39], v[68:71], a[80:95]
    v_mfma_f32_32x32x16_bf16 a[96:111], v[36:39], v[72:75], a[96:111]
    v_mfma_f32_32x32x16_bf16 a[112:127], v[36:39], v[76:79], a[112:127]
    v_mfma_f32_32x32x16_bf16 a[128:143], v[40:43], v[64:67], a[128:143]
    v_mfma_f32_32x32x16_bf16 a[144:159], v[40:43], v[68:71], a[144:159]
    v_mfma_f32_32x32x16_bf16 a[160:175], v[40:43], v[72:75], a[160:175]
    v_mfma_f32_32x32x16_bf16 a[176:191], v[40:43], v[76:79], a[176:191]
    v_mfma_f32_32x32x16_bf16 a[192:207], v[44:47], v[64:67], a[192:207]
    v_mfma_f32_32x32x16_bf16 a[208:223], v[44:47], v[68:71], a[208:223]
    v_mfma_f32_32x32x16_bf16 a[224:239], v[44:47], v[72:75], a[224:239]
    v_mfma_f32_32x32x16_bf16 a[240:255], v[44:47], v[76:79], a[240:255]
    s_waitcnt vmcnt(0)
    s_barrier
    ds_read_b128 v[16:19], v14 offset:0
    ds_read_b128 v[20:23], v14 offset:4096
    ds_read_b128 v[24:27], v14 offset:8192
    ds_read_b128 v[28:31], v14 offset:12288
    ds_read_b128 v[48:51], v15 offset:0
    ds_read_b128 v[52:55], v15 offset:4096
    ds_read_b128 v[56:59], v15 offset:8192
    ds_read_b128 v[60:63], v15 offset:12288
    s_add_u32 m0, s64, 0
    s_add_u32 s60, s62, 8192
    buffer_load_dwordx4 v4, s[36:39], s60 offen offset:0 lds
    buffer_load_dwordx4 v4, s[36:39], s60 offen offset:1024 lds
    buffer_load_dwordx4 v4, s[36:39], s60 offen offset:2048 lds
    buffer_load_dwordx4 v4, s[36:39], s60 offen offset:3072 lds
    s_add_u32 m0, s64, 4096
    s_add_u32 s60, s62, 36864
    buffer_load_dwordx4 v4, s[36:39], s60 offen offset:0 lds
    buffer_load_dwordx4 v4, s[36:39], s60 offen offset:1024 lds
    buffer_load_dwordx4 v4, s[36:39], s60 offen offset:2048 lds
    buffer_load_dwordx4 v4, s[36:39], s60 offen offset:3072 lds
    s_add_u32 m0, s65, 0
    s_add_u32 s60, s63, 8192
    buffer_load_dwordx4 v4, s[36:39], s60 offen offset:0 lds
    buffer_load_dwordx4 v4, s[36:39], s60 offen offset:1024 lds
    buffer_load_dwordx4 v4, s[36:39], s60 offen offset:2048 lds
    buffer_load_dwordx4 v4, s[36:39], s60 offen offset:3072 lds
    s_add_u32 m0, s65, 4096
    s_add_u32 s60, s63, 36864
    buffer_load_dwordx4 v4, s[36:39], s60 offen offset:0 lds
    buffer_load_dwordx4 v4, s[36:39], s60 offen offset:1024 lds
    buffer_load_dwordx4 v4, s[36:39], s60 offen offset:2048 lds
    buffer_load_dwordx4 v4, s[36:39], s60 offen offset:3072 lds
    ds_read_b128 v[32:35], v14 offset:1024
    ds_read_b128 v[36:39], v14 offset:5120
    ds_read_b128 v[40:43], v14 offset:9216
    ds_read_b128 v[44:47], v14 offset:13312
    ds_read_b128 v[64:67], v15 offset:1024
    ds_read_b128 v[68:71], v15 offset:5120
    ds_read_b128 v[72:75], v15 offset:9216
    ds_read_b128 v[76:79], v15 offset:13312
    s_waitcnt lgkmcnt(8)
    v_mfma_f32_32x32x16_bf16 a[0:15], v[16:19], v[48:51], a[0:15]
    v_mfma_f32_32x32x16_bf16 a[16:31], v[16:19], v[52:55], a[16:31]
    v_mfma_f32_32x32x16_bf16 a[32:47], v[16:19], v[56:59], a[32:47]
    v_mfma_f32_32x32x16_bf16 a[48:63], v[16:19], v[60:63], a[48:63]
    v_mfma_f32_32x32x16_bf16 a[64:79], v[20:23], v[48:51], a[64:79]
    v_mfma_f32_32x32x16_bf16 a[80:95], v[20:23], v[52:55], a[80:95]
    v_mfma_f32_32x32x16_bf16 a[96:111], v[20:23], v[56:59], a[96:111]
    v_mfma_f32_32x32x16_bf16 a[112:127], v[20:23], v[60:63], a[112:127]
    v_mfma_f32_32x32x16_bf16 a[128:143], v[24:27], v[48:51], a[128:143]
    v_mfma_f32_32x32x16_bf16 a[144:159], v[24:27], v[52:55], a[144:159]
    v_mfma_f32_32x32x16_bf16 a[160:175], v[24:27], v[56:59], a[160:175]
    v_mfma_f32_32x32x16_bf16 a[176:191], v[24:27], v[60:63], a[176:191]
    v_mfma_f32_32x32x16_bf16 a[192:207], v[28:31], v[48:51], a[192:207]
    v_mfma_f32_32x32x16_bf16 a[208:223], v[28:31], v[52:55], a[208:223]
    v_mfma_f32_32x32x16_bf16 a[224:239], v[28:31], v[56:59], a[224:239]
    v_mfma_f32_32x32x16_bf16 a[240:255], v[28:31], v[60:63], a[240:255]
    ds_read_b128 v[16:19], v14 offset:2048
    ds_read_b128 v[20:23], v14 offset:6144
    ds_read_b128 v[24:27], v14 offset:10240
    ds_read_b128 v[28:31], v14 offset:14336
    ds_read_b128 v[48:51], v15 offset:2048
    ds_read_b128 v[52:55], v15 offset:6144
    ds_read_b128 v[56:59], v15 offset:10240
    ds_read_b128 v[60:63], v15 offset:14336
    s_waitcnt lgkmcnt(8)
    v_mfma_f32_32x32x16_bf16 a[0:15], v[32:35], v[64:67], a[0:15]
    v_mfma_f32_32x32x16_bf16 a[16:31], v[32:35], v[68:71], a[16:31]
    v_mfma_f32_32x32x16_bf16 a[32:47], v[32:35], v[72:75], a[32:47]
    v_mfma_f32_32x32x16_bf16 a[48:63], v[32:35], v[76:79], a[48:63]
    v_mfma_f32_32x32x16_bf16 a[64:79], v[36:39], v[64:67], a[64:79]
    v_mfma_f32_32x32x16_bf16 a[80:95], v[36:39], v[68:71], a[80:95]
    v_mfma_f32_32x32x16_bf16 a[96:111], v[36:39], v[72:75], a[96:111]
    v_mfma_f32_32x32x16_bf16 a[112:127], v[36:39], v[76:79], a[112:127]
    v_mfma_f32_32x32x16_bf16 a[128:143], v[40:43], v[64:67], a[128:143]
    v_mfma_f32_32x32x16_bf16 a[144:159], v[40:43], v[68:71], a[144:159]
    v_mfma_f32_32x32x16_bf16 a[160:175], v[40:43], v[72:75], a[160:175]
    v_mfma_f32_32x32x16_bf16 a[176:191], v[40:43], v[76:79], a[176:191]
    v_mfma_f32_32x32x16_bf16 a[192:207], v[44:47], v[64:67], a[192:207]
    v_mfma_f32_32x32x16_bf16 a[208:223], v[44:47], v[68:71], a[208:223]
    v_mfma_f32_32x32x16_bf16 a[224:239], v[44:47], v[72:75], a[224:239]
    v_mfma_f32_32x32x16_bf16 a[240:255], v[44:47], v[76:79], a[240:255]
    ds_read_b128 v[32:35], v14 offset:3072
    ds_read_b128 v[36:39], v14 offset:7168
    ds_read_b128 v[40:43], v14 offset:11264
    ds_read_b128 v[44:47], v14 offset:15360
    ds_read_b128 v[64:67], v15 offset:3072
    ds_read_b128 v[68:71], v15 offset:7168
    ds_read_b128 v[72:75], v15 offset:11264
    ds_read_b128 v[76:79], v15 offset:15360
    s_waitcnt lgkmcnt(8)
    v_mfma_f32_32x32x16_bf16 a[0:15], v[16:19], v[48:51], a[0:15]
    v_mfma_f32_32x32x16_bf16 a[16:31], v[16:19], v[52:55], a[16:31]
    v_mfma_f32_32x32x16_bf16 a[32:47], v[16:19], v[56:59], a[32:47]
    v_mfma_f32_32x32x16_bf16 a[48:63], v[16:19], v[60:63], a[48:63]
    v_mfma_f32_32x32x16_bf16 a[64:79], v[20:23], v[48:51], a[64:79]
    v_mfma_f32_32x32x16_bf16 a[80:95], v[20:23], v[52:55], a[80:95]
    v_mfma_f32_32x32x16_bf16 a[96:111], v[20:23], v[56:59], a[96:111]
    v_mfma_f32_32x32x16_bf16 a[112:127], v[20:23], v[60:63], a[112:127]
    v_mfma_f32_32x32x16_bf16 a[128:143], v[24:27], v[48:51], a[128:143]
    v_mfma_f32_32x32x16_bf16 a[144:159], v[24:27], v[52:55], a[144:159]
    v_mfma_f32_32x32x16_bf16 a[160:175], v[24:27], v[56:59], a[160:175]
    v_mfma_f32_32x32x16_bf16 a[176:191], v[24:27], v[60:63], a[176:191]
    v_mfma_f32_32x32x16_bf16 a[192:207], v[28:31], v[48:51], a[192:207]
    v_mfma_f32_32x32x16_bf16 a[208:223], v[28:31], v[52:55], a[208:223]
    v_mfma_f32_32x32x16_bf16 a[224:239], v[28:31], v[56:59], a[224:239]
    v_mfma_f32_32x32x16_bf16 a[240:255], v[28:31], v[60:63], a[240:255]
    s_waitcnt lgkmcnt(0)
    v_mfma_f32_32x32x16_bf16 a[0:15], v[32:35], v[64:67], a[0:15]
    v_mfma_f32_32x32x16_bf16 a[16:31], v[32:35], v[68:71], a[16:31]
    v_mfma_f32_32x32x16_bf16 a[32:47], v[32:35], v[72:75], a[32:47]
    v_mfma_f32_32x32x16_bf16 a[48:63], v[32:35], v[76:79], a[48:63]
    v_mfma_f32_32x32x16_bf16 a[64:79], v[36:39], v[64:67], a[64:79]
    v_mfma_f32_32x32x16_bf16 a[80:95], v[36:39], v[68:71], a[80:95]
    v_mfma_f32_32x32x16_bf16 a[96:111], v[36:39], v[72:75], a[96:111]
    v_mfma_f32_32x32x16_bf16 a[112:127], v[36:39], v[76:79], a[112:127]
    v_mfma_f32_32x32x16_bf16 a[128:143], v[40:43], v[64:67], a[128:143]
    v_mfma_f32_32x32x16_bf16 a[144:159], v[40:43], v[68:71], a[144:159]
    v_mfma_f32_32x32x16_bf16 a[160:175], v[40:43], v[72:75], a[160:175]
    v_mfma_f32_32x32x16_bf16 a[176:191], v[40:43], v[76:79], a[176:191]
    v_mfma_f32_32x32x16_bf16 a[192:207], v[44:47], v[64:67], a[192:207]
    v_mfma_f32_32x32x16_bf16 a[208:223], v[44:47], v[68:71], a[208:223]
    v_mfma_f32_32x32x16_bf16 a[224:239], v[44:47], v[72:75], a[224:239]
    v_mfma_f32_32x32x16_bf16 a[240:255], v[44:47], v[76:79], a[240:255]
    s_waitcnt vmcnt(0)
    s_barrier
    ds_read_b128 v[16:19], v12 offset:0
    ds_read_b128 v[20:23], v12 offset:4096
    ds_read_b128 v[24:27], v12 offset:8192
    ds_read_b128 v[28:31], v12 offset:12288
    ds_read_b128 v[48:51], v13 offset:0
    ds_read_b128 v[52:55], v13 offset:4096
    ds_read_b128 v[56:59], v13 offset:8192
    ds_read_b128 v[60:63], v13 offset:12288
    s_add_u32 m0, s64, 65536
    s_add_u32 s60, s62, 12288
    buffer_load_dwordx4 v4, s[36:39], s60 offen offset:0 lds
    buffer_load_dwordx4 v4, s[36:39], s60 offen offset:1024 lds
    buffer_load_dwordx4 v4, s[36:39], s60 offen offset:2048 lds
    buffer_load_dwordx4 v4, s[36:39], s60 offen offset:3072 lds
    s_add_u32 m0, s64, 69632
    s_add_u32 s60, s62, 40960
    buffer_load_dwordx4 v4, s[36:39], s60 offen offset:0 lds
    buffer_load_dwordx4 v4, s[36:39], s60 offen offset:1024 lds
    buffer_load_dwordx4 v4, s[36:39], s60 offen offset:2048 lds
    buffer_load_dwordx4 v4, s[36:39], s60 offen offset:3072 lds
    s_add_u32 m0, s65, 65536
    s_add_u32 s60, s63, 12288
    buffer_load_dwordx4 v4, s[36:39], s60 offen offset:0 lds
    buffer_load_dwordx4 v4, s[36:39], s60 offen offset:1024 lds
    buffer_load_dwordx4 v4, s[36:39], s60 offen offset:2048 lds
    buffer_load_dwordx4 v4, s[36:39], s60 offen offset:3072 lds
    s_add_u32 m0, s65, 69632
    s_add_u32 s60, s63, 40960
    buffer_load_dwordx4 v4, s[36:39], s60 offen offset:0 lds
    buffer_load_dwordx4 v4, s[36:39], s60 offen offset:1024 lds
    buffer_load_dwordx4 v4, s[36:39], s60 offen offset:2048 lds
    buffer_load_dwordx4 v4, s[36:39], s60 offen offset:3072 lds
    ds_read_b128 v[32:35], v12 offset:1024
    ds_read_b128 v[36:39], v12 offset:5120
    ds_read_b128 v[40:43], v12 offset:9216
    ds_read_b128 v[44:47], v12 offset:13312
    ds_read_b128 v[64:67], v13 offset:1024
    ds_read_b128 v[68:71], v13 offset:5120
    ds_read_b128 v[72:75], v13 offset:9216
    ds_read_b128 v[76:79], v13 offset:13312
    s_waitcnt lgkmcnt(8)
    v_mfma_f32_32x32x16_bf16 a[0:15], v[16:19], v[48:51], a[0:15]
    v_mfma_f32_32x32x16_bf16 a[16:31], v[16:19], v[52:55], a[16:31]
    v_mfma_f32_32x32x16_bf16 a[32:47], v[16:19], v[56:59], a[32:47]
    v_mfma_f32_32x32x16_bf16 a[48:63], v[16:19], v[60:63], a[48:63]
    v_mfma_f32_32x32x16_bf16 a[64:79], v[20:23], v[48:51], a[64:79]
    v_mfma_f32_32x32x16_bf16 a[80:95], v[20:23], v[52:55], a[80:95]
    v_mfma_f32_32x32x16_bf16 a[96:111], v[20:23], v[56:59], a[96:111]
    v_mfma_f32_32x32x16_bf16 a[112:127], v[20:23], v[60:63], a[112:127]
    v_mfma_f32_32x32x16_bf16 a[128:143], v[24:27], v[48:51], a[128:143]
    v_mfma_f32_32x32x16_bf16 a[144:159], v[24:27], v[52:55], a[144:159]
    v_mfma_f32_32x32x16_bf16 a[160:175], v[24:27], v[56:59], a[160:175]
    v_mfma_f32_32x32x16_bf16 a[176:191], v[24:27], v[60:63], a[176:191]
    v_mfma_f32_32x32x16_bf16 a[192:207], v[28:31], v[48:51], a[192:207]
    v_mfma_f32_32x32x16_bf16 a[208:223], v[28:31], v[52:55], a[208:223]
    v_mfma_f32_32x32x16_bf16 a[224:239], v[28:31], v[56:59], a[224:239]
    v_mfma_f32_32x32x16_bf16 a[240:255], v[28:31], v[60:63], a[240:255]
    ds_read_b128 v[16:19], v12 offset:2048
    ds_read_b128 v[20:23], v12 offset:6144
    ds_read_b128 v[24:27], v12 offset:10240
    ds_read_b128 v[28:31], v12 offset:14336
    ds_read_b128 v[48:51], v13 offset:2048
    ds_read_b128 v[52:55], v13 offset:6144
    ds_read_b128 v[56:59], v13 offset:10240
    ds_read_b128 v[60:63], v13 offset:14336
    s_waitcnt lgkmcnt(8)
    v_mfma_f32_32x32x16_bf16 a[0:15], v[32:35], v[64:67], a[0:15]
    v_mfma_f32_32x32x16_bf16 a[16:31], v[32:35], v[68:71], a[16:31]
    v_mfma_f32_32x32x16_bf16 a[32:47], v[32:35], v[72:75], a[32:47]
    v_mfma_f32_32x32x16_bf16 a[48:63], v[32:35], v[76:79], a[48:63]
    v_mfma_f32_32x32x16_bf16 a[64:79], v[36:39], v[64:67], a[64:79]
    v_mfma_f32_32x32x16_bf16 a[80:95], v[36:39], v[68:71], a[80:95]
    v_mfma_f32_32x32x16_bf16 a[96:111], v[36:39], v[72:75], a[96:111]
    v_mfma_f32_32x32x16_bf16 a[112:127], v[36:39], v[76:79], a[112:127]
    v_mfma_f32_32x32x16_bf16 a[128:143], v[40:43], v[64:67], a[128:143]
    v_mfma_f32_32x32x16_bf16 a[144:159], v[40:43], v[68:71], a[144:159]
    v_mfma_f32_32x32x16_bf16 a[160:175], v[40:43], v[72:75], a[160:175]
    v_mfma_f32_32x32x16_bf16 a[176:191], v[40:43], v[76:79], a[176:191]
    v_mfma_f32_32x32x16_bf16 a[192:207], v[44:47], v[64:67], a[192:207]
    v_mfma_f32_32x32x16_bf16 a[208:223], v[44:47], v[68:71], a[208:223]
    v_mfma_f32_32x32x16_bf16 a[224:239], v[44:47], v[72:75], a[224:239]
    v_mfma_f32_32x32x16_bf16 a[240:255], v[44:47], v[76:79], a[240:255]
    ds_read_b128 v[32:35], v12 offset:3072
    ds_read_b128 v[36:39], v12 offset:7168
    ds_read_b128 v[40:43], v12 offset:11264
    ds_read_b128 v[44:47], v12 offset:15360
    ds_read_b128 v[64:67], v13 offset:3072
    ds_read_b128 v[68:71], v13 offset:7168
    ds_read_b128 v[72:75], v13 offset:11264
    ds_read_b128 v[76:79], v13 offset:15360
    s_waitcnt lgkmcnt(8)
    v_mfma_f32_32x32x16_bf16 a[0:15], v[16:19], v[48:51], a[0:15]
    v_mfma_f32_32x32x16_bf16 a[16:31], v[16:19], v[52:55], a[16:31]
    v_mfma_f32_32x32x16_bf16 a[32:47], v[16:19], v[56:59], a[32:47]
    v_mfma_f32_32x32x16_bf16 a[48:63], v[16:19], v[60:63], a[48:63]
    v_mfma_f32_32x32x16_bf16 a[64:79], v[20:23], v[48:51], a[64:79]
    v_mfma_f32_32x32x16_bf16 a[80:95], v[20:23], v[52:55], a[80:95]
    v_mfma_f32_32x32x16_bf16 a[96:111], v[20:23], v[56:59], a[96:111]
    v_mfma_f32_32x32x16_bf16 a[112:127], v[20:23], v[60:63], a[112:127]
    v_mfma_f32_32x32x16_bf16 a[128:143], v[24:27], v[48:51], a[128:143]
    v_mfma_f32_32x32x16_bf16 a[144:159], v[24:27], v[52:55], a[144:159]
    v_mfma_f32_32x32x16_bf16 a[160:175], v[24:27], v[56:59], a[160:175]
    v_mfma_f32_32x32x16_bf16 a[176:191], v[24:27], v[60:63], a[176:191]
    v_mfma_f32_32x32x16_bf16 a[192:207], v[28:31], v[48:51], a[192:207]
    v_mfma_f32_32x32x16_bf16 a[208:223], v[28:31], v[52:55], a[208:223]
    v_mfma_f32_32x32x16_bf16 a[224:239], v[28:31], v[56:59], a[224:239]
    v_mfma_f32_32x32x16_bf16 a[240:255], v[28:31], v[60:63], a[240:255]
    s_waitcnt lgkmcnt(0)
    v_mfma_f32_32x32x16_bf16 a[0:15], v[32:35], v[64:67], a[0:15]
    v_mfma_f32_32x32x16_bf16 a[16:31], v[32:35], v[68:71], a[16:31]
    v_mfma_f32_32x32x16_bf16 a[32:47], v[32:35], v[72:75], a[32:47]
    v_mfma_f32_32x32x16_bf16 a[48:63], v[32:35], v[76:79], a[48:63]
    v_mfma_f32_32x32x16_bf16 a[64:79], v[36:39], v[64:67], a[64:79]
    v_mfma_f32_32x32x16_bf16 a[80:95], v[36:39], v[68:71], a[80:95]
    v_mfma_f32_32x32x16_bf16 a[96:111], v[36:39], v[72:75], a[96:111]
    v_mfma_f32_32x32x16_bf16 a[112:127], v[36:39], v[76:79], a[112:127]
    v_mfma_f32_32x32x16_bf16 a[128:143], v[40:43], v[64:67], a[128:143]
    v_mfma_f32_32x32x16_bf16 a[144:159], v[40:43], v[68:71], a[144:159]
    v_mfma_f32_32x32x16_bf16 a[160:175], v[40:43], v[72:75], a[160:175]
    v_mfma_f32_32x32x16_bf16 a[176:191], v[40:43], v[76:79], a[176:191]
    v_mfma_f32_32x32x16_bf16 a[192:207], v[44:47], v[64:67], a[192:207]
    v_mfma_f32_32x32x16_bf16 a[208:223], v[44:47], v[68:71], a[208:223]
    v_mfma_f32_32x32x16_bf16 a[224:239], v[44:47], v[72:75], a[224:239]
    v_mfma_f32_32x32x16_bf16 a[240:255], v[44:47], v[76:79], a[240:255]
    s_waitcnt vmcnt(0)
    s_barrier
    ds_read_b128 v[16:19], v14 offset:0
    ds_read_b128 v[20:23], v14 offset:4096
    ds_read_b128 v[24:27], v14 offset:8192
    ds_read_b128 v[28:31], v14 offset:12288
    ds_read_b128 v[48:51], v15 offset:0
    ds_read_b128 v[52:55], v15 offset:4096
    ds_read_b128 v[56:59], v15 offset:8192
    ds_read_b128 v[60:63], v15 offset:12288
    s_add_u32 m0, s64, 0
    s_add_u32 s60, s62, 16384
    buffer_load_dwordx4 v4, s[36:39], s60 offen offset:0 lds
    buffer_load_dwordx4 v4, s[36:39], s60 offen offset:1024 lds
    buffer_load_dwordx4 v4, s[36:39], s60 offen offset:2048 lds
    buffer_load_dwordx4 v4, s[36:39], s60 offen offset:3072 lds
    s_add_u32 m0, s64, 4096
    s_add_u32 s60, s62, 45056
    buffer_load_dwordx4 v4, s[36:39], s60 offen offset:0 lds
    buffer_load_dwordx4 v4, s[36:39], s60 offen offset:1024 lds
    buffer_load_dwordx4 v4, s[36:39], s60 offen offset:2048 lds
    buffer_load_dwordx4 v4, s[36:39], s60 offen offset:3072 lds
    s_add_u32 m0, s65, 0
    s_add_u32 s60, s63, 16384
    buffer_load_dwordx4 v4, s[36:39], s60 offen offset:0 lds
    buffer_load_dwordx4 v4, s[36:39], s60 offen offset:1024 lds
    buffer_load_dwordx4 v4, s[36:39], s60 offen offset:2048 lds
    buffer_load_dwordx4 v4, s[36:39], s60 offen offset:3072 lds
    s_add_u32 m0, s65, 4096
    s_add_u32 s60, s63, 45056
    buffer_load_dwordx4 v4, s[36:39], s60 offen offset:0 lds
    buffer_load_dwordx4 v4, s[36:39], s60 offen offset:1024 lds
    buffer_load_dwordx4 v4, s[36:39], s60 offen offset:2048 lds
    buffer_load_dwordx4 v4, s[36:39], s60 offen offset:3072 lds
    ds_read_b128 v[32:35], v14 offset:1024
    ds_read_b128 v[36:39], v14 offset:5120
    ds_read_b128 v[40:43], v14 offset:9216
    ds_read_b128 v[44:47], v14 offset:13312
    ds_read_b128 v[64:67], v15 offset:1024
    ds_read_b128 v[68:71], v15 offset:5120
    ds_read_b128 v[72:75], v15 offset:9216
    ds_read_b128 v[76:79], v15 offset:13312
    s_waitcnt lgkmcnt(8)
    v_mfma_f32_32x32x16_bf16 a[0:15], v[16:19], v[48:51], a[0:15]
    v_mfma_f32_32x32x16_bf16 a[16:31], v[16:19], v[52:55], a[16:31]
    v_mfma_f32_32x32x16_bf16 a[32:47], v[16:19], v[56:59], a[32:47]
    v_mfma_f32_32x32x16_bf16 a[48:63], v[16:19], v[60:63], a[48:63]
    v_mfma_f32_32x32x16_bf16 a[64:79], v[20:23], v[48:51], a[64:79]
    v_mfma_f32_32x32x16_bf16 a[80:95], v[20:23], v[52:55], a[80:95]
    v_mfma_f32_32x32x16_bf16 a[96:111], v[20:23], v[56:59], a[96:111]
    v_mfma_f32_32x32x16_bf16 a[112:127], v[20:23], v[60:63], a[112:127]
    v_mfma_f32_32x32x16_bf16 a[128:143], v[24:27], v[48:51], a[128:143]
    v_mfma_f32_32x32x16_bf16 a[144:159], v[24:27], v[52:55], a[144:159]
    v_mfma_f32_32x32x16_bf16 a[160:175], v[24:27], v[56:59], a[160:175]
    v_mfma_f32_32x32x16_bf16 a[176:191], v[24:27], v[60:63], a[176:191]
    v_mfma_f32_32x32x16_bf16 a[192:207], v[28:31], v[48:51], a[192:207]
    v_mfma_f32_32x32x16_bf16 a[208:223], v[28:31], v[52:55], a[208:223]
    v_mfma_f32_32x32x16_bf16 a[224:239], v[28:31], v[56:59], a[224:239]
    v_mfma_f32_32x32x16_bf16 a[240:255], v[28:31], v[60:63], a[240:255]
    ds_read_b128 v[16:19], v14 offset:2048
    ds_read_b128 v[20:23], v14 offset:6144
    ds_read_b128 v[24:27], v14 offset:10240
    ds_read_b128 v[28:31], v14 offset:14336
    ds_read_b128 v[48:51], v15 offset:2048
    ds_read_b128 v[52:55], v15 offset:6144
    ds_read_b128 v[56:59], v15 offset:10240
    ds_read_b128 v[60:63], v15 offset:14336
    s_waitcnt lgkmcnt(8)
    v_mfma_f32_32x32x16_bf16 a[0:15], v[32:35], v[64:67], a[0:15]
    v_mfma_f32_32x32x16_bf16 a[16:31], v[32:35], v[68:71], a[16:31]
    v_mfma_f32_32x32x16_bf16 a[32:47], v[32:35], v[72:75], a[32:47]
    v_mfma_f32_32x32x16_bf16 a[48:63], v[32:35], v[76:79], a[48:63]
    v_mfma_f32_32x32x16_bf16 a[64:79], v[36:39], v[64:67], a[64:79]
    v_mfma_f32_32x32x16_bf16 a[80:95], v[36:39], v[68:71], a[80:95]
    v_mfma_f32_32x32x16_bf16 a[96:111], v[36:39], v[72:75], a[96:111]
    v_mfma_f32_32x32x16_bf16 a[112:127], v[36:39], v[76:79], a[112:127]
    v_mfma_f32_32x32x16_bf16 a[128:143], v[40:43], v[64:67], a[128:143]
    v_mfma_f32_32x32x16_bf16 a[144:159], v[40:43], v[68:71], a[144:159]
    v_mfma_f32_32x32x16_bf16 a[160:175], v[40:43], v[72:75], a[160:175]
    v_mfma_f32_32x32x16_bf16 a[176:191], v[40:43], v[76:79], a[176:191]
    v_mfma_f32_32x32x16_bf16 a[192:207], v[44:47], v[64:67], a[192:207]
    v_mfma_f32_32x32x16_bf16 a[208:223], v[44:47], v[68:71], a[208:223]
    v_mfma_f32_32x32x16_bf16 a[224:239], v[44:47], v[72:75], a[224:239]
    v_mfma_f32_32x32x16_bf16 a[240:255], v[44:47], v[76:79], a[240:255]
    ds_read_b128 v[32:35], v14 offset:3072
    ds_read_b128 v[36:39], v14 offset:7168
    ds_read_b128 v[40:43], v14 offset:11264
    ds_read_b128 v[44:47], v14 offset:15360
    ds_read_b128 v[64:67], v15 offset:3072
    ds_read_b128 v[68:71], v15 offset:7168
    ds_read_b128 v[72:75], v15 offset:11264
    ds_read_b128 v[76:79], v15 offset:15360
    s_waitcnt lgkmcnt(8)
    v_mfma_f32_32x32x16_bf16 a[0:15], v[16:19], v[48:51], a[0:15]
    v_mfma_f32_32x32x16_bf16 a[16:31], v[16:19], v[52:55], a[16:31]
    v_mfma_f32_32x32x16_bf16 a[32:47], v[16:19], v[56:59], a[32:47]
    v_mfma_f32_32x32x16_bf16 a[48:63], v[16:19], v[60:63], a[48:63]
    v_mfma_f32_32x32x16_bf16 a[64:79], v[20:23], v[48:51], a[64:79]
    v_mfma_f32_32x32x16_bf16 a[80:95], v[20:23], v[52:55], a[80:95]
    v_mfma_f32_32x32x16_bf16 a[96:111], v[20:23], v[56:59], a[96:111]
    v_mfma_f32_32x32x16_bf16 a[112:127], v[20:23], v[60:63], a[112:127]
    v_mfma_f32_32x32x16_bf16 a[128:143], v[24:27], v[48:51], a[128:143]
    v_mfma_f32_32x32x16_bf16 a[144:159], v[24:27], v[52:55], a[144:159]
    v_mfma_f32_32x32x16_bf16 a[160:175], v[24:27], v[56:59], a[160:175]
    v_mfma_f32_32x32x16_bf16 a[176:191], v[24:27], v[60:63], a[176:191]
    v_mfma_f32_32x32x16_bf16 a[192:207], v[28:31], v[48:51], a[192:207]
    v_mfma_f32_32x32x16_bf16 a[208:223], v[28:31], v[52:55], a[208:223]
    v_mfma_f32_32x32x16_bf16 a[224:239], v[28:31], v[56:59], a[224:239]
    v_mfma_f32_32x32x16_bf16 a[240:255], v[28:31], v[60:63], a[240:255]
    s_waitcnt lgkmcnt(0)
    v_mfma_f32_32x32x16_bf16 a[0:15], v[32:35], v[64:67], a[0:15]
    v_mfma_f32_32x32x16_bf16 a[16:31], v[32:35], v[68:71], a[16:31]
    v_mfma_f32_32x32x16_bf16 a[32:47], v[32:35], v[72:75], a[32:47]
    v_mfma_f32_32x32x16_bf16 a[48:63], v[32:35], v[76:79], a[48:63]
    v_mfma_f32_32x32x16_bf16 a[64:79], v[36:39], v[64:67], a[64:79]
    v_mfma_f32_32x32x16_bf16 a[80:95], v[36:39], v[68:71], a[80:95]
    v_mfma_f32_32x32x16_bf16 a[96:111], v[36:39], v[72:75], a[96:111]
    v_mfma_f32_32x32x16_bf16 a[112:127], v[36:39], v[76:79], a[112:127]
    v_mfma_f32_32x32x16_bf16 a[128:143], v[40:43], v[64:67], a[128:143]
    v_mfma_f32_32x32x16_bf16 a[144:159], v[40:43], v[68:71], a[144:159]
    v_mfma_f32_32x32x16_bf16 a[160:175], v[40:43], v[72:75], a[160:175]
    v_mfma_f32_32x32x16_bf16 a[176:191], v[40:43], v[76:79], a[176:191]
    v_mfma_f32_32x32x16_bf16 a[192:207], v[44:47], v[64:67], a[192:207]
    v_mfma_f32_32x32x16_bf16 a[208:223], v[44:47], v[68:71], a[208:223]
    v_mfma_f32_32x32x16_bf16 a[224:239], v[44:47], v[72:75], a[224:239]
    v_mfma_f32_32x32x16_bf16 a[240:255], v[44:47], v[76:79], a[240:255]
    s_waitcnt vmcnt(0)
    s_barrier
    ds_read_b128 v[16:19], v12 offset:0
    ds_read_b128 v[20:23], v12 offset:4096
    ds_read_b128 v[24:27], v12 offset:8192
    ds_read_b128 v[28:31], v12 offset:12288
    ds_read_b128 v[48:51], v13 offset:0
    ds_read_b128 v[52:55], v13 offset:4096
    ds_read_b128 v[56:59], v13 offset:8192
    ds_read_b128 v[60:63], v13 offset:12288
    s_add_u32 m0, s64, 65536
    s_add_u32 s60, s62, 20480
    buffer_load_dwordx4 v4, s[36:39], s60 offen offset:0 lds
    buffer_load_dwordx4 v4, s[36:39], s60 offen offset:1024 lds
    buffer_load_dwordx4 v4, s[36:39], s60 offen offset:2048 lds
    buffer_load_dwordx4 v4, s[36:39], s60 offen offset:3072 lds
    s_add_u32 m0, s64, 69632
    s_add_u32 s60, s62, 49152
    buffer_load_dwordx4 v4, s[36:39], s60 offen offset:0 lds
    buffer_load_dwordx4 v4, s[36:39], s60 offen offset:1024 lds
    buffer_load_dwordx4 v4, s[36:39], s60 offen offset:2048 lds
    buffer_load_dwordx4 v4, s[36:39], s60 offen offset:3072 lds
    s_add_u32 m0, s65, 65536
    s_add_u32 s60, s63, 20480
    buffer_load_dwordx4 v4, s[36:39], s60 offen offset:0 lds
    buffer_load_dwordx4 v4, s[36:39], s60 offen offset:1024 lds
    buffer_load_dwordx4 v4, s[36:39], s60 offen offset:2048 lds
    buffer_load_dwordx4 v4, s[36:39], s60 offen offset:3072 lds
    s_add_u32 m0, s65, 69632
    s_add_u32 s60, s63, 49152
    buffer_load_dwordx4 v4, s[36:39], s60 offen offset:0 lds
    buffer_load_dwordx4 v4, s[36:39], s60 offen offset:1024 lds
    buffer_load_dwordx4 v4, s[36:39], s60 offen offset:2048 lds
    buffer_load_dwordx4 v4, s[36:39], s60 offen offset:3072 lds
    ds_read_b128 v[32:35], v12 offset:1024
    ds_read_b128 v[36:39], v12 offset:5120
    ds_read_b128 v[40:43], v12 offset:9216
    ds_read_b128 v[44:47], v12 offset:13312
    ds_read_b128 v[64:67], v13 offset:1024
    ds_read_b128 v[68:71], v13 offset:5120
    ds_read_b128 v[72:75], v13 offset:9216
    ds_read_b128 v[76:79], v13 offset:13312
    s_waitcnt lgkmcnt(8)
    v_mfma_f32_32x32x16_bf16 a[0:15], v[16:19], v[48:51], a[0:15]
    v_mfma_f32_32x32x16_bf16 a[16:31], v[16:19], v[52:55], a[16:31]
    v_mfma_f32_32x32x16_bf16 a[32:47], v[16:19], v[56:59], a[32:47]
    v_mfma_f32_32x32x16_bf16 a[48:63], v[16:19], v[60:63], a[48:63]
    v_mfma_f32_32x32x16_bf16 a[64:79], v[20:23], v[48:51], a[64:79]
    v_mfma_f32_32x32x16_bf16 a[80:95], v[20:23], v[52:55], a[80:95]
    v_mfma_f32_32x32x16_bf16 a[96:111], v[20:23], v[56:59], a[96:111]
    v_mfma_f32_32x32x16_bf16 a[112:127], v[20:23], v[60:63], a[112:127]
    v_mfma_f32_32x32x16_bf16 a[128:143], v[24:27], v[48:51], a[128:143]
    v_mfma_f32_32x32x16_bf16 a[144:159], v[24:27], v[52:55], a[144:159]
    v_mfma_f32_32x32x16_bf16 a[160:175], v[24:27], v[56:59], a[160:175]
    v_mfma_f32_32x32x16_bf16 a[176:191], v[24:27], v[60:63], a[176:191]
    v_mfma_f32_32x32x16_bf16 a[192:207], v[28:31], v[48:51], a[192:207]
    v_mfma_f32_32x32x16_bf16 a[208:223], v[28:31], v[52:55], a[208:223]
    v_mfma_f32_32x32x16_bf16 a[224:239], v[28:31], v[56:59], a[224:239]
    v_mfma_f32_32x32x16_bf16 a[240:255], v[28:31], v[60:63], a[240:255]
    ds_read_b128 v[16:19], v12 offset:2048
    ds_read_b128 v[20:23], v12 offset:6144
    ds_read_b128 v[24:27], v12 offset:10240
    ds_read_b128 v[28:31], v12 offset:14336
    ds_read_b128 v[48:51], v13 offset:2048
    ds_read_b128 v[52:55], v13 offset:6144
    ds_read_b128 v[56:59], v13 offset:10240
    ds_read_b128 v[60:63], v13 offset:14336
    s_waitcnt lgkmcnt(8)
    v_mfma_f32_32x32x16_bf16 a[0:15], v[32:35], v[64:67], a[0:15]
    v_mfma_f32_32x32x16_bf16 a[16:31], v[32:35], v[68:71], a[16:31]
    v_mfma_f32_32x32x16_bf16 a[32:47], v[32:35], v[72:75], a[32:47]
    v_mfma_f32_32x32x16_bf16 a[48:63], v[32:35], v[76:79], a[48:63]
    v_mfma_f32_32x32x16_bf16 a[64:79], v[36:39], v[64:67], a[64:79]
    v_mfma_f32_32x32x16_bf16 a[80:95], v[36:39], v[68:71], a[80:95]
    v_mfma_f32_32x32x16_bf16 a[96:111], v[36:39], v[72:75], a[96:111]
    v_mfma_f32_32x32x16_bf16 a[112:127], v[36:39], v[76:79], a[112:127]
    v_mfma_f32_32x32x16_bf16 a[128:143], v[40:43], v[64:67], a[128:143]
    v_mfma_f32_32x32x16_bf16 a[144:159], v[40:43], v[68:71], a[144:159]
    v_mfma_f32_32x32x16_bf16 a[160:175], v[40:43], v[72:75], a[160:175]
    v_mfma_f32_32x32x16_bf16 a[176:191], v[40:43], v[76:79], a[176:191]
    v_mfma_f32_32x32x16_bf16 a[192:207], v[44:47], v[64:67], a[192:207]
    v_mfma_f32_32x32x16_bf16 a[208:223], v[44:47], v[68:71], a[208:223]
    v_mfma_f32_32x32x16_bf16 a[224:239], v[44:47], v[72:75], a[224:239]
    v_mfma_f32_32x32x16_bf16 a[240:255], v[44:47], v[76:79], a[240:255]
    ds_read_b128 v[32:35], v12 offset:3072
    ds_read_b128 v[36:39], v12 offset:7168
    ds_read_b128 v[40:43], v12 offset:11264
    ds_read_b128 v[44:47], v12 offset:15360
    ds_read_b128 v[64:67], v13 offset:3072
    ds_read_b128 v[68:71], v13 offset:7168
    ds_read_b128 v[72:75], v13 offset:11264
    ds_read_b128 v[76:79], v13 offset:15360
    s_waitcnt lgkmcnt(8)
    v_mfma_f32_32x32x16_bf16 a[0:15], v[16:19], v[48:51], a[0:15]
    v_mfma_f32_32x32x16_bf16 a[16:31], v[16:19], v[52:55], a[16:31]
    v_mfma_f32_32x32x16_bf16 a[32:47], v[16:19], v[56:59], a[32:47]
    v_mfma_f32_32x32x16_bf16 a[48:63], v[16:19], v[60:63], a[48:63]
    v_mfma_f32_32x32x16_bf16 a[64:79], v[20:23], v[48:51], a[64:79]
    v_mfma_f32_32x32x16_bf16 a[80:95], v[20:23], v[52:55], a[80:95]
    v_mfma_f32_32x32x16_bf16 a[96:111], v[20:23], v[56:59], a[96:111]
    v_mfma_f32_32x32x16_bf16 a[112:127], v[20:23], v[60:63], a[112:127]
    v_mfma_f32_32x32x16_bf16 a[128:143], v[24:27], v[48:51], a[128:143]
    v_mfma_f32_32x32x16_bf16 a[144:159], v[24:27], v[52:55], a[144:159]
    v_mfma_f32_32x32x16_bf16 a[160:175], v[24:27], v[56:59], a[160:175]
    v_mfma_f32_32x32x16_bf16 a[176:191], v[24:27], v[60:63], a[176:191]
    v_mfma_f32_32x32x16_bf16 a[192:207], v[28:31], v[48:51], a[192:207]
    v_mfma_f32_32x32x16_bf16 a[208:223], v[28:31], v[52:55], a[208:223]
    v_mfma_f32_32x32x16_bf16 a[224:239], v[28:31], v[56:59], a[224:239]
    v_mfma_f32_32x32x16_bf16 a[240:255], v[28:31], v[60:63], a[240:255]
    s_waitcnt lgkmcnt(0)
    v_mfma_f32_32x32x16_bf16 a[0:15], v[32:35], v[64:67], a[0:15]
    v_mfma_f32_32x32x16_bf16 a[16:31], v[32:35], v[68:71], a[16:31]
    v_mfma_f32_32x32x16_bf16 a[32:47], v[32:35], v[72:75], a[32:47]
    v_mfma_f32_32x32x16_bf16 a[48:63], v[32:35], v[76:79], a[48:63]
    v_mfma_f32_32x32x16_bf16 a[64:79], v[36:39], v[64:67], a[64:79]
    v_mfma_f32_32x32x16_bf16 a[80:95], v[36:39], v[68:71], a[80:95]
    v_mfma_f32_32x32x16_bf16 a[96:111], v[36:39], v[72:75], a[96:111]
    v_mfma_f32_32x32x16_bf16 a[112:127], v[36:39], v[76:79], a[112:127]
    v_mfma_f32_32x32x16_bf16 a[128:143], v[40:43], v[64:67], a[128:143]
    v_mfma_f32_32x32x16_bf16 a[144:159], v[40:43], v[68:71], a[144:159]
    v_mfma_f32_32x32x16_bf16 a[160:175], v[40:43], v[72:75], a[160:175]
    v_mfma_f32_32x32x16_bf16 a[176:191], v[40:43], v[76:79], a[176:191]
    v_mfma_f32_32x32x16_bf16 a[192:207], v[44:47], v[64:67], a[192:207]
    v_mfma_f32_32x32x16_bf16 a[208:223], v[44:47], v[68:71], a[208:223]
    v_mfma_f32_32x32x16_bf16 a[224:239], v[44:47], v[72:75], a[224:239]
    v_mfma_f32_32x32x16_bf16 a[240:255], v[44:47], v[76:79], a[240:255]
    s_waitcnt vmcnt(0)
    s_barrier
    ds_read_b128 v[16:19], v14 offset:0
    ds_read_b128 v[20:23], v14 offset:4096
    ds_read_b128 v[24:27], v14 offset:8192
    ds_read_b128 v[28:31], v14 offset:12288
    ds_read_b128 v[48:51], v15 offset:0
    ds_read_b128 v[52:55], v15 offset:4096
    ds_read_b128 v[56:59], v15 offset:8192
    ds_read_b128 v[60:63], v15 offset:12288
    s_add_u32 m0, s64, 0
    s_add_u32 s60, s62, 24576
    buffer_load_dwordx4 v4, s[36:39], s60 offen offset:0 lds
    buffer_load_dwordx4 v4, s[36:39], s60 offen offset:1024 lds
    buffer_load_dwordx4 v4, s[36:39], s60 offen offset:2048 lds
    buffer_load_dwordx4 v4, s[36:39], s60 offen offset:3072 lds
    s_add_u32 m0, s64, 4096
    s_add_u32 s60, s62, 53248
    buffer_load_dwordx4 v4, s[36:39], s60 offen offset:0 lds
    buffer_load_dwordx4 v4, s[36:39], s60 offen offset:1024 lds
    buffer_load_dwordx4 v4, s[36:39], s60 offen offset:2048 lds
    buffer_load_dwordx4 v4, s[36:39], s60 offen offset:3072 lds
    s_add_u32 m0, s65, 0
    s_add_u32 s60, s63, 24576
    buffer_load_dwordx4 v4, s[36:39], s60 offen offset:0 lds
    buffer_load_dwordx4 v4, s[36:39], s60 offen offset:1024 lds
    buffer_load_dwordx4 v4, s[36:39], s60 offen offset:2048 lds
    buffer_load_dwordx4 v4, s[36:39], s60 offen offset:3072 lds
    s_add_u32 m0, s65, 4096
    s_add_u32 s60, s63, 53248
    buffer_load_dwordx4 v4, s[36:39], s60 offen offset:0 lds
    buffer_load_dwordx4 v4, s[36:39], s60 offen offset:1024 lds
    buffer_load_dwordx4 v4, s[36:39], s60 offen offset:2048 lds
    buffer_load_dwordx4 v4, s[36:39], s60 offen offset:3072 lds
    ds_read_b128 v[32:35], v14 offset:1024
    ds_read_b128 v[36:39], v14 offset:5120
    ds_read_b128 v[40:43], v14 offset:9216
    ds_read_b128 v[44:47], v14 offset:13312
    ds_read_b128 v[64:67], v15 offset:1024
    ds_read_b128 v[68:71], v15 offset:5120
    ds_read_b128 v[72:75], v15 offset:9216
    ds_read_b128 v[76:79], v15 offset:13312
    s_waitcnt lgkmcnt(8)
    v_mfma_f32_32x32x16_bf16 a[0:15], v[16:19], v[48:51], a[0:15]
    v_mfma_f32_32x32x16_bf16 a[16:31], v[16:19], v[52:55], a[16:31]
    v_mfma_f32_32x32x16_bf16 a[32:47], v[16:19], v[56:59], a[32:47]
    v_mfma_f32_32x32x16_bf16 a[48:63], v[16:19], v[60:63], a[48:63]
    v_mfma_f32_32x32x16_bf16 a[64:79], v[20:23], v[48:51], a[64:79]
    v_mfma_f32_32x32x16_bf16 a[80:95], v[20:23], v[52:55], a[80:95]
    v_mfma_f32_32x32x16_bf16 a[96:111], v[20:23], v[56:59], a[96:111]
    v_mfma_f32_32x32x16_bf16 a[112:127], v[20:23], v[60:63], a[112:127]
    v_mfma_f32_32x32x16_bf16 a[128:143], v[24:27], v[48:51], a[128:143]
    v_mfma_f32_32x32x16_bf16 a[144:159], v[24:27], v[52:55], a[144:159]
    v_mfma_f32_32x32x16_bf16 a[160:175], v[24:27], v[56:59], a[160:175]
    v_mfma_f32_32x32x16_bf16 a[176:191], v[24:27], v[60:63], a[176:191]
    v_mfma_f32_32x32x16_bf16 a[192:207], v[28:31], v[48:51], a[192:207]
    v_mfma_f32_32x32x16_bf16 a[208:223], v[28:31], v[52:55], a[208:223]
    v_mfma_f32_32x32x16_bf16 a[224:239], v[28:31], v[56:59], a[224:239]
    v_mfma_f32_32x32x16_bf16 a[240:255], v[28:31], v[60:63], a[240:255]
    ds_read_b128 v[16:19], v14 offset:2048
    ds_read_b128 v[20:23], v14 offset:6144
    ds_read_b128 v[24:27], v14 offset:10240
    ds_read_b128 v[28:31], v14 offset:14336
    ds_read_b128 v[48:51], v15 offset:2048
    ds_read_b128 v[52:55], v15 offset:6144
    ds_read_b128 v[56:59], v15 offset:10240
    ds_read_b128 v[60:63], v15 offset:14336
    s_waitcnt lgkmcnt(8)
    v_mfma_f32_32x32x16_bf16 a[0:15], v[32:35], v[64:67], a[0:15]
    v_mfma_f32_32x32x16_bf16 a[16:31], v[32:35], v[68:71], a[16:31]
    v_mfma_f32_32x32x16_bf16 a[32:47], v[32:35], v[72:75], a[32:47]
    v_mfma_f32_32x32x16_bf16 a[48:63], v[32:35], v[76:79], a[48:63]
    v_mfma_f32_32x32x16_bf16 a[64:79], v[36:39], v[64:67], a[64:79]
    v_mfma_f32_32x32x16_bf16 a[80:95], v[36:39], v[68:71], a[80:95]
    v_mfma_f32_32x32x16_bf16 a[96:111], v[36:39], v[72:75], a[96:111]
    v_mfma_f32_32x32x16_bf16 a[112:127], v[36:39], v[76:79], a[112:127]
    v_mfma_f32_32x32x16_bf16 a[128:143], v[40:43], v[64:67], a[128:143]
    v_mfma_f32_32x32x16_bf16 a[144:159], v[40:43], v[68:71], a[144:159]
    v_mfma_f32_32x32x16_bf16 a[160:175], v[40:43], v[72:75], a[160:175]
    v_mfma_f32_32x32x16_bf16 a[176:191], v[40:43], v[76:79], a[176:191]
    v_mfma_f32_32x32x16_bf16 a[192:207], v[44:47], v[64:67], a[192:207]
    v_mfma_f32_32x32x16_bf16 a[208:223], v[44:47], v[68:71], a[208:223]
    v_mfma_f32_32x32x16_bf16 a[224:239], v[44:47], v[72:75], a[224:239]
    v_mfma_f32_32x32x16_bf16 a[240:255], v[44:47], v[76:79], a[240:255]
    ds_read_b128 v[32:35], v14 offset:3072
    ds_read_b128 v[36:39], v14 offset:7168
    ds_read_b128 v[40:43], v14 offset:11264
    ds_read_b128 v[44:47], v14 offset:15360
    ds_read_b128 v[64:67], v15 offset:3072
    ds_read_b128 v[68:71], v15 offset:7168
    ds_read_b128 v[72:75], v15 offset:11264
    ds_read_b128 v[76:79], v15 offset:15360
    s_waitcnt lgkmcnt(8)
    v_mfma_f32_32x32x16_bf16 a[0:15], v[16:19], v[48:51], a[0:15]
    v_mfma_f32_32x32x16_bf16 a[16:31], v[16:19], v[52:55], a[16:31]
    v_mfma_f32_32x32x16_bf16 a[32:47], v[16:19], v[56:59], a[32:47]
    v_mfma_f32_32x32x16_bf16 a[48:63], v[16:19], v[60:63], a[48:63]
    v_mfma_f32_32x32x16_bf16 a[64:79], v[20:23], v[48:51], a[64:79]
    v_mfma_f32_32x32x16_bf16 a[80:95], v[20:23], v[52:55], a[80:95]
    v_mfma_f32_32x32x16_bf16 a[96:111], v[20:23], v[56:59], a[96:111]
    v_mfma_f32_32x32x16_bf16 a[112:127], v[20:23], v[60:63], a[112:127]
    v_mfma_f32_32x32x16_bf16 a[128:143], v[24:27], v[48:51], a[128:143]
    v_mfma_f32_32x32x16_bf16 a[144:159], v[24:27], v[52:55], a[144:159]
    v_mfma_f32_32x32x16_bf16 a[160:175], v[24:27], v[56:59], a[160:175]
    v_mfma_f32_32x32x16_bf16 a[176:191], v[24:27], v[60:63], a[176:191]
    v_mfma_f32_32x32x16_bf16 a[192:207], v[28:31], v[48:51], a[192:207]
    v_mfma_f32_32x32x16_bf16 a[208:223], v[28:31], v[52:55], a[208:223]
    v_mfma_f32_32x32x16_bf16 a[224:239], v[28:31], v[56:59], a[224:239]
    v_mfma_f32_32x32x16_bf16 a[240:255], v[28:31], v[60:63], a[240:255]
    s_waitcnt lgkmcnt(0)
    v_mfma_f32_32x32x16_bf16 a[0:15], v[32:35], v[64:67], a[0:15]
    v_mfma_f32_32x32x16_bf16 a[16:31], v[32:35], v[68:71], a[16:31]
    v_mfma_f32_32x32x16_bf16 a[32:47], v[32:35], v[72:75], a[32:47]
    v_mfma_f32_32x32x16_bf16 a[48:63], v[32:35], v[76:79], a[48:63]
    v_mfma_f32_32x32x16_bf16 a[64:79], v[36:39], v[64:67], a[64:79]
    v_mfma_f32_32x32x16_bf16 a[80:95], v[36:39], v[68:71], a[80:95]
    v_mfma_f32_32x32x16_bf16 a[96:111], v[36:39], v[72:75], a[96:111]
    v_mfma_f32_32x32x16_bf16 a[112:127], v[36:39], v[76:79], a[112:127]
    v_mfma_f32_32x32x16_bf16 a[128:143], v[40:43], v[64:67], a[128:143]
    v_mfma_f32_32x32x16_bf16 a[144:159], v[40:43], v[68:71], a[144:159]
    v_mfma_f32_32x32x16_bf16 a[160:175], v[40:43], v[72:75], a[160:175]
    v_mfma_f32_32x32x16_bf16 a[176:191], v[40:43], v[76:79], a[176:191]
    v_mfma_f32_32x32x16_bf16 a[192:207], v[44:47], v[64:67], a[192:207]
    v_mfma_f32_32x32x16_bf16 a[208:223], v[44:47], v[68:71], a[208:223]
    v_mfma_f32_32x32x16_bf16 a[224:239], v[44:47], v[72:75], a[224:239]
    v_mfma_f32_32x32x16_bf16 a[240:255], v[44:47], v[76:79], a[240:255]
    s_waitcnt vmcnt(0)
    s_barrier
    ds_read_b128 v[16:19], v12 offset:0
    ds_read_b128 v[20:23], v12 offset:4096
    ds_read_b128 v[24:27], v12 offset:8192
    ds_read_b128 v[28:31], v12 offset:12288
    ds_read_b128 v[48:51], v13 offset:0
    ds_read_b128 v[52:55], v13 offset:4096
    ds_read_b128 v[56:59], v13 offset:8192
    ds_read_b128 v[60:63], v13 offset:12288
    ds_read_b128 v[32:35], v12 offset:1024
    ds_read_b128 v[36:39], v12 offset:5120
    ds_read_b128 v[40:43], v12 offset:9216
    ds_read_b128 v[44:47], v12 offset:13312
    ds_read_b128 v[64:67], v13 offset:1024
    ds_read_b128 v[68:71], v13 offset:5120
    ds_read_b128 v[72:75], v13 offset:9216
    ds_read_b128 v[76:79], v13 offset:13312
    s_waitcnt lgkmcnt(8)
    v_mfma_f32_32x32x16_bf16 a[0:15], v[16:19], v[48:51], a[0:15]
    v_mfma_f32_32x32x16_bf16 a[16:31], v[16:19], v[52:55], a[16:31]
    v_mfma_f32_32x32x16_bf16 a[32:47], v[16:19], v[56:59], a[32:47]
    v_mfma_f32_32x32x16_bf16 a[48:63], v[16:19], v[60:63], a[48:63]
    v_mfma_f32_32x32x16_bf16 a[64:79], v[20:23], v[48:51], a[64:79]
    v_mfma_f32_32x32x16_bf16 a[80:95], v[20:23], v[52:55], a[80:95]
    v_mfma_f32_32x32x16_bf16 a[96:111], v[20:23], v[56:59], a[96:111]
    v_mfma_f32_32x32x16_bf16 a[112:127], v[20:23], v[60:63], a[112:127]
    v_mfma_f32_32x32x16_bf16 a[128:143], v[24:27], v[48:51], a[128:143]
    v_mfma_f32_32x32x16_bf16 a[144:159], v[24:27], v[52:55], a[144:159]
    v_mfma_f32_32x32x16_bf16 a[160:175], v[24:27], v[56:59], a[160:175]
    v_mfma_f32_32x32x16_bf16 a[176:191], v[24:27], v[60:63], a[176:191]
    v_mfma_f32_32x32x16_bf16 a[192:207], v[28:31], v[48:51], a[192:207]
    v_mfma_f32_32x32x16_bf16 a[208:223], v[28:31], v[52:55], a[208:223]
    v_mfma_f32_32x32x16_bf16 a[224:239], v[28:31], v[56:59], a[224:239]
    v_mfma_f32_32x32x16_bf16 a[240:255], v[28:31], v[60:63], a[240:255]
    ds_read_b128 v[16:19], v12 offset:2048
    ds_read_b128 v[20:23], v12 offset:6144
    ds_read_b128 v[24:27], v12 offset:10240
    ds_read_b128 v[28:31], v12 offset:14336
    ds_read_b128 v[48:51], v13 offset:2048
    ds_read_b128 v[52:55], v13 offset:6144
    ds_read_b128 v[56:59], v13 offset:10240
    ds_read_b128 v[60:63], v13 offset:14336
    s_waitcnt lgkmcnt(8)
    v_mfma_f32_32x32x16_bf16 a[0:15], v[32:35], v[64:67], a[0:15]
    v_mfma_f32_32x32x16_bf16 a[16:31], v[32:35], v[68:71], a[16:31]
    v_mfma_f32_32x32x16_bf16 a[32:47], v[32:35], v[72:75], a[32:47]
    v_mfma_f32_32x32x16_bf16 a[48:63], v[32:35], v[76:79], a[48:63]
    v_mfma_f32_32x32x16_bf16 a[64:79], v[36:39], v[64:67], a[64:79]
    v_mfma_f32_32x32x16_bf16 a[80:95], v[36:39], v[68:71], a[80:95]
    v_mfma_f32_32x32x16_bf16 a[96:111], v[36:39], v[72:75], a[96:111]
    v_mfma_f32_32x32x16_bf16 a[112:127], v[36:39], v[76:79], a[112:127]
    v_mfma_f32_32x32x16_bf16 a[128:143], v[40:43], v[64:67], a[128:143]
    v_mfma_f32_32x32x16_bf16 a[144:159], v[40:43], v[68:71], a[144:159]
    v_mfma_f32_32x32x16_bf16 a[160:175], v[40:43], v[72:75], a[160:175]
    v_mfma_f32_32x32x16_bf16 a[176:191], v[40:43], v[76:79], a[176:191]
    v_mfma_f32_32x32x16_bf16 a[192:207], v[44:47], v[64:67], a[192:207]
    v_mfma_f32_32x32x16_bf16 a[208:223], v[44:47], v[68:71], a[208:223]
    v_mfma_f32_32x32x16_bf16 a[224:239], v[44:47], v[72:75], a[224:239]
    v_mfma_f32_32x32x16_bf16 a[240:255], v[44:47], v[76:79], a[240:255]
    ds_read_b128 v[32:35], v12 offset:3072
    ds_read_b128 v[36:39], v12 offset:7168
    ds_read_b128 v[40:43], v12 offset:11264
    ds_read_b128 v[44:47], v12 offset:15360
    ds_read_b128 v[64:67], v13 offset:3072
    ds_read_b128 v[68:71], v13 offset:7168
    ds_read_b128 v[72:75], v13 offset:11264
    ds_read_b128 v[76:79], v13 offset:15360
    s_waitcnt lgkmcnt(8)
    v_mfma_f32_32x32x16_bf16 a[0:15], v[16:19], v[48:51], a[0:15]
    v_mfma_f32_32x32x16_bf16 a[16:31], v[16:19], v[52:55], a[16:31]
    v_mfma_f32_32x32x16_bf16 a[32:47], v[16:19], v[56:59], a[32:47]
    v_mfma_f32_32x32x16_bf16 a[48:63], v[16:19], v[60:63], a[48:63]
    v_mfma_f32_32x32x16_bf16 a[64:79], v[20:23], v[48:51], a[64:79]
    v_mfma_f32_32x32x16_bf16 a[80:95], v[20:23], v[52:55], a[80:95]
    v_mfma_f32_32x32x16_bf16 a[96:111], v[20:23], v[56:59], a[96:111]
    v_mfma_f32_32x32x16_bf16 a[112:127], v[20:23], v[60:63], a[112:127]
    v_mfma_f32_32x32x16_bf16 a[128:143], v[24:27], v[48:51], a[128:143]
    v_mfma_f32_32x32x16_bf16 a[144:159], v[24:27], v[52:55], a[144:159]
    v_mfma_f32_32x32x16_bf16 a[160:175], v[24:27], v[56:59], a[160:175]
    v_mfma_f32_32x32x16_bf16 a[176:191], v[24:27], v[60:63], a[176:191]
    v_mfma_f32_32x32x16_bf16 a[192:207], v[28:31], v[48:51], a[192:207]
    v_mfma_f32_32x32x16_bf16 a[208:223], v[28:31], v[52:55], a[208:223]
    v_mfma_f32_32x32x16_bf16 a[224:239], v[28:31], v[56:59], a[224:239]
    v_mfma_f32_32x32x16_bf16 a[240:255], v[28:31], v[60:63], a[240:255]
    s_waitcnt lgkmcnt(0)
    v_mfma_f32_32x32x16_bf16 a[0:15], v[32:35], v[64:67], a[0:15]
    v_mfma_f32_32x32x16_bf16 a[16:31], v[32:35], v[68:71], a[16:31]
    v_mfma_f32_32x32x16_bf16 a[32:47], v[32:35], v[72:75], a[32:47]
    v_mfma_f32_32x32x16_bf16 a[48:63], v[32:35], v[76:79], a[48:63]
    v_mfma_f32_32x32x16_bf16 a[64:79], v[36:39], v[64:67], a[64:79]
    v_mfma_f32_32x32x16_bf16 a[80:95], v[36:39], v[68:71], a[80:95]
    v_mfma_f32_32x32x16_bf16 a[96:111], v[36:39], v[72:75], a[96:111]
    v_mfma_f32_32x32x16_bf16 a[112:127], v[36:39], v[76:79], a[112:127]
    v_mfma_f32_32x32x16_bf16 a[128:143], v[40:43], v[64:67], a[128:143]
    v_mfma_f32_32x32x16_bf16 a[144:159], v[40:43], v[68:71], a[144:159]
    v_mfma_f32_32x32x16_bf16 a[160:175], v[40:43], v[72:75], a[160:175]
    v_mfma_f32_32x32x16_bf16 a[176:191], v[40:43], v[76:79], a[176:191]
    v_mfma_f32_32x32x16_bf16 a[192:207], v[44:47], v[64:67], a[192:207]
    v_mfma_f32_32x32x16_bf16 a[208:223], v[44:47], v[68:71], a[208:223]
    v_mfma_f32_32x32x16_bf16 a[224:239], v[44:47], v[72:75], a[224:239]
    v_mfma_f32_32x32x16_bf16 a[240:255], v[44:47], v[76:79], a[240:255]
    s_lshl_b32 s54, s54, 1
    s_lshr_b32 s58, s40, 1
    s_add_u32 s54, s54, s58
    s_lshl_b32 s55, s55, 1
    s_and_b32 s58, s40, 1
    s_add_u32 s55, s55, s58
    v_and_b32 v7, 15, v2
    v_lshl_add_u32 v7, v3, 4, v7
    v_lshlrev_b32 v7, 4, v7
    v_lshl_add_u32 v7, v5, 10, v7
    s_nop 7
    s_nop 7
    s_mul_i32 s58, s55, 4
    s_add_u32 s58, s58, 0
    s_mul_i32 s59, s58, 4682
    s_lshr_b32 s59, s59, 16
    s_mul_i32 s61, s59, 14
    s_sub_u32 s61, s58, s61
    s_mul_i32 s59, s59, 28
    s_lshl_b32 s61, s61, 1
    s_add_u32 s59, s59, s61
    s_mul_i32 s61, s54, 1792
    s_add_u32 s59, s59, s61
    s_lshl_b32 s59, s59, 10
    s_add_u32 s59, s59, 83886080
    v_accvgpr_read_b32 v16, a0
    v_accvgpr_read_b32 v17, a1
    v_accvgpr_read_b32 v18, a2
    v_accvgpr_read_b32 v19, a3
    v_accvgpr_read_b32 v20, a4
    v_accvgpr_read_b32 v21, a5
    v_accvgpr_read_b32 v22, a6
    v_accvgpr_read_b32 v23, a7
    v_accvgpr_read_b32 v24, a8
    v_accvgpr_read_b32 v25, a9
    v_accvgpr_read_b32 v26, a10
    v_accvgpr_read_b32 v27, a11
    v_accvgpr_read_b32 v28, a12
    v_accvgpr_read_b32 v29, a13
    v_accvgpr_read_b32 v30, a14
    v_accvgpr_read_b32 v31, a15
    v_cvt_pk_bf16_f32 v32, v16, v17
    v_cvt_pk_bf16_f32 v33, v18, v19
    v_cvt_pk_bf16_f32 v34, v20, v21
    v_cvt_pk_bf16_f32 v35, v22, v23
    v_cvt_pk_bf16_f32 v36, v24, v25
    v_cvt_pk_bf16_f32 v37, v26, v27
    v_cvt_pk_bf16_f32 v38, v28, v29
    v_cvt_pk_bf16_f32 v39, v30, v31
    s_add_u32 s61, s59, 0
    s_nop 0
    v_permlane32_swap_b32 v32, v34
    v_permlane32_swap_b32 v33, v35
    v_permlane32_swap_b32 v36, v38
    v_permlane32_swap_b32 v37, v39
    buffer_store_dwordx4 v[32:35], v7, s[36:39], s61 offen offset:0 sc1
    buffer_store_dwordx4 v[36:39], v7, s[36:39], s61 offen offset:512 sc1
    s_nop 1
    v_accvgpr_read_b32 v16, a64
    v_accvgpr_read_b32 v17, a65
    v_accvgpr_read_b32 v18, a66
    v_accvgpr_read_b32 v19, a67
    v_accvgpr_read_b32 v20, a68
    v_accvgpr_read_b32 v21, a69
    v_accvgpr_read_b32 v22, a70
    v_accvgpr_read_b32 v23, a71
    v_accvgpr_read_b32 v24, a72
    v_accvgpr_read_b32 v25, a73
    v_accvgpr_read_b32 v26, a74
    v_accvgpr_read_b32 v27, a75
    v_accvgpr_read_b32 v28, a76
    v_accvgpr_read_b32 v29, a77
    v_accvgpr_read_b32 v30, a78
    v_accvgpr_read_b32 v31, a79
    v_cvt_pk_bf16_f32 v32, v16, v17
    v_cvt_pk_bf16_f32 v33, v18, v19
    v_cvt_pk_bf16_f32 v34, v20, v21
    v_cvt_pk_bf16_f32 v35, v22, v23
    v_cvt_pk_bf16_f32 v36, v24, v25
    v_cvt_pk_bf16_f32 v37, v26, v27
    v_cvt_pk_bf16_f32 v38, v28, v29
    v_cvt_pk_bf16_f32 v39, v30, v31
    s_add_u32 s61, s59, 458752
    s_nop 0
    v_permlane32_swap_b32 v32, v34
    v_permlane32_swap_b32 v33, v35
    v_permlane32_swap_b32 v36, v38
    v_permlane32_swap_b32 v37, v39
    buffer_store_dwordx4 v[32:35], v7, s[36:39], s61 offen offset:0 sc1
    buffer_store_dwordx4 v[36:39], v7, s[36:39], s61 offen offset:512 sc1
    s_nop 1
    v_accvgpr_read_b32 v16, a128
    v_accvgpr_read_b32 v17, a129
    v_accvgpr_read_b32 v18, a130
    v_accvgpr_read_b32 v19, a131
    v_accvgpr_read_b32 v20, a132
    v_accvgpr_read_b32 v21, a133
    v_accvgpr_read_b32 v22, a134
    v_accvgpr_read_b32 v23, a135
    v_accvgpr_read_b32 v24, a136
    v_accvgpr_read_b32 v25, a137
    v_accvgpr_read_b32 v26, a138
    v_accvgpr_read_b32 v27, a139
    v_accvgpr_read_b32 v28, a140
    v_accvgpr_read_b32 v29, a141
    v_accvgpr_read_b32 v30, a142
    v_accvgpr_read_b32 v31, a143
    v_cvt_pk_bf16_f32 v32, v16, v17
    v_cvt_pk_bf16_f32 v33, v18, v19
    v_cvt_pk_bf16_f32 v34, v20, v21
    v_cvt_pk_bf16_f32 v35, v22, v23
    v_cvt_pk_bf16_f32 v36, v24, v25
    v_cvt_pk_bf16_f32 v37, v26, v27
    v_cvt_pk_bf16_f32 v38, v28, v29
    v_cvt_pk_bf16_f32 v39, v30, v31
    s_add_u32 s61, s59, 917504
    s_nop 0
    v_permlane32_swap_b32 v32, v34
    v_permlane32_swap_b32 v33, v35
    v_permlane32_swap_b32 v36, v38
    v_permlane32_swap_b32 v37, v39
    buffer_store_dwordx4 v[32:35], v7, s[36:39], s61 offen offset:0 sc1
    buffer_store_dwordx4 v[36:39], v7, s[36:39], s61 offen offset:512 sc1
    s_nop 1
    v_accvgpr_read_b32 v16, a192
    v_accvgpr_read_b32 v17, a193
    v_accvgpr_read_b32 v18, a194
    v_accvgpr_read_b32 v19, a195
    v_accvgpr_read_b32 v20, a196
    v_accvgpr_read_b32 v21, a197
    v_accvgpr_read_b32 v22, a198
    v_accvgpr_read_b32 v23, a199
    v_accvgpr_read_b32 v24, a200
    v_accvgpr_read_b32 v25, a201
    v_accvgpr_read_b32 v26, a202
    v_accvgpr_read_b32 v27, a203
    v_accvgpr_read_b32 v28, a204
    v_accvgpr_read_b32 v29, a205
    v_accvgpr_read_b32 v30, a206
    v_accvgpr_read_b32 v31, a207
    v_cvt_pk_bf16_f32 v32, v16, v17
    v_cvt_pk_bf16_f32 v33, v18, v19
    v_cvt_pk_bf16_f32 v34, v20, v21
    v_cvt_pk_bf16_f32 v35, v22, v23
    v_cvt_pk_bf16_f32 v36, v24, v25
    v_cvt_pk_bf16_f32 v37, v26, v27
    v_cvt_pk_bf16_f32 v38, v28, v29
    v_cvt_pk_bf16_f32 v39, v30, v31
    s_add_u32 s61, s59, 1376256
    s_nop 0
    v_permlane32_swap_b32 v32, v34
    v_permlane32_swap_b32 v33, v35
    v_permlane32_swap_b32 v36, v38
    v_permlane32_swap_b32 v37, v39
    buffer_store_dwordx4 v[32:35], v7, s[36:39], s61 offen offset:0 sc1
    buffer_store_dwordx4 v[36:39], v7, s[36:39], s61 offen offset:512 sc1
    s_nop 1
    s_mul_i32 s58, s55, 4
    s_add_u32 s58, s58, 1
    s_mul_i32 s59, s58, 4682
    s_lshr_b32 s59, s59, 16
    s_mul_i32 s61, s59, 14
    s_sub_u32 s61, s58, s61
    s_mul_i32 s59, s59, 28
    s_lshl_b32 s61, s61, 1
    s_add_u32 s59, s59, s61
    s_mul_i32 s61, s54, 1792
    s_add_u32 s59, s59, s61
    s_lshl_b32 s59, s59, 10
    s_add_u32 s59, s59, 83886080
    v_accvgpr_read_b32 v16, a16
    v_accvgpr_read_b32 v17, a17
    v_accvgpr_read_b32 v18, a18
    v_accvgpr_read_b32 v19, a19
    v_accvgpr_read_b32 v20, a20
    v_accvgpr_read_b32 v21, a21
    v_accvgpr_read_b32 v22, a22
    v_accvgpr_read_b32 v23, a23
    v_accvgpr_read_b32 v24, a24
    v_accvgpr_read_b32 v25, a25
    v_accvgpr_read_b32 v26, a26
    v_accvgpr_read_b32 v27, a27
    v_accvgpr_read_b32 v28, a28
    v_accvgpr_read_b32 v29, a29
    v_accvgpr_read_b32 v30, a30
    v_accvgpr_read_b32 v31, a31
    v_cvt_pk_bf16_f32 v32, v16, v17
    v_cvt_pk_bf16_f32 v33, v18, v19
    v_cvt_pk_bf16_f32 v34, v20, v21
    v_cvt_pk_bf16_f32 v35, v22, v23
    v_cvt_pk_bf16_f32 v36, v24, v25
    v_cvt_pk_bf16_f32 v37, v26, v27
    v_cvt_pk_bf16_f32 v38, v28, v29
    v_cvt_pk_bf16_f32 v39, v30, v31
    s_add_u32 s61, s59, 0
    s_nop 0
    v_permlane32_swap_b32 v32, v34
    v_permlane32_swap_b32 v33, v35
    v_permlane32_swap_b32 v36, v38
    v_permlane32_swap_b32 v37, v39
    buffer_store_dwordx4 v[32:35], v7, s[36:39], s61 offen offset:0 sc1
    buffer_store_dwordx4 v[36:39], v7, s[36:39], s61 offen offset:512 sc1
    s_nop 1
    v_accvgpr_read_b32 v16, a80
    v_accvgpr_read_b32 v17, a81
    v_accvgpr_read_b32 v18, a82
    v_accvgpr_read_b32 v19, a83
    v_accvgpr_read_b32 v20, a84
    v_accvgpr_read_b32 v21, a85
    v_accvgpr_read_b32 v22, a86
    v_accvgpr_read_b32 v23, a87
    v_accvgpr_read_b32 v24, a88
    v_accvgpr_read_b32 v25, a89
    v_accvgpr_read_b32 v26, a90
    v_accvgpr_read_b32 v27, a91
    v_accvgpr_read_b32 v28, a92
    v_accvgpr_read_b32 v29, a93
    v_accvgpr_read_b32 v30, a94
    v_accvgpr_read_b32 v31, a95
    v_cvt_pk_bf16_f32 v32, v16, v17
    v_cvt_pk_bf16_f32 v33, v18, v19
    v_cvt_pk_bf16_f32 v34, v20, v21
    v_cvt_pk_bf16_f32 v35, v22, v23
    v_cvt_pk_bf16_f32 v36, v24, v25
    v_cvt_pk_bf16_f32 v37, v26, v27
    v_cvt_pk_bf16_f32 v38, v28, v29
    v_cvt_pk_bf16_f32 v39, v30, v31
    s_add_u32 s61, s59, 458752
    s_nop 0
    v_permlane32_swap_b32 v32, v34
    v_permlane32_swap_b32 v33, v35
    v_permlane32_swap_b32 v36, v38
    v_permlane32_swap_b32 v37, v39
    buffer_store_dwordx4 v[32:35], v7, s[36:39], s61 offen offset:0 sc1
    buffer_store_dwordx4 v[36:39], v7, s[36:39], s61 offen offset:512 sc1
    s_nop 1
    v_accvgpr_read_b32 v16, a144
    v_accvgpr_read_b32 v17, a145
    v_accvgpr_read_b32 v18, a146
    v_accvgpr_read_b32 v19, a147
    v_accvgpr_read_b32 v20, a148
    v_accvgpr_read_b32 v21, a149
    v_accvgpr_read_b32 v22, a150
    v_accvgpr_read_b32 v23, a151
    v_accvgpr_read_b32 v24, a152
    v_accvgpr_read_b32 v25, a153
    v_accvgpr_read_b32 v26, a154
    v_accvgpr_read_b32 v27, a155
    v_accvgpr_read_b32 v28, a156
    v_accvgpr_read_b32 v29, a157
    v_accvgpr_read_b32 v30, a158
    v_accvgpr_read_b32 v31, a159
    v_cvt_pk_bf16_f32 v32, v16, v17
    v_cvt_pk_bf16_f32 v33, v18, v19
    v_cvt_pk_bf16_f32 v34, v20, v21
    v_cvt_pk_bf16_f32 v35, v22, v23
    v_cvt_pk_bf16_f32 v36, v24, v25
    v_cvt_pk_bf16_f32 v37, v26, v27
    v_cvt_pk_bf16_f32 v38, v28, v29
    v_cvt_pk_bf16_f32 v39, v30, v31
    s_add_u32 s61, s59, 917504
    s_nop 0
    v_permlane32_swap_b32 v32, v34
    v_permlane32_swap_b32 v33, v35
    v_permlane32_swap_b32 v36, v38
    v_permlane32_swap_b32 v37, v39
    buffer_store_dwordx4 v[32:35], v7, s[36:39], s61 offen offset:0 sc1
    buffer_store_dwordx4 v[36:39], v7, s[36:39], s61 offen offset:512 sc1
    s_nop 1
    v_accvgpr_read_b32 v16, a208
    v_accvgpr_read_b32 v17, a209
    v_accvgpr_read_b32 v18, a210
    v_accvgpr_read_b32 v19, a211
    v_accvgpr_read_b32 v20, a212
    v_accvgpr_read_b32 v21, a213
    v_accvgpr_read_b32 v22, a214
    v_accvgpr_read_b32 v23, a215
    v_accvgpr_read_b32 v24, a216
    v_accvgpr_read_b32 v25, a217
    v_accvgpr_read_b32 v26, a218
    v_accvgpr_read_b32 v27, a219
    v_accvgpr_read_b32 v28, a220
    v_accvgpr_read_b32 v29, a221
    v_accvgpr_read_b32 v30, a222
    v_accvgpr_read_b32 v31, a223
    v_cvt_pk_bf16_f32 v32, v16, v17
    v_cvt_pk_bf16_f32 v33, v18, v19
    v_cvt_pk_bf16_f32 v34, v20, v21
    v_cvt_pk_bf16_f32 v35, v22, v23
    v_cvt_pk_bf16_f32 v36, v24, v25
    v_cvt_pk_bf16_f32 v37, v26, v27
    v_cvt_pk_bf16_f32 v38, v28, v29
    v_cvt_pk_bf16_f32 v39, v30, v31
    s_add_u32 s61, s59, 1376256
    s_nop 0
    v_permlane32_swap_b32 v32, v34
    v_permlane32_swap_b32 v33, v35
    v_permlane32_swap_b32 v36, v38
    v_permlane32_swap_b32 v37, v39
    buffer_store_dwordx4 v[32:35], v7, s[36:39], s61 offen offset:0 sc1
    buffer_store_dwordx4 v[36:39], v7, s[36:39], s61 offen offset:512 sc1
    s_nop 1
    s_mul_i32 s58, s55, 4
    s_add_u32 s58, s58, 2
    s_mul_i32 s59, s58, 4682
    s_lshr_b32 s59, s59, 16
    s_mul_i32 s61, s59, 14
    s_sub_u32 s61, s58, s61
    s_mul_i32 s59, s59, 28
    s_lshl_b32 s61, s61, 1
    s_add_u32 s59, s59, s61
    s_mul_i32 s61, s54, 1792
    s_add_u32 s59, s59, s61
    s_lshl_b32 s59, s59, 10
    s_add_u32 s59, s59, 83886080
    v_accvgpr_read_b32 v16, a32
    v_accvgpr_read_b32 v17, a33
    v_accvgpr_read_b32 v18, a34
    v_accvgpr_read_b32 v19, a35
    v_accvgpr_read_b32 v20, a36
    v_accvgpr_read_b32 v21, a37
    v_accvgpr_read_b32 v22, a38
    v_accvgpr_read_b32 v23, a39
    v_accvgpr_read_b32 v24, a40
    v_accvgpr_read_b32 v25, a41
    v_accvgpr_read_b32 v26, a42
    v_accvgpr_read_b32 v27, a43
    v_accvgpr_read_b32 v28, a44
    v_accvgpr_read_b32 v29, a45
    v_accvgpr_read_b32 v30, a46
    v_accvgpr_read_b32 v31, a47
    v_cvt_pk_bf16_f32 v32, v16, v17
    v_cvt_pk_bf16_f32 v33, v18, v19
    v_cvt_pk_bf16_f32 v34, v20, v21
    v_cvt_pk_bf16_f32 v35, v22, v23
    v_cvt_pk_bf16_f32 v36, v24, v25
    v_cvt_pk_bf16_f32 v37, v26, v27
    v_cvt_pk_bf16_f32 v38, v28, v29
    v_cvt_pk_bf16_f32 v39, v30, v31
    s_add_u32 s61, s59, 0
    s_nop 0
    v_permlane32_swap_b32 v32, v34
    v_permlane32_swap_b32 v33, v35
    v_permlane32_swap_b32 v36, v38
    v_permlane32_swap_b32 v37, v39
    buffer_store_dwordx4 v[32:35], v7, s[36:39], s61 offen offset:0 sc1
    buffer_store_dwordx4 v[36:39], v7, s[36:39], s61 offen offset:512 sc1
    s_nop 1
    v_accvgpr_read_b32 v16, a96
    v_accvgpr_read_b32 v17, a97
    v_accvgpr_read_b32 v18, a98
    v_accvgpr_read_b32 v19, a99
    v_accvgpr_read_b32 v20, a100
    v_accvgpr_read_b32 v21, a101
    v_accvgpr_read_b32 v22, a102
    v_accvgpr_read_b32 v23, a103
    v_accvgpr_read_b32 v24, a104
    v_accvgpr_read_b32 v25, a105
    v_accvgpr_read_b32 v26, a106
    v_accvgpr_read_b32 v27, a107
    v_accvgpr_read_b32 v28, a108
    v_accvgpr_read_b32 v29, a109
    v_accvgpr_read_b32 v30, a110
    v_accvgpr_read_b32 v31, a111
    v_cvt_pk_bf16_f32 v32, v16, v17
    v_cvt_pk_bf16_f32 v33, v18, v19
    v_cvt_pk_bf16_f32 v34, v20, v21
    v_cvt_pk_bf16_f32 v35, v22, v23
    v_cvt_pk_bf16_f32 v36, v24, v25
    v_cvt_pk_bf16_f32 v37, v26, v27
    v_cvt_pk_bf16_f32 v38, v28, v29
    v_cvt_pk_bf16_f32 v39, v30, v31
    s_add_u32 s61, s59, 458752
    s_nop 0
    v_permlane32_swap_b32 v32, v34
    v_permlane32_swap_b32 v33, v35
    v_permlane32_swap_b32 v36, v38
    v_permlane32_swap_b32 v37, v39
    buffer_store_dwordx4 v[32:35], v7, s[36:39], s61 offen offset:0 sc1
    buffer_store_dwordx4 v[36:39], v7, s[36:39], s61 offen offset:512 sc1
    s_nop 1
    v_accvgpr_read_b32 v16, a160
    v_accvgpr_read_b32 v17, a161
    v_accvgpr_read_b32 v18, a162
    v_accvgpr_read_b32 v19, a163
    v_accvgpr_read_b32 v20, a164
    v_accvgpr_read_b32 v21, a165
    v_accvgpr_read_b32 v22, a166
    v_accvgpr_read_b32 v23, a167
    v_accvgpr_read_b32 v24, a168
    v_accvgpr_read_b32 v25, a169
    v_accvgpr_read_b32 v26, a170
    v_accvgpr_read_b32 v27, a171
    v_accvgpr_read_b32 v28, a172
    v_accvgpr_read_b32 v29, a173
    v_accvgpr_read_b32 v30, a174
    v_accvgpr_read_b32 v31, a175
    v_cvt_pk_bf16_f32 v32, v16, v17
    v_cvt_pk_bf16_f32 v33, v18, v19
    v_cvt_pk_bf16_f32 v34, v20, v21
    v_cvt_pk_bf16_f32 v35, v22, v23
    v_cvt_pk_bf16_f32 v36, v24, v25
    v_cvt_pk_bf16_f32 v37, v26, v27
    v_cvt_pk_bf16_f32 v38, v28, v29
    v_cvt_pk_bf16_f32 v39, v30, v31
    s_add_u32 s61, s59, 917504
    s_nop 0
    v_permlane32_swap_b32 v32, v34
    v_permlane32_swap_b32 v33, v35
    v_permlane32_swap_b32 v36, v38
    v_permlane32_swap_b32 v37, v39
    buffer_store_dwordx4 v[32:35], v7, s[36:39], s61 offen offset:0 sc1
    buffer_store_dwordx4 v[36:39], v7, s[36:39], s61 offen offset:512 sc1
    s_nop 1
    v_accvgpr_read_b32 v16, a224
    v_accvgpr_read_b32 v17, a225
    v_accvgpr_read_b32 v18, a226
    v_accvgpr_read_b32 v19, a227
    v_accvgpr_read_b32 v20, a228
    v_accvgpr_read_b32 v21, a229
    v_accvgpr_read_b32 v22, a230
    v_accvgpr_read_b32 v23, a231
    v_accvgpr_read_b32 v24, a232
    v_accvgpr_read_b32 v25, a233
    v_accvgpr_read_b32 v26, a234
    v_accvgpr_read_b32 v27, a235
    v_accvgpr_read_b32 v28, a236
    v_accvgpr_read_b32 v29, a237
    v_accvgpr_read_b32 v30, a238
    v_accvgpr_read_b32 v31, a239
    v_cvt_pk_bf16_f32 v32, v16, v17
    v_cvt_pk_bf16_f32 v33, v18, v19
    v_cvt_pk_bf16_f32 v34, v20, v21
    v_cvt_pk_bf16_f32 v35, v22, v23
    v_cvt_pk_bf16_f32 v36, v24, v25
    v_cvt_pk_bf16_f32 v37, v26, v27
    v_cvt_pk_bf16_f32 v38, v28, v29
    v_cvt_pk_bf16_f32 v39, v30, v31
    s_add_u32 s61, s59, 1376256
    s_nop 0
    v_permlane32_swap_b32 v32, v34
    v_permlane32_swap_b32 v33, v35
    v_permlane32_swap_b32 v36, v38
    v_permlane32_swap_b32 v37, v39
    buffer_store_dwordx4 v[32:35], v7, s[36:39], s61 offen offset:0 sc1
    buffer_store_dwordx4 v[36:39], v7, s[36:39], s61 offen offset:512 sc1
    s_nop 1
    s_mul_i32 s58, s55, 4
    s_add_u32 s58, s58, 3
    s_mul_i32 s59, s58, 4682
    s_lshr_b32 s59, s59, 16
    s_mul_i32 s61, s59, 14
    s_sub_u32 s61, s58, s61
    s_mul_i32 s59, s59, 28
    s_lshl_b32 s61, s61, 1
    s_add_u32 s59, s59, s61
    s_mul_i32 s61, s54, 1792
    s_add_u32 s59, s59, s61
    s_lshl_b32 s59, s59, 10
    s_add_u32 s59, s59, 83886080
    v_accvgpr_read_b32 v16, a48
    v_accvgpr_read_b32 v17, a49
    v_accvgpr_read_b32 v18, a50
    v_accvgpr_read_b32 v19, a51
    v_accvgpr_read_b32 v20, a52
    v_accvgpr_read_b32 v21, a53
    v_accvgpr_read_b32 v22, a54
    v_accvgpr_read_b32 v23, a55
    v_accvgpr_read_b32 v24, a56
    v_accvgpr_read_b32 v25, a57
    v_accvgpr_read_b32 v26, a58
    v_accvgpr_read_b32 v27, a59
    v_accvgpr_read_b32 v28, a60
    v_accvgpr_read_b32 v29, a61
    v_accvgpr_read_b32 v30, a62
    v_accvgpr_read_b32 v31, a63
    v_cvt_pk_bf16_f32 v32, v16, v17
    v_cvt_pk_bf16_f32 v33, v18, v19
    v_cvt_pk_bf16_f32 v34, v20, v21
    v_cvt_pk_bf16_f32 v35, v22, v23
    v_cvt_pk_bf16_f32 v36, v24, v25
    v_cvt_pk_bf16_f32 v37, v26, v27
    v_cvt_pk_bf16_f32 v38, v28, v29
    v_cvt_pk_bf16_f32 v39, v30, v31
    s_add_u32 s61, s59, 0
    s_nop 0
    v_permlane32_swap_b32 v32, v34
    v_permlane32_swap_b32 v33, v35
    v_permlane32_swap_b32 v36, v38
    v_permlane32_swap_b32 v37, v39
    buffer_store_dwordx4 v[32:35], v7, s[36:39], s61 offen offset:0 sc1
    buffer_store_dwordx4 v[36:39], v7, s[36:39], s61 offen offset:512 sc1
    s_nop 1
    v_accvgpr_read_b32 v16, a112
    v_accvgpr_read_b32 v17, a113
    v_accvgpr_read_b32 v18, a114
    v_accvgpr_read_b32 v19, a115
    v_accvgpr_read_b32 v20, a116
    v_accvgpr_read_b32 v21, a117
    v_accvgpr_read_b32 v22, a118
    v_accvgpr_read_b32 v23, a119
    v_accvgpr_read_b32 v24, a120
    v_accvgpr_read_b32 v25, a121
    v_accvgpr_read_b32 v26, a122
    v_accvgpr_read_b32 v27, a123
    v_accvgpr_read_b32 v28, a124
    v_accvgpr_read_b32 v29, a125
    v_accvgpr_read_b32 v30, a126
    v_accvgpr_read_b32 v31, a127
    v_cvt_pk_bf16_f32 v32, v16, v17
    v_cvt_pk_bf16_f32 v33, v18, v19
    v_cvt_pk_bf16_f32 v34, v20, v21
    v_cvt_pk_bf16_f32 v35, v22, v23
    v_cvt_pk_bf16_f32 v36, v24, v25
    v_cvt_pk_bf16_f32 v37, v26, v27
    v_cvt_pk_bf16_f32 v38, v28, v29
    v_cvt_pk_bf16_f32 v39, v30, v31
    s_add_u32 s61, s59, 458752
    s_nop 0
    v_permlane32_swap_b32 v32, v34
    v_permlane32_swap_b32 v33, v35
    v_permlane32_swap_b32 v36, v38
    v_permlane32_swap_b32 v37, v39
    buffer_store_dwordx4 v[32:35], v7, s[36:39], s61 offen offset:0 sc1
    buffer_store_dwordx4 v[36:39], v7, s[36:39], s61 offen offset:512 sc1
    s_nop 1
    v_accvgpr_read_b32 v16, a176
    v_accvgpr_read_b32 v17, a177
    v_accvgpr_read_b32 v18, a178
    v_accvgpr_read_b32 v19, a179
    v_accvgpr_read_b32 v20, a180
    v_accvgpr_read_b32 v21, a181
    v_accvgpr_read_b32 v22, a182
    v_accvgpr_read_b32 v23, a183
    v_accvgpr_read_b32 v24, a184
    v_accvgpr_read_b32 v25, a185
    v_accvgpr_read_b32 v26, a186
    v_accvgpr_read_b32 v27, a187
    v_accvgpr_read_b32 v28, a188
    v_accvgpr_read_b32 v29, a189
    v_accvgpr_read_b32 v30, a190
    v_accvgpr_read_b32 v31, a191
    v_cvt_pk_bf16_f32 v32, v16, v17
    v_cvt_pk_bf16_f32 v33, v18, v19
    v_cvt_pk_bf16_f32 v34, v20, v21
    v_cvt_pk_bf16_f32 v35, v22, v23
    v_cvt_pk_bf16_f32 v36, v24, v25
    v_cvt_pk_bf16_f32 v37, v26, v27
    v_cvt_pk_bf16_f32 v38, v28, v29
    v_cvt_pk_bf16_f32 v39, v30, v31
    s_add_u32 s61, s59, 917504
    s_nop 0
    v_permlane32_swap_b32 v32, v34
    v_permlane32_swap_b32 v33, v35
    v_permlane32_swap_b32 v36, v38
    v_permlane32_swap_b32 v37, v39
    buffer_store_dwordx4 v[32:35], v7, s[36:39], s61 offen offset:0 sc1
    buffer_store_dwordx4 v[36:39], v7, s[36:39], s61 offen offset:512 sc1
    s_nop 1
    v_accvgpr_read_b32 v16, a240
    v_accvgpr_read_b32 v17, a241
    v_accvgpr_read_b32 v18, a242
    v_accvgpr_read_b32 v19, a243
    v_accvgpr_read_b32 v20, a244
    v_accvgpr_read_b32 v21, a245
    v_accvgpr_read_b32 v22, a246
    v_accvgpr_read_b32 v23, a247
    v_accvgpr_read_b32 v24, a248
    v_accvgpr_read_b32 v25, a249
    v_accvgpr_read_b32 v26, a250
    v_accvgpr_read_b32 v27, a251
    v_accvgpr_read_b32 v28, a252
    v_accvgpr_read_b32 v29, a253
    v_accvgpr_read_b32 v30, a254
    v_accvgpr_read_b32 v31, a255
    v_cvt_pk_bf16_f32 v32, v16, v17
    v_cvt_pk_bf16_f32 v33, v18, v19
    v_cvt_pk_bf16_f32 v34, v20, v21
    v_cvt_pk_bf16_f32 v35, v22, v23
    v_cvt_pk_bf16_f32 v36, v24, v25
    v_cvt_pk_bf16_f32 v37, v26, v27
    v_cvt_pk_bf16_f32 v38, v28, v29
    v_cvt_pk_bf16_f32 v39, v30, v31
    s_add_u32 s61, s59, 1376256
    s_nop 0
    v_permlane32_swap_b32 v32, v34
    v_permlane32_swap_b32 v33, v35
    v_permlane32_swap_b32 v36, v38
    v_permlane32_swap_b32 v37, v39
    buffer_store_dwordx4 v[32:35], v7, s[36:39], s61 offen offset:0 sc1
    buffer_store_dwordx4 v[36:39], v7, s[36:39], s61 offen offset:512 sc1
    s_nop 1
    s_waitcnt vmcnt(0)
    s_mul_i32 s58, s54, 4
    s_lshr_b32 s58, s58, 2
    s_lshl_b32 s58, s58, 7
    s_add_u32 s58, s58, 24182784
    s_mov_b64 exec, 1
    v_mov_b32 v8, 0
    v_mov_b32 v9, 4
    buffer_atomic_add v9, v8, s[36:39], s58 offen
    s_mov_b64 exec, -1
    s_branch W_NEXT
W_PREP:
    s_sub_u32 s51, s51, 32
    s_cmp_lt_u32 s51, 21
    s_cbranch_scc0 W_PCS
    s_mul_i32 s41, s90, 21
    s_add_u32 s41, s41, s51
    s_barrier
    s_lshl_b32 s41, s41, 2
    s_add_u32 s41, s41, s40
    s_mul_i32 s42, s41, 21400
    s_lshr_b32 s42, s42, 22
    s_mul_i32 s43, s42, 196
    s_sub_u32 s43, s41, s43
    s_cmp_eq_u32 s42, 2
    s_cbranch_scc1 K1_TR_D
    s_mul_i32 s48, s43, 2341
    s_lshr_b32 s48, s48, 16
    s_mul_i32 s49, s48, 28
    s_sub_u32 s49, s43, s49
    s_cmp_eq_u32 s42, 0
    s_cselect_b32 s44, s24, s26
    s_cselect_b32 s45, s25, s27
    s_and_b32 s45, s45, 0xffff
    s_mov_b32 s46, 0x188000
    s_mov_b32 s47, 0x00020000
    s_mov_b32 s50, 3584
    s_mul_i32 s51, s48, 64*3584
    s_lshl_b32 s52, s49, 7
    s_add_u32 s51, s51, s52
    s_mov_b32 s53, 28*1024
    s_lshl_b32 s54, s49, 1
    s_add_u32 s54, s54, s42
    s_mul_i32 s54, s54, 2*28*1024
    s_lshl_b32 s52, s48, 12
    s_add_u32 s54, s54, s52
    s_add_u32 s54, s54, 17825792
    s_branch K1_TR_GO
K1_TR_D:
    s_mul_i32 s48, s43, 9363
    s_lshr_b32 s48, s48, 16
    s_mul_i32 s49, s48, 7
    s_sub_u32 s49, s43, s49
    s_mov_b32 s44, s28
    s_and_b32 s45, s29, 0xffff
    s_mov_b32 s46, 0x188000
    s_mov_b32 s47, 0x00020000
    s_mov_b32 s50, 896
    s_mul_i32 s51, s48, 64*896
    s_lshl_b32 s52, s49, 7
    s_add_u32 s51, s51, s52
    s_mov_b32 s53, 112*1024
    s_mul_i32 s54, s49, 2*112*1024
    s_lshl_b32 s52, s48, 12
    s_add_u32 s54, s54, s52
    s_add_u32 s54, s54, 22020096
K1_TR_GO:
    v_lshrrev_b32 v2, 3, v1
    v_and_b32 v3, 7, v1
    v_mul_lo_u32 v4, v2, s50
    v_lshl_add_u32 v4, v3, 4, v4
    s_mul_i32 s55, s40, 64*144
    v_mul_u32_u24 v5, 144, v2
    v_lshl_add_u32 v5, v3, 4, v5
    v_add_u32 v5, s55, v5
    s_lshl_b32 s56, s50, 3
    buffer_load_dwordx4 v[8:11], v4, s[44:47], s51 offen
    s_add_u32 s51, s51, s56
    buffer_load_dwordx4 v[12:15], v4, s[44:47], s51 offen
    s_add_u32 s51, s51, s56
    buffer_load_dwordx4 v[16:19], v4, s[44:47], s51 offen
    s_add_u32 s51, s51, s56
    buffer_load_dwordx4 v[20:23], v4, s[44:47], s51 offen
    s_add_u32 s51, s51, s56
    buffer_load_dwordx4 v[24:27], v4, s[44:47], s51 offen
    s_add_u32 s51, s51, s56
    buffer_load_dwordx4 v[28:31], v4, s[44:47], s51 offen
    s_add_u32 s51, s51, s56
    buffer_load_dwordx4 v[32:35], v4, s[44:47], s51 offen
    s_add_u32 s51, s51, s56
    buffer_load_dwordx4 v[36:39], v4, s[44:47], s51 offen
    s_waitcnt vmcnt(7)
    ds_write_b128 v5, v[8:11] offset:0
    s_waitcnt vmcnt(6)
    ds_write_b128 v5, v[12:15] offset:1152
    s_waitcnt vmcnt(5)
    ds_write_b128 v5, v[16:19] offset:2304
    s_waitcnt vmcnt(4)
    ds_write_b128 v5, v[20:23] offset:3456
    s_waitcnt vmcnt(3)
    ds_write_b128 v5, v[24:27] offset:4608
    s_waitcnt vmcnt(2)
    ds_write_b128 v5, v[28:31] offset:5760
    s_waitcnt vmcnt(1)
    ds_write_b128 v5, v[32:35] offset:6912
    s_waitcnt vmcnt(0)
    ds_write_b128 v5, v[36:39] offset:8064
    v_and_b32 v2, 15, v1
    v_lshrrev_b32 v3, 4, v1
    v_lshrrev_b32 v6, 2, v2
    v_lshl_add_u32 v6, v3, 3, v6
    v_mul_u32_u24 v6, 144, v6
    v_and_b32 v7, 3, v2
    v_lshl_add_u32 v6, v7, 3, v6
    v_add_u32 v6, s55, v6
    v_lshrrev_b32 v7, 1, v3
    v_lshlrev_b32 v7, 10, v7
    v_and_b32 v8, 1, v3
    v_lshl_add_u32 v7, v8, 9, v7
    v_lshl_add_u32 v7, v2, 4, v7
    s_waitcnt lgkmcnt(0)
    ds_read_b64_tr_b16 v[40:41], v6 offset:0
    ds_read_b64_tr_b16 v[42:43], v6 offset:576
    ds_read_b64_tr_b16 v[44:45], v6 offset:4608
    ds_read_b64_tr_b16 v[46:47], v6 offset:5184
    ds_read_b64_tr_b16 v[48:49], v6 offset:32
    ds_read_b64_tr_b16 v[50:51], v6 offset:608
    ds_read_b64_tr_b16 v[52:53], v6 offset:4640
    ds_read_b64_tr_b16 v[54:55], v6 offset:5216
    ds_read_b64_tr_b16 v[56:57], v6 offset:64
    ds_read_b64_tr_b16 v[58:59], v6 offset:640
    ds_read_b64_tr_b16 v[60:61], v6 offset:4672
    ds_read_b64_tr_b16 v[62:63], v6 offset:5248
    ds_read_b64_tr_b16 v[64:65], v6 offset:96
    ds_read_b64_tr_b16 v[66:67], v6 offset:672
    ds_read_b64_tr_b16 v[68:69], v6 offset:4704
    ds_read_b64_tr_b16 v[70:71], v6 offset:5280
    s_waitcnt lgkmcnt(0)
    buffer_store_dwordx4 v[40:43], v7, s[36:39], s54 offen offset:0 sc1
    buffer_store_dwordx4 v[44:47], v7, s[36:39], s54 offen offset:2048 sc1
    buffer_store_dwordx4 v[48:51], v7, s[36:39], s54 offen offset:256 sc1
    buffer_store_dwordx4 v[52:55], v7, s[36:39], s54 offen offset:2304 sc1
    s_add_u32 s54, s54, s53
    buffer_store_dwordx4 v[56:59], v7, s[36:39], s54 offen offset:0 sc1
    buffer_store_dwordx4 v[60:63], v7, s[36:39], s54 offen offset:2048 sc1
    buffer_store_dwordx4 v[64:67], v7, s[36:39], s54 offen offset:256 sc1
    buffer_store_dwordx4 v[68:71], v7, s[36:39], s54 offen offset:2304 sc1
    s_branch W_PDONE
W_PCS:
    s_sub_u32 s51, s51, 21
    s_lshl_b32 s41, s90, 3
    s_add_u32 s41, s41, s51
    s_barrier
    s_cmp_ge_u32 s41, 28
    s_cselect_b32 s50, 1, 0
    s_cselect_b32 s51, 28, 0
    s_sub_u32 s41, s41, s51
    s_cmp_ge_u32 s41, 14
    s_cselect_b32 s42, 1, 0
    s_cselect_b32 s43, 14, 0
    s_cselect_b32 s44, s26, s24
    s_cselect_b32 s45, s27, s25
    s_sub_u32 s43, s41, s43
    s_and_b32 s45, s45, 0xffff
    s_mov_b32 s46, 0x188000
    s_mov_b32 s47, 0x00020000
    v_lshlrev_b32 v2, 2, v1
    s_lshl_b32 s48, s50, 2
    s_add_u32 s48, s48, s40
    s_mul_i32 s48, s48, 56*3584
    s_lshl_b32 s49, s43, 8
    s_add_u32 s48, s48, s49
    v_mov_b32 v4, 0
    v_mov_b32 v5, 0
    buffer_load_dword v8, v2, s[44:47], s48 offen
    s_add_u32 s48, s48, 3584
    buffer_load_dword v9, v2, s[44:47], s48 offen
    s_add_u32 s48, s48, 3584
    buffer_load_dword v10, v2, s[44:47], s48 offen
    s_add_u32 s48, s48, 3584
    buffer_load_dword v11, v2, s[44:47], s48 offen
    s_add_u32 s48, s48, 3584
    buffer_load_dword v12, v2, s[44:47], s48 offen
    s_add_u32 s48, s48, 3584
    buffer_load_dword v13, v2, s[44:47], s48 offen
    s_add_u32 s48, s48, 3584
    buffer_load_dword v14, v2, s[44:47], s48 offen
    s_add_u32 s48, s48, 3584
    buffer_load_dword v15, v2, s[44:47], s48 offen
    s_add_u32 s48, s48, 3584
    buffer_load_dword v16, v2, s[44:47], s48 offen
    s_add_u32 s48, s48, 3584
    buffer_load_dword v17, v2, s[44:47], s48 offen
    s_add_u32 s48, s48, 3584
    buffer_load_dword v18, v2, s[44:47], s48 offen
    s_add_u32 s48, s48, 3584
    buffer_load_dword v19, v2, s[44:47], s48 offen
    s_add_u32 s48, s48, 3584
    buffer_load_dword v20, v2, s[44:47], s48 offen
    s_add_u32 s48, s48, 3584
    buffer_load_dword v21, v2, s[44:47], s48 offen
    s_add_u32 s48, s48, 3584
    buffer_load_dword v22, v2, s[44:47], s48 offen
    s_add_u32 s48, s48, 3584
    buffer_load_dword v23, v2, s[44:47], s48 offen
    s_add_u32 s48, s48, 3584
    buffer_load_dword v24, v2, s[44:47], s48 offen
    s_add_u32 s48, s48, 3584
    buffer_load_dword v25, v2, s[44:47], s48 offen
    s_add_u32 s48, s48, 3584
    buffer_load_dword v26, v2, s[44:47], s48 offen
    s_add_u32 s48, s48, 3584
    buffer_load_dword v27, v2, s[44:47], s48 offen
    s_add_u32 s48, s48, 3584
    buffer_load_dword v28, v2, s[44:47], s48 offen
    s_add_u32 s48, s48, 3584
    buffer_load_dword v29, v2, s[44:47], s48 offen
    s_add_u32 s48, s48, 3584
    buffer_load_dword v30, v2, s[44:47], s48 offen
    s_add_u32 s48, s48, 3584
    buffer_load_dword v31, v2, s[44:47], s48 offen
    s_add_u32 s48, s48, 3584
    buffer_load_dword v32, v2, s[44:47], s48 offen
    s_add_u32 s48, s48, 3584
    buffer_load_dword v33, v2, s[44:47], s48 offen
    s_add_u32 s48, s48, 3584
    buffer_load_dword v34, v2, s[44:47], s48 offen
    s_add_u32 s48, s48, 3584
    buffer_load_dword v35, v2, s[44:47], s48 offen
    s_add_u32 s48, s48, 3584
    buffer_load_dword v36, v2, s[44:47], s48 offen
    s_add_u32 s48, s48, 3584
    buffer_load_dword v37, v2, s[44:47], s48 offen
    s_add_u32 s48, s48, 3584
    buffer_load_dword v38, v2, s[44:47], s48 offen
    s_add_u32 s48, s48, 3584
    buffer_load_dword v39, v2, s[44:47], s48 offen
    s_add_u32 s48, s48, 3584
    buffer_load_dword v40, v2, s[44:47], s48 offen
    s_add_u32 s48, s48, 3584
    buffer_load_dword v41, v2, s[44:47], s48 offen
    s_add_u32 s48, s48, 3584
    buffer_load_dword v42, v2, s[44:47], s48 offen
    s_add_u32 s48, s48, 3584
    buffer_load_dword v43, v2, s[44:47], s48 offen
    s_add_u32 s48, s48, 3584
    buffer_load_dword v44, v2, s[44:47], s48 offen
    s_add_u32 s48, s48, 3584
    buffer_load_dword v45, v2, s[44:47], s48 offen
    s_add_u32 s48, s48, 3584
    buffer_load_dword v46, v2, s[44:47], s48 offen
    s_add_u32 s48, s48, 3584
    buffer_load_dword v47, v2, s[44:47], s48 offen
    s_add_u32 s48, s48, 3584
    buffer_load_dword v48, v2, s[44:47], s48 offen
    s_add_u32 s48, s48, 3584
    buffer_load_dword v49, v2, s[44:47], s48 offen
    s_add_u32 s48, s48, 3584
    buffer_load_dword v50, v2, s[44:47], s48 offen
    s_add_u32 s48, s48, 3584
    buffer_load_dword v51, v2, s[44:47], s48 offen
    s_add_u32 s48, s48, 3584
    buffer_load_dword v52, v2, s[44:47], s48 offen
    s_add_u32 s48, s48, 3584
    buffer_load_dword v53, v2, s[44:47], s48 offen
    s_add_u32 s48, s48, 3584
    buffer_load_dword v54, v2, s[44:47], s48 offen
    s_add_u32 s48, s48, 3584
    buffer_load_dword v55, v2, s[44:47], s48 offen
    s_add_u32 s48, s48, 3584
    buffer_load_dword v56, v2, s[44:47], s48 offen
    s_add_u32 s48, s48, 3584
    buffer_load_dword v57, v2, s[44:47], s48 offen
    s_add_u32 s48, s48, 3584
    buffer_load_dword v58, v2, s[44:47], s48 offen
    s_add_u32 s48, s48, 3584
    buffer_load_dword v59, v2, s[44:47], s48 offen
    s_add_u32 s48, s48, 3584
    buffer_load_dword v60, v2, s[44:47], s48 offen
    s_add_u32 s48, s48, 3584
    buffer_load_dword v61, v2, s[44:47], s48 offen
    s_add_u32 s48, s48, 3584
    buffer_load_dword v62, v2, s[44:47], s48 offen
    s_add_u32 s48, s48, 3584
    buffer_load_dword v63, v2, s[44:47], s48 offen
    s_add_u32 s48, s48, 3584
    s_waitcnt vmcnt(55)
    v_lshlrev_b32 v6, 16, v8
    v_and_b32 v7, 0xffff0000, v8
    v_add_f32 v4, v4, v6
    v_add_f32 v5, v5, v7
    s_waitcnt vmcnt(54)
    v_lshlrev_b32 v6, 16, v9
    v_and_b32 v7, 0xffff0000, v9
    v_add_f32 v4, v4, v6
    v_add_f32 v5, v5, v7
    s_waitcnt vmcnt(53)
    v_lshlrev_b32 v6, 16, v10
    v_and_b32 v7, 0xffff0000, v10
    v_add_f32 v4, v4, v6
    v_add_f32 v5, v5, v7
    s_waitcnt vmcnt(52)
    v_lshlrev_b32 v6, 16, v11
    v_and_b32 v7, 0xffff0000, v11
    v_add_f32 v4, v4, v6
    v_add_f32 v5, v5, v7
    s_waitcnt vmcnt(51)
    v_lshlrev_b32 v6, 16, v12
    v_and_b32 v7, 0xffff0000, v12
    v_add_f32 v4, v4, v6
    v_add_f32 v5, v5, v7
    s_waitcnt vmcnt(50)
    v_lshlrev_b32 v6, 16, v13
    v_and_b32 v7, 0xffff0000, v13
    v_add_f32 v4, v4, v6
    v_add_f32 v5, v5, v7
    s_waitcnt vmcnt(49)
    v_lshlrev_b32 v6, 16, v14
    v_and_b32 v7, 0xffff0000, v14
    v_add_f32 v4, v4, v6
    v_add_f32 v5, v5, v7
    s_waitcnt vmcnt(48)
    v_lshlrev_b32 v6, 16, v15
    v_and_b32 v7, 0xffff0000, v15
    v_add_f32 v4, v4, v6
    v_add_f32 v5, v5, v7
    s_waitcnt vmcnt(47)
    v_lshlrev_b32 v6, 16, v16
    v_and_b32 v7, 0xffff0000, v16
    v_add_f32 v4, v4, v6
    v_add_f32 v5, v5, v7
    s_waitcnt vmcnt(46)
    v_lshlrev_b32 v6, 16, v17
    v_and_b32 v7, 0xffff0000, v17
    v_add_f32 v4, v4, v6
    v_add_f32 v5, v5, v7
    s_waitcnt vmcnt(45)
    v_lshlrev_b32 v6, 16, v18
    v_and_b32 v7, 0xffff0000, v18
    v_add_f32 v4, v4, v6
    v_add_f32 v5, v5, v7
    s_waitcnt vmcnt(44)
    v_lshlrev_b32 v6, 16, v19
    v_and_b32 v7, 0xffff0000, v19
    v_add_f32 v4, v4, v6
    v_add_f32 v5, v5, v7
    s_waitcnt vmcnt(43)
    v_lshlrev_b32 v6, 16, v20
    v_and_b32 v7, 0xffff0000, v20
    v_add_f32 v4, v4, v6
    v_add_f32 v5, v5, v7
    s_waitcnt vmcnt(42)
    v_lshlrev_b32 v6, 16, v21
    v_and_b32 v7, 0xffff0000, v21
    v_add_f32 v4, v4, v6
    v_add_f32 v5, v5, v7
    s_waitcnt vmcnt(41)
    v_lshlrev_b32 v6, 16, v22
    v_and_b32 v7, 0xffff0000, v22
    v_add_f32 v4, v4, v6
    v_add_f32 v5, v5, v7
    s_waitcnt vmcnt(40)
    v_lshlrev_b32 v6, 16, v23
    v_and_b32 v7, 0xffff0000, v23
    v_add_f32 v4, v4, v6
    v_add_f32 v5, v5, v7
    s_waitcnt vmcnt(39)
    v_lshlrev_b32 v6, 16, v24
    v_and_b32 v7, 0xffff0000, v24
    v_add_f32 v4, v4, v6
    v_add_f32 v5, v5, v7
    s_waitcnt vmcnt(38)
    v_lshlrev_b32 v6, 16, v25
    v_and_b32 v7, 0xffff0000, v25
    v_add_f32 v4, v4, v6
    v_add_f32 v5, v5, v7
    s_waitcnt vmcnt(37)
    v_lshlrev_b32 v6, 16, v26
    v_and_b32 v7, 0xffff0000, v26
    v_add_f32 v4, v4, v6
    v_add_f32 v5, v5, v7
    s_waitcnt vmcnt(36)
    v_lshlrev_b32 v6, 16, v27
    v_and_b32 v7, 0xffff0000, v27
    v_add_f32 v4, v4, v6
    v_add_f32 v5, v5, v7
    s_waitcnt vmcnt(35)
    v_lshlrev_b32 v6, 16, v28
    v_and_b32 v7, 0xffff0000, v28
    v_add_f32 v4, v4, v6
    v_add_f32 v5, v5, v7
    s_waitcnt vmcnt(34)
    v_lshlrev_b32 v6, 16, v29
    v_and_b32 v7, 0xffff0000, v29
    v_add_f32 v4, v4, v6
    v_add_f32 v5, v5, v7
    s_waitcnt vmcnt(33)
    v_lshlrev_b32 v6, 16, v30
    v_and_b32 v7, 0xffff0000, v30
    v_add_f32 v4, v4, v6
    v_add_f32 v5, v5, v7
    s_waitcnt vmcnt(32)
    v_lshlrev_b32 v6, 16, v31
    v_and_b32 v7, 0xffff0000, v31
    v_add_f32 v4, v4, v6
    v_add_f32 v5, v5, v7
    s_waitcnt vmcnt(31)
    v_lshlrev_b32 v6, 16, v32
    v_and_b32 v7, 0xffff0000, v32
    v_add_f32 v4, v4, v6
    v_add_f32 v5, v5, v7
    s_waitcnt vmcnt(30)
    v_lshlrev_b32 v6, 16, v33
    v_and_b32 v7, 0xffff0000, v33
    v_add_f32 v4, v4, v6
    v_add_f32 v5, v5, v7
    s_waitcnt vmcnt(29)
    v_lshlrev_b32 v6, 16, v34
    v_and_b32 v7, 0xffff0000, v34
    v_add_f32 v4, v4, v6
    v_add_f32 v5, v5, v7
    s_waitcnt vmcnt(28)
    v_lshlrev_b32 v6, 16, v35
    v_and_b32 v7, 0xffff0000, v35
    v_add_f32 v4, v4, v6
    v_add_f32 v5, v5, v7
    s_waitcnt vmcnt(27)
    v_lshlrev_b32 v6, 16, v36
    v_and_b32 v7, 0xffff0000, v36
    v_add_f32 v4, v4, v6
    v_add_f32 v5, v5, v7
    s_waitcnt vmcnt(26)
    v_lshlrev_b32 v6, 16, v37
    v_and_b32 v7, 0xffff0000, v37
    v_add_f32 v4, v4, v6
    v_add_f32 v5, v5, v7
    s_waitcnt vmcnt(25)
    v_lshlrev_b32 v6, 16, v38
    v_and_b32 v7, 0xffff0000, v38
    v_add_f32 v4, v4, v6
    v_add_f32 v5, v5, v7
    s_waitcnt vmcnt(24)
    v_lshlrev_b32 v6, 16, v39
    v_and_b32 v7, 0xffff0000, v39
    v_add_f32 v4, v4, v6
    v_add_f32 v5, v5, v7
    s_waitcnt vmcnt(23)
    v_lshlrev_b32 v6, 16, v40
    v_and_b32 v7, 0xffff0000, v40
    v_add_f32 v4, v4, v6
    v_add_f32 v5, v5, v7
    s_waitcnt vmcnt(22)
    v_lshlrev_b32 v6, 16, v41
    v_and_b32 v7, 0xffff0000, v41
    v_add_f32 v4, v4, v6
    v_add_f32 v5, v5, v7
    s_waitcnt vmcnt(21)
    v_lshlrev_b32 v6, 16, v42
    v_and_b32 v7, 0xffff0000, v42
    v_add_f32 v4, v4, v6
    v_add_f32 v5, v5, v7
    s_waitcnt vmcnt(20)
    v_lshlrev_b32 v6, 16, v43
    v_and_b32 v7, 0xffff0000, v43
    v_add_f32 v4, v4, v6
    v_add_f32 v5, v5, v7
    s_waitcnt vmcnt(19)
    v_lshlrev_b32 v6, 16, v44
    v_and_b32 v7, 0xffff0000, v44
    v_add_f32 v4, v4, v6
    v_add_f32 v5, v5, v7
    s_waitcnt vmcnt(18)
    v_lshlrev_b32 v6, 16, v45
    v_and_b32 v7, 0xffff0000, v45
    v_add_f32 v4, v4, v6
    v_add_f32 v5, v5, v7
    s_waitcnt vmcnt(17)
    v_lshlrev_b32 v6, 16, v46
    v_and_b32 v7, 0xffff0000, v46
    v_add_f32 v4, v4, v6
    v_add_f32 v5, v5, v7
    s_waitcnt vmcnt(16)
    v_lshlrev_b32 v6, 16, v47
    v_and_b32 v7, 0xffff0000, v47
    v_add_f32 v4, v4, v6
    v_add_f32 v5, v5, v7
    s_waitcnt vmcnt(15)
    v_lshlrev_b32 v6, 16, v48
    v_and_b32 v7, 0xffff0000, v48
    v_add_f32 v4, v4, v6
    v_add_f32 v5, v5, v7
    s_waitcnt vmcnt(14)
    v_lshlrev_b32 v6, 16, v49
    v_and_b32 v7, 0xffff0000, v49
    v_add_f32 v4, v4, v6
    v_add_f32 v5, v5, v7
    s_waitcnt vmcnt(13)
    v_lshlrev_b32 v6, 16, v50
    v_and_b32 v7, 0xffff0000, v50
    v_add_f32 v4, v4, v6
    v_add_f32 v5, v5, v7
    s_waitcnt vmcnt(12)
    v_lshlrev_b32 v6, 16, v51
    v_and_b32 v7, 0xffff0000, v51
    v_add_f32 v4, v4, v6
    v_add_f32 v5, v5, v7
    s_waitcnt vmcnt(11)
    v_lshlrev_b32 v6, 16, v52
    v_and_b32 v7, 0xffff0000, v52
    v_add_f32 v4, v4, v6
    v_add_f32 v5, v5, v7
    s_waitcnt vmcnt(10)
    v_lshlrev_b32 v6, 16, v53
    v_and_b32 v7, 0xffff0000, v53
    v_add_f32 v4, v4, v6
    v_add_f32 v5, v5, v7
    s_waitcnt vmcnt(9)
    v_lshlrev_b32 v6, 16, v54
    v_and_b32 v7, 0xffff0000, v54
    v_add_f32 v4, v4, v6
    v_add_f32 v5, v5, v7
    s_waitcnt vmcnt(8)
    v_lshlrev_b32 v6, 16, v55
    v_and_b32 v7, 0xffff0000, v55
    v_add_f32 v4, v4, v6
    v_add_f32 v5, v5, v7
    s_waitcnt vmcnt(7)
    v_lshlrev_b32 v6, 16, v56
    v_and_b32 v7, 0xffff0000, v56
    v_add_f32 v4, v4, v6
    v_add_f32 v5, v5, v7
    s_waitcnt vmcnt(6)
    v_lshlrev_b32 v6, 16, v57
    v_and_b32 v7, 0xffff0000, v57
    v_add_f32 v4, v4, v6
    v_add_f32 v5, v5, v7
    s_waitcnt vmcnt(5)
    v_lshlrev_b32 v6, 16, v58
    v_and_b32 v7, 0xffff0000, v58
    v_add_f32 v4, v4, v6
    v_add_f32 v5, v5, v7
    s_waitcnt vmcnt(4)
    v_lshlrev_b32 v6, 16, v59
    v_and_b32 v7, 0xffff0000, v59
    v_add_f32 v4, v4, v6
    v_add_f32 v5, v5, v7
    s_waitcnt vmcnt(3)
    v_lshlrev_b32 v6, 16, v60
    v_and_b32 v7, 0xffff0000, v60
    v_add_f32 v4, v4, v6
    v_add_f32 v5, v5, v7
    s_waitcnt vmcnt(2)
    v_lshlrev_b32 v6, 16, v61
    v_and_b32 v7, 0xffff0000, v61
    v_add_f32 v4, v4, v6
    v_add_f32 v5, v5, v7
    s_waitcnt vmcnt(1)
    v_lshlrev_b32 v6, 16, v62
    v_and_b32 v7, 0xffff0000, v62
    v_add_f32 v4, v4, v6
    v_add_f32 v5, v5, v7
    s_waitcnt vmcnt(0)
    v_lshlrev_b32 v6, 16, v63
    v_and_b32 v7, 0xffff0000, v63
    v_add_f32 v4, v4, v6
    v_add_f32 v5, v5, v7
    v_lshlrev_b32 v6, 3, v0
    ds_write_b64 v6, v[4:5]
    s_waitcnt lgkmcnt(0)
    s_barrier
    s_cmp_eq_u32 s40, 0
    s_cbranch_scc0 K1_CS_END
    ds_read_b64 v[8:9], v6 offset:512
    ds_read_b64 v[10:11], v6 offset:1024
    ds_read_b64 v[12:13], v6 offset:1536
    s_waitcnt lgkmcnt(0)
    v_add_f32 v4, v4, v8
    v_add_f32 v5, v5, v9
    v_add_f32 v4, v4, v10
    v_add_f32 v5, v5, v11
    v_add_f32 v4, v4, v12
    v_add_f32 v5, v5, v13
    v_lshlrev_b32 v6, 1, v1
    v_lshrrev_b32 v7, 6, v6
    v_and_b32 v6, 63, v6
    v_lshl_add_u32 v6, v7, 7, v6
    s_lshl_b32 s49, s43, 8
    s_lshl_b32 s51, s42, 6
    s_add_u32 s49, s49, s51
    v_add_u32 v6, s49, v6
    v_lshlrev_b32 v6, 2, v6
    s_mul_i32 s49, s50, 16384
    s_add_u32 s49, s49, 24117248
    buffer_store_dwordx2 v[4:5], v6, s[36:39], s49 offen sc1
K1_CS_END:
W_PDONE:
    s_waitcnt vmcnt(0)
    s_barrier
    s_cmp_eq_u32 s40, 0
    s_cbranch_scc0 W_NEXT
    s_mov_b64 exec, 1
    s_mov_b32 s58, 24198400
    v_mov_b32 v8, 0
    v_mov_b32 v9, 1
    buffer_atomic_add v9, v8, s[36:39], s58 offen
    s_mov_b64 exec, -1
    s_branch W_NEXT
W_VS:
    s_lshr_b32 s54, s51, 3
    s_and_b32 s53, s51, 7
    s_lshl_b32 s55, s90, 3
    s_add_u32 s55, s55, s53
    s_mul_i32 s56, s54, 4*28*1024
    s_add_u32 s56, s56, 0
    s_mul_i32 s57, s55, 4*28*1024
    s_add_u32 s57, s57, 10616832
    s_mul_i32 s62, s40, 28672
    s_add_u32 s62, s62, s56
    s_mul_i32 s63, s40, 28672
    s_add_u32 s63, s63, s57
    s_mul_i32 s64, s40, 4096
    s_add_u32 s64, s64, 0
    s_mul_i32 s65, s40, 4096
    s_add_u32 s65, s65, 16384
    s_lshr_b32 s60, s40, 1
    s_mul_i32 s60, s60, 8192
    s_add_u32 s60, s60, 0
    v_add_u32 v12, s60, v4
    s_and_b32 s60, s40, 1
    s_mul_i32 s60, s60, 8192
    s_add_u32 s60, s60, 16384
    v_add_u32 v13, s60, v4
    v_add_u32 v14, 32768, v12
    v_add_u32 v15, 32768, v13
    s_barrier
    s_add_u32 m0, s64, 0
    s_add_u32 s60, s62, 0
    buffer_load_dwordx4 v4, s[36:39], s60 offen offset:0 lds
    buffer_load_dwordx4 v4, s[36:39], s60 offen offset:1024 lds
    buffer_load_dwordx4 v4, s[36:39], s60 offen offset:2048 lds
    buffer_load_dwordx4 v4, s[36:39], s60 offen offset:3072 lds
    s_add_u32 m0, s65, 0
    s_add_u32 s60, s63, 0
    buffer_load_dwordx4 v4, s[36:39], s60 offen offset:0 lds
    buffer_load_dwordx4 v4, s[36:39], s60 offen offset:1024 lds
    buffer_load_dwordx4 v4, s[36:39], s60 offen offset:2048 lds
    buffer_load_dwordx4 v4, s[36:39], s60 offen offset:3072 lds
    s_waitcnt vmcnt(0)
    s_barrier
    ds_read_b128 v[16:19], v12 offset:0
    ds_read_b128 v[20:23], v12 offset:4096
    ds_read_b128 v[32:35], v13 offset:0
    ds_read_b128 v[36:39], v13 offset:4096
    s_add_u32 m0, s64, 32768
    s_add_u32 s60, s62, 4096
    buffer_load_dwordx4 v4, s[36:39], s60 offen offset:0 lds
    buffer_load_dwordx4 v4, s[36:39], s60 offen offset:1024 lds
    buffer_load_dwordx4 v4, s[36:39], s60 offen offset:2048 lds
    buffer_load_dwordx4 v4, s[36:39], s60 offen offset:3072 lds
    s_add_u32 m0, s65, 32768
    s_add_u32 s60, s63, 4096
    buffer_load_dwordx4 v4, s[36:39], s60 offen offset:0 lds
    buffer_load_dwordx4 v4, s[36:39], s60 offen offset:1024 lds
    buffer_load_dwordx4 v4, s[36:39], s60 offen offset:2048 lds
    buffer_load_dwordx4 v4, s[36:39], s60 offen offset:3072 lds
    ds_read_b128 v[24:27], v12 offset:1024
    ds_read_b128 v[28:31], v12 offset:5120
    ds_read_b128 v[40:43], v13 offset:1024
    ds_read_b128 v[44:47], v13 offset:5120
    s_waitcnt lgkmcnt(4)
    v_mfma_f32_32x32x16_bf16 a[0:15], v[16:19], v[32:35], 0
    v_mfma_f32_32x32x16_bf16 a[16:31], v[16:19], v[36:39], 0
    v_mfma_f32_32x32x16_bf16 a[32:47], v[20:23], v[32:35], 0
    v_mfma_f32_32x32x16_bf16 a[48:63], v[20:23], v[36:39], 0
    ds_read_b128 v[16:19], v12 offset:2048
    ds_read_b128 v[20:23], v12 offset:6144
    ds_read_b128 v[32:35], v13 offset:2048
    ds_read_b128 v[36:39], v13 offset:6144
    s_waitcnt lgkmcnt(4)
    v_mfma_f32_32x32x16_bf16 a[0:15], v[24:27], v[40:43], a[0:15]
    v_mfma_f32_32x32x16_bf16 a[16:31], v[24:27], v[44:47], a[16:31]
    v_mfma_f32_32x32x16_bf16 a[32:47], v[28:31], v[40:43], a[32:47]
    v_mfma_f32_32x32x16_bf16 a[48:63], v[28:31], v[44:47], a[48:63]
    ds_read_b128 v[24:27], v12 offset:3072
    ds_read_b128 v[28:31], v12 offset:7168
    ds_read_b128 v[40:43], v13 offset:3072
    ds_read_b128 v[44:47], v13 offset:7168
    s_waitcnt lgkmcnt(4)
    v_mfma_f32_32x32x16_bf16 a[0:15], v[16:19], v[32:35], a[0:15]
    v_mfma_f32_32x32x16_bf16 a[16:31], v[16:19], v[36:39], a[16:31]
    v_mfma_f32_32x32x16_bf16 a[32:47], v[20:23], v[32:35], a[32:47]
    v_mfma_f32_32x32x16_bf16 a[48:63], v[20:23], v[36:39], a[48:63]
    s_waitcnt lgkmcnt(0)
    v_mfma_f32_32x32x16_bf16 a[0:15], v[24:27], v[40:43], a[0:15]
    v_mfma_f32_32x32x16_bf16 a[16:31], v[24:27], v[44:47], a[16:31]
    v_mfma_f32_32x32x16_bf16 a[32:47], v[28:31], v[40:43], a[32:47]
    v_mfma_f32_32x32x16_bf16 a[48:63], v[28:31], v[44:47], a[48:63]
    s_waitcnt vmcnt(0)
    s_barrier
    ds_read_b128 v[16:19], v14 offset:0
    ds_read_b128 v[20:23], v14 offset:4096
    ds_read_b128 v[32:35], v15 offset:0
    ds_read_b128 v[36:39], v15 offset:4096
    s_add_u32 m0, s64, 0
    s_add_u32 s60, s62, 8192
    buffer_load_dwordx4 v4, s[36:39], s60 offen offset:0 lds
    buffer_load_dwordx4 v4, s[36:39], s60 offen offset:1024 lds
    buffer_load_dwordx4 v4, s[36:39], s60 offen offset:2048 lds
    buffer_load_dwordx4 v4, s[36:39], s60 offen offset:3072 lds
    s_add_u32 m0, s65, 0
    s_add_u32 s60, s63, 8192
    buffer_load_dwordx4 v4, s[36:39], s60 offen offset:0 lds
    buffer_load_dwordx4 v4, s[36:39], s60 offen offset:1024 lds
    buffer_load_dwordx4 v4, s[36:39], s60 offen offset:2048 lds
    buffer_load_dwordx4 v4, s[36:39], s60 offen offset:3072 lds
    ds_read_b128 v[24:27], v14 offset:1024
    ds_read_b128 v[28:31], v14 offset:5120
    ds_read_b128 v[40:43], v15 offset:1024
    ds_read_b128 v[44:47], v15 offset:5120
    s_waitcnt lgkmcnt(4)
    v_mfma_f32_32x32x16_bf16 a[0:15], v[16:19], v[32:35], a[0:15]
    v_mfma_f32_32x32x16_bf16 a[16:31], v[16:19], v[36:39], a[16:31]
    v_mfma_f32_32x32x16_bf16 a[32:47], v[20:23], v[32:35], a[32:47]
    v_mfma_f32_32x32x16_bf16 a[48:63], v[20:23], v[36:39], a[48:63]
    ds_read_b128 v[16:19], v14 offset:2048
    ds_read_b128 v[20:23], v14 offset:6144
    ds_read_b128 v[32:35], v15 offset:2048
    ds_read_b128 v[36:39], v15 offset:6144
    s_waitcnt lgkmcnt(4)
    v_mfma_f32_32x32x16_bf16 a[0:15], v[24:27], v[40:43], a[0:15]
    v_mfma_f32_32x32x16_bf16 a[16:31], v[24:27], v[44:47], a[16:31]
    v_mfma_f32_32x32x16_bf16 a[32:47], v[28:31], v[40:43], a[32:47]
    v_mfma_f32_32x32x16_bf16 a[48:63], v[28:31], v[44:47], a[48:63]
    ds_read_b128 v[24:27], v14 offset:3072
    ds_read_b128 v[28:31], v14 offset:7168
    ds_read_b128 v[40:43], v15 offset:3072
    ds_read_b128 v[44:47], v15 offset:7168
    s_waitcnt lgkmcnt(4)
    v_mfma_f32_32x32x16_bf16 a[0:15], v[16:19], v[32:35], a[0:15]
    v_mfma_f32_32x32x16_bf16 a[16:31], v[16:19], v[36:39], a[16:31]
    v_mfma_f32_32x32x16_bf16 a[32:47], v[20:23], v[32:35], a[32:47]
    v_mfma_f32_32x32x16_bf16 a[48:63], v[20:23], v[36:39], a[48:63]
    s_waitcnt lgkmcnt(0)
    v_mfma_f32_32x32x16_bf16 a[0:15], v[24:27], v[40:43], a[0:15]
    v_mfma_f32_32x32x16_bf16 a[16:31], v[24:27], v[44:47], a[16:31]
    v_mfma_f32_32x32x16_bf16 a[32:47], v[28:31], v[40:43], a[32:47]
    v_mfma_f32_32x32x16_bf16 a[48:63], v[28:31], v[44:47], a[48:63]
    s_waitcnt vmcnt(0)
    s_barrier
    ds_read_b128 v[16:19], v12 offset:0
    ds_read_b128 v[20:23], v12 offset:4096
    ds_read_b128 v[32:35], v13 offset:0
    ds_read_b128 v[36:39], v13 offset:4096
    s_add_u32 m0, s64, 32768
    s_add_u32 s60, s62, 12288
    buffer_load_dwordx4 v4, s[36:39], s60 offen offset:0 lds
    buffer_load_dwordx4 v4, s[36:39], s60 offen offset:1024 lds
    buffer_load_dwordx4 v4, s[36:39], s60 offen offset:2048 lds
    buffer_load_dwordx4 v4, s[36:39], s60 offen offset:3072 lds
    s_add_u32 m0, s65, 32768
    s_add_u32 s60, s63, 12288
    buffer_load_dwordx4 v4, s[36:39], s60 offen offset:0 lds
    buffer_load_dwordx4 v4, s[36:39], s60 offen offset:1024 lds
    buffer_load_dwordx4 v4, s[36:39], s60 offen offset:2048 lds
    buffer_load_dwordx4 v4, s[36:39], s60 offen offset:3072 lds
    ds_read_b128 v[24:27], v12 offset:1024
    ds_read_b128 v[28:31], v12 offset:5120
    ds_read_b128 v[40:43], v13 offset:1024
    ds_read_b128 v[44:47], v13 offset:5120
    s_waitcnt lgkmcnt(4)
    v_mfma_f32_32x32x16_bf16 a[0:15], v[16:19], v[32:35], a[0:15]
    v_mfma_f32_32x32x16_bf16 a[16:31], v[16:19], v[36:39], a[16:31]
    v_mfma_f32_32x32x16_bf16 a[32:47], v[20:23], v[32:35], a[32:47]
    v_mfma_f32_32x32x16_bf16 a[48:63], v[20:23], v[36:39], a[48:63]
    ds_read_b128 v[16:19], v12 offset:2048
    ds_read_b128 v[20:23], v12 offset:6144
    ds_read_b128 v[32:35], v13 offset:2048
    ds_read_b128 v[36:39], v13 offset:6144
    s_waitcnt lgkmcnt(4)
    v_mfma_f32_32x32x16_bf16 a[0:15], v[24:27], v[40:43], a[0:15]
    v_mfma_f32_32x32x16_bf16 a[16:31], v[24:27], v[44:47], a[16:31]
    v_mfma_f32_32x32x16_bf16 a[32:47], v[28:31], v[40:43], a[32:47]
    v_mfma_f32_32x32x16_bf16 a[48:63], v[28:31], v[44:47], a[48:63]
    ds_read_b128 v[24:27], v12 offset:3072
    ds_read_b128 v[28:31], v12 offset:7168
    ds_read_b128 v[40:43], v13 offset:3072
    ds_read_b128 v[44:47], v13 offset:7168
    s_waitcnt lgkmcnt(4)
    v_mfma_f32_32x32x16_bf16 a[0:15], v[16:19], v[32:35], a[0:15]
    v_mfma_f32_32x32x16_bf16 a[16:31], v[16:19], v[36:39], a[16:31]
    v_mfma_f32_32x32x16_bf16 a[32:47], v[20:23], v[32:35], a[32:47]
    v_mfma_f32_32x32x16_bf16 a[48:63], v[20:23], v[36:39], a[48:63]
    s_waitcnt lgkmcnt(0)
    v_mfma_f32_32x32x16_bf16 a[0:15], v[24:27], v[40:43], a[0:15]
    v_mfma_f32_32x32x16_bf16 a[16:31], v[24:27], v[44:47], a[16:31]
    v_mfma_f32_32x32x16_bf16 a[32:47], v[28:31], v[40:43], a[32:47]
    v_mfma_f32_32x32x16_bf16 a[48:63], v[28:31], v[44:47], a[48:63]
    s_waitcnt vmcnt(0)
    s_barrier
    ds_read_b128 v[16:19], v14 offset:0
    ds_read_b128 v[20:23], v14 offset:4096
    ds_read_b128 v[32:35], v15 offset:0
    ds_read_b128 v[36:39], v15 offset:4096
    s_add_u32 m0, s64, 0
    s_add_u32 s60, s62, 16384
    buffer_load_dwordx4 v4, s[36:39], s60 offen offset:0 lds
    buffer_load_dwordx4 v4, s[36:39], s60 offen offset:1024 lds
    buffer_load_dwordx4 v4, s[36:39], s60 offen offset:2048 lds
    buffer_load_dwordx4 v4, s[36:39], s60 offen offset:3072 lds
    s_add_u32 m0, s65, 0
    s_add_u32 s60, s63, 16384
    buffer_load_dwordx4 v4, s[36:39], s60 offen offset:0 lds
    buffer_load_dwordx4 v4, s[36:39], s60 offen offset:1024 lds
    buffer_load_dwordx4 v4, s[36:39], s60 offen offset:2048 lds
    buffer_load_dwordx4 v4, s[36:39], s60 offen offset:3072 lds
    ds_read_b128 v[24:27], v14 offset:1024
    ds_read_b128 v[28:31], v14 offset:5120
    ds_read_b128 v[40:43], v15 offset:1024
    ds_read_b128 v[44:47], v15 offset:5120
    s_waitcnt lgkmcnt(4)
    v_mfma_f32_32x32x16_bf16 a[0:15], v[16:19], v[32:35], a[0:15]
    v_mfma_f32_32x32x16_bf16 a[16:31], v[16:19], v[36:39], a[16:31]
    v_mfma_f32_32x32x16_bf16 a[32:47], v[20:23], v[32:35], a[32:47]
    v_mfma_f32_32x32x16_bf16 a[48:63], v[20:23], v[36:39], a[48:63]
    ds_read_b128 v[16:19], v14 offset:2048
    ds_read_b128 v[20:23], v14 offset:6144
    ds_read_b128 v[32:35], v15 offset:2048
    ds_read_b128 v[36:39], v15 offset:6144
    s_waitcnt lgkmcnt(4)
    v_mfma_f32_32x32x16_bf16 a[0:15], v[24:27], v[40:43], a[0:15]
    v_mfma_f32_32x32x16_bf16 a[16:31], v[24:27], v[44:47], a[16:31]
    v_mfma_f32_32x32x16_bf16 a[32:47], v[28:31], v[40:43], a[32:47]
    v_mfma_f32_32x32x16_bf16 a[48:63], v[28:31], v[44:47], a[48:63]
    ds_read_b128 v[24:27], v14 offset:3072
    ds_read_b128 v[28:31], v14 offset:7168
    ds_read_b128 v[40:43], v15 offset:3072
    ds_read_b128 v[44:47], v15 offset:7168
    s_waitcnt lgkmcnt(4)
    v_mfma_f32_32x32x16_bf16 a[0:15], v[16:19], v[32:35], a[0:15]
    v_mfma_f32_32x32x16_bf16 a[16:31], v[16:19], v[36:39], a[16:31]
    v_mfma_f32_32x32x16_bf16 a[32:47], v[20:23], v[32:35], a[32:47]
    v_mfma_f32_32x32x16_bf16 a[48:63], v[20:23], v[36:39], a[48:63]
    s_waitcnt lgkmcnt(0)
    v_mfma_f32_32x32x16_bf16 a[0:15], v[24:27], v[40:43], a[0:15]
    v_mfma_f32_32x32x16_bf16 a[16:31], v[24:27], v[44:47], a[16:31]
    v_mfma_f32_32x32x16_bf16 a[32:47], v[28:31], v[40:43], a[32:47]
    v_mfma_f32_32x32x16_bf16 a[48:63], v[28:31], v[44:47], a[48:63]
    s_waitcnt vmcnt(0)
    s_barrier
    ds_read_b128 v[16:19], v12 offset:0
    ds_read_b128 v[20:23], v12 offset:4096
    ds_read_b128 v[32:35], v13 offset:0
    ds_read_b128 v[36:39], v13 offset:4096
    s_add_u32 m0, s64, 32768
    s_add_u32 s60, s62, 20480
    buffer_load_dwordx4 v4, s[36:39], s60 offen offset:0 lds
    buffer_load_dwordx4 v4, s[36:39], s60 offen offset:1024 lds
    buffer_load_dwordx4 v4, s[36:39], s60 offen offset:2048 lds
    buffer_load_dwordx4 v4, s[36:39], s60 offen offset:3072 lds
    s_add_u32 m0, s65, 32768
    s_add_u32 s60, s63, 20480
    buffer_load_dwordx4 v4, s[36:39], s60 offen offset:0 lds
    buffer_load_dwordx4 v4, s[36:39], s60 offen offset:1024 lds
    buffer_load_dwordx4 v4, s[36:39], s60 offen offset:2048 lds
    buffer_load_dwordx4 v4, s[36:39], s60 offen offset:3072 lds
    ds_read_b128 v[24:27], v12 offset:1024
    ds_read_b128 v[28:31], v12 offset:5120
    ds_read_b128 v[40:43], v13 offset:1024
    ds_read_b128 v[44:47], v13 offset:5120
    s_waitcnt lgkmcnt(4)
    v_mfma_f32_32x32x16_bf16 a[0:15], v[16:19], v[32:35], a[0:15]
    v_mfma_f32_32x32x16_bf16 a[16:31], v[16:19], v[36:39], a[16:31]
    v_mfma_f32_32x32x16_bf16 a[32:47], v[20:23], v[32:35], a[32:47]
    v_mfma_f32_32x32x16_bf16 a[48:63], v[20:23], v[36:39], a[48:63]
    ds_read_b128 v[16:19], v12 offset:2048
    ds_read_b128 v[20:23], v12 offset:6144
    ds_read_b128 v[32:35], v13 offset:2048
    ds_read_b128 v[36:39], v13 offset:6144
    s_waitcnt lgkmcnt(4)
    v_mfma_f32_32x32x16_bf16 a[0:15], v[24:27], v[40:43], a[0:15]
    v_mfma_f32_32x32x16_bf16 a[16:31], v[24:27], v[44:47], a[16:31]
    v_mfma_f32_32x32x16_bf16 a[32:47], v[28:31], v[40:43], a[32:47]
    v_mfma_f32_32x32x16_bf16 a[48:63], v[28:31], v[44:47], a[48:63]
    ds_read_b128 v[24:27], v12 offset:3072
    ds_read_b128 v[28:31], v12 offset:7168
    ds_read_b128 v[40:43], v13 offset:3072
    ds_read_b128 v[44:47], v13 offset:7168
    s_waitcnt lgkmcnt(4)
    v_mfma_f32_32x32x16_bf16 a[0:15], v[16:19], v[32:35], a[0:15]
    v_mfma_f32_32x32x16_bf16 a[16:31], v[16:19], v[36:39], a[16:31]
    v_mfma_f32_32x32x16_bf16 a[32:47], v[20:23], v[32:35], a[32:47]
    v_mfma_f32_32x32x16_bf16 a[48:63], v[20:23], v[36:39], a[48:63]
    s_waitcnt lgkmcnt(0)
    v_mfma_f32_32x32x16_bf16 a[0:15], v[24:27], v[40:43], a[0:15]
    v_mfma_f32_32x32x16_bf16 a[16:31], v[24:27], v[44:47], a[16:31]
    v_mfma_f32_32x32x16_bf16 a[32:47], v[28:31], v[40:43], a[32:47]
    v_mfma_f32_32x32x16_bf16 a[48:63], v[28:31], v[44:47], a[48:63]
    s_waitcnt vmcnt(0)
    s_barrier
    ds_read_b128 v[16:19], v14 offset:0
    ds_read_b128 v[20:23], v14 offset:4096
    ds_read_b128 v[32:35], v15 offset:0
    ds_read_b128 v[36:39], v15 offset:4096
    s_add_u32 m0, s64, 0
    s_add_u32 s60, s62, 24576
    buffer_load_dwordx4 v4, s[36:39], s60 offen offset:0 lds
    buffer_load_dwordx4 v4, s[36:39], s60 offen offset:1024 lds
    buffer_load_dwordx4 v4, s[36:39], s60 offen offset:2048 lds
    buffer_load_dwordx4 v4, s[36:39], s60 offen offset:3072 lds
    s_add_u32 m0, s65, 0
    s_add_u32 s60, s63, 24576
    buffer_load_dwordx4 v4, s[36:39], s60 offen offset:0 lds
    buffer_load_dwordx4 v4, s[36:39], s60 offen offset:1024 lds
    buffer_load_dwordx4 v4, s[36:39], s60 offen offset:2048 lds
    buffer_load_dwordx4 v4, s[36:39], s60 offen offset:3072 lds
    ds_read_b128 v[24:27], v14 offset:1024
    ds_read_b128 v[28:31], v14 offset:5120
    ds_read_b128 v[40:43], v15 offset:1024
    ds_read_b128 v[44:47], v15 offset:5120
    s_waitcnt lgkmcnt(4)
    v_mfma_f32_32x32x16_bf16 a[0:15], v[16:19], v[32:35], a[0:15]
    v_mfma_f32_32x32x16_bf16 a[16:31], v[16:19], v[36:39], a[16:31]
    v_mfma_f32_32x32x16_bf16 a[32:47], v[20:23], v[32:35], a[32:47]
    v_mfma_f32_32x32x16_bf16 a[48:63], v[20:23], v[36:39], a[48:63]
    ds_read_b128 v[16:19], v14 offset:2048
    ds_read_b128 v[20:23], v14 offset:6144
    ds_read_b128 v[32:35], v15 offset:2048
    ds_read_b128 v[36:39], v15 offset:6144
    s_waitcnt lgkmcnt(4)
    v_mfma_f32_32x32x16_bf16 a[0:15], v[24:27], v[40:43], a[0:15]
    v_mfma_f32_32x32x16_bf16 a[16:31], v[24:27], v[44:47], a[16:31]
    v_mfma_f32_32x32x16_bf16 a[32:47], v[28:31], v[40:43], a[32:47]
    v_mfma_f32_32x32x16_bf16 a[48:63], v[28:31], v[44:47], a[48:63]
    ds_read_b128 v[24:27], v14 offset:3072
    ds_read_b128 v[28:31], v14 offset:7168
    ds_read_b128 v[40:43], v15 offset:3072
    ds_read_b128 v[44:47], v15 offset:7168
    s_waitcnt lgkmcnt(4)
    v_mfma_f32_32x32x16_bf16 a[0:15], v[16:19], v[32:35], a[0:15]
    v_mfma_f32_32x32x16_bf16 a[16:31], v[16:19], v[36:39], a[16:31]
    v_mfma_f32_32x32x16_bf16 a[32:47], v[20:23], v[32:35], a[32:47]
    v_mfma_f32_32x32x16_bf16 a[48:63], v[20:23], v[36:39], a[48:63]
    s_waitcnt lgkmcnt(0)
    v_mfma_f32_32x32x16_bf16 a[0:15], v[24:27], v[40:43], a[0:15]
    v_mfma_f32_32x32x16_bf16 a[16:31], v[24:27], v[44:47], a[16:31]
    v_mfma_f32_32x32x16_bf16 a[32:47], v[28:31], v[40:43], a[32:47]
    v_mfma_f32_32x32x16_bf16 a[48:63], v[28:31], v[44:47], a[48:63]
    s_waitcnt vmcnt(0)
    s_barrier
    ds_read_b128 v[16:19], v12 offset:0
    ds_read_b128 v[20:23], v12 offset:4096
    ds_read_b128 v[32:35], v13 offset:0
    ds_read_b128 v[36:39], v13 offset:4096
    ds_read_b128 v[24:27], v12 offset:1024
    ds_read_b128 v[28:31], v12 offset:5120
    ds_read_b128 v[40:43], v13 offset:1024
    ds_read_b128 v[44:47], v13 offset:5120
    s_waitcnt lgkmcnt(4)
    v_mfma_f32_32x32x16_bf16 a[0:15], v[16:19], v[32:35], a[0:15]
    v_mfma_f32_32x32x16_bf16 a[16:31], v[16:19], v[36:39], a[16:31]
    v_mfma_f32_32x32x16_bf16 a[32:47], v[20:23], v[32:35], a[32:47]
    v_mfma_f32_32x32x16_bf16 a[48:63], v[20:23], v[36:39], a[48:63]
    ds_read_b128 v[16:19], v12 offset:2048
    ds_read_b128 v[20:23], v12 offset:6144
    ds_read_b128 v[32:35], v13 offset:2048
    ds_read_b128 v[36:39], v13 offset:6144
    s_waitcnt lgkmcnt(4)
    v_mfma_f32_32x32x16_bf16 a[0:15], v[24:27], v[40:43], a[0:15]
    v_mfma_f32_32x32x16_bf16 a[16:31], v[24:27], v[44:47], a[16:31]
    v_mfma_f32_32x32x16_bf16 a[32:47], v[28:31], v[40:43], a[32:47]
    v_mfma_f32_32x32x16_bf16 a[48:63], v[28:31], v[44:47], a[48:63]
    ds_read_b128 v[24:27], v12 offset:3072
    ds_read_b128 v[28:31], v12 offset:7168
    ds_read_b128 v[40:43], v13 offset:3072
    ds_read_b128 v[44:47], v13 offset:7168
    s_waitcnt lgkmcnt(4)
    v_mfma_f32_32x32x16_bf16 a[0:15], v[16:19], v[32:35], a[0:15]
    v_mfma_f32_32x32x16_bf16 a[16:31], v[16:19], v[36:39], a[16:31]
    v_mfma_f32_32x32x16_bf16 a[32:47], v[20:23], v[32:35], a[32:47]
    v_mfma_f32_32x32x16_bf16 a[48:63], v[20:23], v[36:39], a[48:63]
    s_waitcnt lgkmcnt(0)
    v_mfma_f32_32x32x16_bf16 a[0:15], v[24:27], v[40:43], a[0:15]
    v_mfma_f32_32x32x16_bf16 a[16:31], v[24:27], v[44:47], a[16:31]
    v_mfma_f32_32x32x16_bf16 a[32:47], v[28:31], v[40:43], a[32:47]
    v_mfma_f32_32x32x16_bf16 a[48:63], v[28:31], v[44:47], a[48:63]
    s_lshr_b32 s59, s54, 0
    s_lshl_b32 s54, s54, 1
    s_lshr_b32 s58, s40, 1
    s_add_u32 s54, s54, s58
    s_lshl_b32 s55, s55, 1
    s_and_b32 s58, s40, 1
    s_add_u32 s55, s55, s58
    v_and_b32 v7, 15, v2
    v_lshl_add_u32 v7, v3, 4, v7
    v_lshlrev_b32 v7, 4, v7
    v_lshl_add_u32 v7, v5, 10, v7
    s_nop 7
    s_nop 7
    s_mul_i32 s58, s55, 2
    s_add_u32 s58, s58, 0
    s_mul_i32 s59, s58, 4682
    s_lshr_b32 s59, s59, 16
    s_mul_i32 s61, s59, 14
    s_sub_u32 s61, s58, s61
    s_mul_i32 s59, s59, 28
    s_lshl_b32 s61, s61, 1
    s_add_u32 s59, s59, s61
    s_mul_i32 s61, s54, 896
    s_add_u32 s59, s59, s61
    s_lshl_b32 s59, s59, 10
    s_add_u32 s59, s59, 83886080
    v_accvgpr_read_b32 v16, a0
    v_accvgpr_read_b32 v17, a1
    v_accvgpr_read_b32 v18, a2
    v_accvgpr_read_b32 v19, a3
    v_accvgpr_read_b32 v20, a4
    v_accvgpr_read_b32 v21, a5
    v_accvgpr_read_b32 v22, a6
    v_accvgpr_read_b32 v23, a7
    v_accvgpr_read_b32 v24, a8
    v_accvgpr_read_b32 v25, a9
    v_accvgpr_read_b32 v26, a10
    v_accvgpr_read_b32 v27, a11
    v_accvgpr_read_b32 v28, a12
    v_accvgpr_read_b32 v29, a13
    v_accvgpr_read_b32 v30, a14
    v_accvgpr_read_b32 v31, a15
    v_cvt_pk_bf16_f32 v32, v16, v17
    v_cvt_pk_bf16_f32 v33, v18, v19
    v_cvt_pk_bf16_f32 v34, v20, v21
    v_cvt_pk_bf16_f32 v35, v22, v23
    v_cvt_pk_bf16_f32 v36, v24, v25
    v_cvt_pk_bf16_f32 v37, v26, v27
    v_cvt_pk_bf16_f32 v38, v28, v29
    v_cvt_pk_bf16_f32 v39, v30, v31
    s_add_u32 s61, s59, 0
    s_nop 0
    v_permlane32_swap_b32 v32, v34
    v_permlane32_swap_b32 v33, v35
    v_permlane32_swap_b32 v36, v38
    v_permlane32_swap_b32 v37, v39
    buffer_store_dwordx4 v[32:35], v7, s[36:39], s61 offen offset:0 sc1
    buffer_store_dwordx4 v[36:39], v7, s[36:39], s61 offen offset:512 sc1
    s_nop 1
    v_accvgpr_read_b32 v16, a32
    v_accvgpr_read_b32 v17, a33
    v_accvgpr_read_b32 v18, a34
    v_accvgpr_read_b32 v19, a35
    v_accvgpr_read_b32 v20, a36
    v_accvgpr_read_b32 v21, a37
    v_accvgpr_read_b32 v22, a38
    v_accvgpr_read_b32 v23, a39
    v_accvgpr_read_b32 v24, a40
    v_accvgpr_read_b32 v25, a41
    v_accvgpr_read_b32 v26, a42
    v_accvgpr_read_b32 v27, a43
    v_accvgpr_read_b32 v28, a44
    v_accvgpr_read_b32 v29, a45
    v_accvgpr_read_b32 v30, a46
    v_accvgpr_read_b32 v31, a47
    v_cvt_pk_bf16_f32 v32, v16, v17
    v_cvt_pk_bf16_f32 v33, v18, v19
    v_cvt_pk_bf16_f32 v34, v20, v21
    v_cvt_pk_bf16_f32 v35, v22, v23
    v_cvt_pk_bf16_f32 v36, v24, v25
    v_cvt_pk_bf16_f32 v37, v26, v27
    v_cvt_pk_bf16_f32 v38, v28, v29
    v_cvt_pk_bf16_f32 v39, v30, v31
    s_add_u32 s61, s59, 458752
    s_nop 0
    v_permlane32_swap_b32 v32, v34
    v_permlane32_swap_b32 v33, v35
    v_permlane32_swap_b32 v36, v38
    v_permlane32_swap_b32 v37, v39
    buffer_store_dwordx4 v[32:35], v7, s[36:39], s61 offen offset:0 sc1
    buffer_store_dwordx4 v[36:39], v7, s[36:39], s61 offen offset:512 sc1
    s_nop 1
    s_mul_i32 s58, s55, 2
    s_add_u32 s58, s58, 1
    s_mul_i32 s59, s58, 4682
    s_lshr_b32 s59, s59, 16
    s_mul_i32 s61, s59, 14
    s_sub_u32 s61, s58, s61
    s_mul_i32 s59, s59, 28
    s_lshl_b32 s61, s61, 1
    s_add_u32 s59, s59, s61
    s_mul_i32 s61, s54, 896
    s_add_u32 s59, s59, s61
    s_lshl_b32 s59, s59, 10
    s_add_u32 s59, s59, 83886080
    v_accvgpr_read_b32 v16, a16
    v_accvgpr_read_b32 v17, a17
    v_accvgpr_read_b32 v18, a18
    v_accvgpr_read_b32 v19, a19
    v_accvgpr_read_b32 v20, a20
    v_accvgpr_read_b32 v21, a21
    v_accvgpr_read_b32 v22, a22
    v_accvgpr_read_b32 v23, a23
    v_accvgpr_read_b32 v24, a24
    v_accvgpr_read_b32 v25, a25
    v_accvgpr_read_b32 v26, a26
    v_accvgpr_read_b32 v27, a27
    v_accvgpr_read_b32 v28, a28
    v_accvgpr_read_b32 v29, a29
    v_accvgpr_read_b32 v30, a30
    v_accvgpr_read_b32 v31, a31
    v_cvt_pk_bf16_f32 v32, v16, v17
    v_cvt_pk_bf16_f32 v33, v18, v19
    v_cvt_pk_bf16_f32 v34, v20, v21
    v_cvt_pk_bf16_f32 v35, v22, v23
    v_cvt_pk_bf16_f32 v36, v24, v25
    v_cvt_pk_bf16_f32 v37, v26, v27
    v_cvt_pk_bf16_f32 v38, v28, v29
    v_cvt_pk_bf16_f32 v39, v30, v31
    s_add_u32 s61, s59, 0
    s_nop 0
    v_permlane32_swap_b32 v32, v34
    v_permlane32_swap_b32 v33, v35
    v_permlane32_swap_b32 v36, v38
    v_permlane32_swap_b32 v37, v39
    buffer_store_dwordx4 v[32:35], v7, s[36:39], s61 offen offset:0 sc1
    buffer_store_dwordx4 v[36:39], v7, s[36:39], s61 offen offset:512 sc1
    s_nop 1
    v_accvgpr_read_b32 v16, a48
    v_accvgpr_read_b32 v17, a49
    v_accvgpr_read_b32 v18, a50
    v_accvgpr_read_b32 v19, a51
    v_accvgpr_read_b32 v20, a52
    v_accvgpr_read_b32 v21, a53
    v_accvgpr_read_b32 v22, a54
    v_accvgpr_read_b32 v23, a55
    v_accvgpr_read_b32 v24, a56
    v_accvgpr_read_b32 v25, a57
    v_accvgpr_read_b32 v26, a58
    v_accvgpr_read_b32 v27, a59
    v_accvgpr_read_b32 v28, a60
    v_accvgpr_read_b32 v29, a61
    v_accvgpr_read_b32 v30, a62
    v_accvgpr_read_b32 v31, a63
    v_cvt_pk_bf16_f32 v32, v16, v17
    v_cvt_pk_bf16_f32 v33, v18, v19
    v_cvt_pk_bf16_f32 v34, v20, v21
    v_cvt_pk_bf16_f32 v35, v22, v23
    v_cvt_pk_bf16_f32 v36, v24, v25
    v_cvt_pk_bf16_f32 v37, v26, v27
    v_cvt_pk_bf16_f32 v38, v28, v29
    v_cvt_pk_bf16_f32 v39, v30, v31
    s_add_u32 s61, s59, 458752
    s_nop 0
    v_permlane32_swap_b32 v32, v34
    v_permlane32_swap_b32 v33, v35
    v_permlane32_swap_b32 v36, v38
    v_permlane32_swap_b32 v37, v39
    buffer_store_dwordx4 v[32:35], v7, s[36:39], s61 offen offset:0 sc1
    buffer_store_dwordx4 v[36:39], v7, s[36:39], s61 offen offset:512 sc1
    s_nop 1
    s_waitcnt vmcnt(0)
    s_mul_i32 s58, s54, 2
    s_lshr_b32 s58, s58, 2
    s_lshl_b32 s58, s58, 7
    s_add_u32 s58, s58, 24182784
    s_mov_b64 exec, 1
    v_mov_b32 v8, 0
    v_mov_b32 v9, 1
    buffer_atomic_add v9, v8, s[36:39], s58 offen
    s_mov_b64 exec, -1
    s_branch W_NEXT
W_T:
    s_add_u32 s57, s57, 4194304
    s_mul_i32 s62, s40, 57344
    s_add_u32 s62, s62, s57
    s_mul_i32 s63, s40, 57344
    s_add_u32 s63, s63, s56
    s_mul_i32 s64, s40, 8192
    s_add_u32 s64, s64, 0
    s_mul_i32 s65, s40, 8192
    s_add_u32 s65, s65, 32768
    s_lshr_b32 s60, s40, 1
    s_mul_i32 s60, s60, 16384
    s_add_u32 s60, s60, 0
    v_add_u32 v12, s60, v4
    s_and_b32 s60, s40, 1
    s_mul_i32 s60, s60, 16384
    s_add_u32 s60, s60, 32768
    v_add_u32 v13, s60, v4
    v_add_u32 v14, 65536, v12
    v_add_u32 v15, 65536, v13
    s_barrier
    s_add_u32 m0, s64, 0
    s_add_u32 s60, s62, 0
    buffer_load_dwordx4 v4, s[36:39], s60 offen offset:0 lds
    buffer_load_dwordx4 v4, s[36:39], s60 offen offset:1024 lds
    buffer_load_dwordx4 v4, s[36:39], s60 offen offset:2048 lds
    buffer_load_dwordx4 v4, s[36:39], s60 offen offset:3072 lds
    s_add_u32 m0, s64, 4096
    s_add_u32 s60, s62, 28672
    buffer_load_dwordx4 v4, s[36:39], s60 offen offset:0 lds
    buffer_load_dwordx4 v4, s[36:39], s60 offen offset:1024 lds
    buffer_load_dwordx4 v4, s[36:39], s60 offen offset:2048 lds
    buffer_load_dwordx4 v4, s[36:39], s60 offen offset:3072 lds
    s_add_u32 m0, s65, 0
    s_add_u32 s60, s63, 0
    buffer_load_dwordx4 v4, s[36:39], s60 offen offset:0 lds
    buffer_load_dwordx4 v4, s[36:39], s60 offen offset:1024 lds
    buffer_load_dwordx4 v4, s[36:39], s60 offen offset:2048 lds
    buffer_load_dwordx4 v4, s[36:39], s60 offen offset:3072 lds
    s_add_u32 m0, s65, 4096
    s_add_u32 s60, s63, 28672
    buffer_load_dwordx4 v4, s[36:39], s60 offen offset:0 lds
    buffer_load_dwordx4 v4, s[36:39], s60 offen offset:1024 lds
    buffer_load_dwordx4 v4, s[36:39], s60 offen offset:2048 lds
    buffer_load_dwordx4 v4, s[36:39], s60 offen offset:3072 lds
    s_waitcnt vmcnt(0)
    s_barrier
    ds_read_b128 v[16:19], v12 offset:0
    ds_read_b128 v[20:23], v12 offset:4096
    ds_read_b128 v[24:27], v12 offset:8192
    ds_read_b128 v[28:31], v12 offset:12288
    ds_read_b128 v[48:51], v13 offset:0
    ds_read_b128 v[52:55], v13 offset:4096
    ds_read_b128 v[56:59], v13 offset:8192
    ds_read_b128 v[60:63], v13 offset:12288
    s_add_u32 m0, s64, 65536
    s_add_u32 s60, s62, 4096
    buffer_load_dwordx4 v4, s[36:39], s60 offen offset:0 lds
    buffer_load_dwordx4 v4, s[36:39], s60 offen offset:1024 lds
    buffer_load_dwordx4 v4, s[36:39], s60 offen offset:2048 lds
    buffer_load_dwordx4 v4, s[36:39], s60 offen offset:3072 lds
    s_add_u32 m0, s64, 69632
    s_add_u32 s60, s62, 32768
    buffer_load_dwordx4 v4, s[36:39], s60 offen offset:0 lds
    buffer_load_dwordx4 v4, s[36:39], s60 offen offset:1024 lds
    buffer_load_dwordx4 v4, s[36:39], s60 offen offset:2048 lds
    buffer_load_dwordx4 v4, s[36:39], s60 offen offset:3072 lds
    s_add_u32 m0, s65, 65536
    s_add_u32 s60, s63, 4096
    buffer_load_dwordx4 v4, s[36:39], s60 offen offset:0 lds
    buffer_load_dwordx4 v4, s[36:39], s60 offen offset:1024 lds
    buffer_load_dwordx4 v4, s[36:39], s60 offen offset:2048 lds
    buffer_load_dwordx4 v4, s[36:39], s60 offen offset:3072 lds
    s_add_u32 m0, s65, 69632
    s_add_u32 s60, s63, 32768
    buffer_load_dwordx4 v4, s[36:39], s60 offen offset:0 lds
    buffer_load_dwordx4 v4, s[36:39], s60 offen offset:1024 lds
    buffer_load_dwordx4 v4, s[36:39], s60 offen offset:2048 lds
    buffer_load_dwordx4 v4, s[36:39], s60 offen offset:3072 lds
    ds_read_b128 v[32:35], v12 offset:1024
    ds_read_b128 v[36:39], v12 offset:5120
    ds_read_b128 v[40:43], v12 offset:9216
    ds_read_b128 v[44:47], v12 offset:13312
    ds_read_b128 v[64:67], v13 offset:1024
    ds_read_b128 v[68:71], v13 offset:5120
    ds_read_b128 v[72:75], v13 offset:9216
    ds_read_b128 v[76:79], v13 offset:13312
    s_waitcnt lgkmcnt(8)
    v_mfma_f32_32x32x16_bf16 a[0:15], v[16:19], v[48:51], 0
    v_mfma_f32_32x32x16_bf16 a[16:31], v[16:19], v[52:55], 0
    v_mfma_f32_32x32x16_bf16 a[32:47], v[16:19], v[56:59], 0
    v_mfma_f32_32x32x16_bf16 a[48:63], v[16:19], v[60:63], 0
    v_mfma_f32_32x32x16_bf16 a[64:79], v[20:23], v[48:51], 0
    v_mfma_f32_32x32x16_bf16 a[80:95], v[20:23], v[52:55], 0
    v_mfma_f32_32x32x16_bf16 a[96:111], v[20:23], v[56:59], 0
    v_mfma_f32_32x32x16_bf16 a[112:127], v[20:23], v[60:63], 0
    v_mfma_f32_32x32x16_bf16 a[128:143], v[24:27], v[48:51], 0
    v_mfma_f32_32x32x16_bf16 a[144:159], v[24:27], v[52:55], 0
    v_mfma_f32_32x32x16_bf16 a[160:175], v[24:27], v[56:59], 0
    v_mfma_f32_32x32x16_bf16 a[176:191], v[24:27], v[60:63], 0
    v_mfma_f32_32x32x16_bf16 a[192:207], v[28:31], v[48:51], 0
    v_mfma_f32_32x32x16_bf16 a[208:223], v[28:31], v[52:55], 0
    v_mfma_f32_32x32x16_bf16 a[224:239], v[28:31], v[56:59], 0
    v_mfma_f32_32x32x16_bf16 a[240:255], v[28:31], v[60:63], 0
    ds_read_b128 v[16:19], v12 offset:2048
    ds_read_b128 v[20:23], v12 offset:6144
    ds_read_b128 v[24:27], v12 offset:10240
    ds_read_b128 v[28:31], v12 offset:14336
    ds_read_b128 v[48:51], v13 offset:2048
    ds_read_b128 v[52:55], v13 offset:6144
    ds_read_b128 v[56:59], v13 offset:10240
    ds_read_b128 v[60:63], v13 offset:14336
    s_waitcnt lgkmcnt(8)
    v_mfma_f32_32x32x16_bf16 a[0:15], v[32:35], v[64:67], a[0:15]
    v_mfma_f32_32x32x16_bf16 a[16:31], v[32:35], v[68:71], a[16:31]
    v_mfma_f32_32x32x16_bf16 a[32:47], v[32:35], v[72:75], a[32:47]
    v_mfma_f32_32x32x16_bf16 a[48:63], v[32:35], v[76:79], a[48:63]
    v_mfma_f32_32x32x16_bf16 a[64:79], v[36:39], v[64:67], a[64:79]
    v_mfma_f32_32x32x16_bf16 a[80:95], v[36:39], v[68:71], a[80:95]
    v_mfma_f32_32x32x16_bf16 a[96:111], v[36:39], v[72:75], a[96:111]
    v_mfma_f32_32x32x16_bf16 a[112:127], v[36:39], v[76:79], a[112:127]
    v_mfma_f32_32x32x16_bf16 a[128:143], v[40:43], v[64:67], a[128:143]
    v_mfma_f32_32x32x16_bf16 a[144:159], v[40:43], v[68:71], a[144:159]
    v_mfma_f32_32x32x16_bf16 a[160:175], v[40:43], v[72:75], a[160:175]
    v_mfma_f32_32x32x16_bf16 a[176:191], v[40:43], v[76:79], a[176:191]
    v_mfma_f32_32x32x16_bf16 a[192:207], v[44:47], v[64:67], a[192:207]
    v_mfma_f32_32x32x16_bf16 a[208:223], v[44:47], v[68:71], a[208:223]
    v_mfma_f32_32x32x16_bf16 a[224:239], v[44:47], v[72:75], a[224:239]
    v_mfma_f32_32x32x16_bf16 a[240:255], v[44:47], v[76:79], a[240:255]
    ds_read_b128 v[32:35], v12 offset:3072
    ds_read_b128 v[36:39], v12 offset:7168
    ds_read_b128 v[40:43], v12 offset:11264
    ds_read_b128 v[44:47], v12 offset:15360
    ds_read_b128 v[64:67], v13 offset:3072
    ds_read_b128 v[68:71], v13 offset:7168
    ds_read_b128 v[72:75], v13 offset:11264
    ds_read_b128 v[76:79], v13 offset:15360
    s_waitcnt lgkmcnt(8)
    v_mfma_f32_32x32x16_bf16 a[0:15], v[16:19], v[48:51], a[0:15]
    v_mfma_f32_32x32x16_bf16 a[16:31], v[16:19], v[52:55], a[16:31]
    v_mfma_f32_32x32x16_bf16 a[32:47], v[16:19], v[56:59], a[32:47]
    v_mfma_f32_32x32x16_bf16 a[48:63], v[16:19], v[60:63], a[48:63]
    v_mfma_f32_32x32x16_bf16 a[64:79], v[20:23], v[48:51], a[64:79]
    v_mfma_f32_32x32x16_bf16 a[80:95], v[20:23], v[52:55], a[80:95]
    v_mfma_f32_32x32x16_bf16 a[96:111], v[20:23], v[56:59], a[96:111]
    v_mfma_f32_32x32x16_bf16 a[112:127], v[20:23], v[60:63], a[112:127]
    v_mfma_f32_32x32x16_bf16 a[128:143], v[24:27], v[48:51], a[128:143]
    v_mfma_f32_32x32x16_bf16 a[144:159], v[24:27], v[52:55], a[144:159]
    v_mfma_f32_32x32x16_bf16 a[160:175], v[24:27], v[56:59], a[160:175]
    v_mfma_f32_32x32x16_bf16 a[176:191], v[24:27], v[60:63], a[176:191]
    v_mfma_f32_32x32x16_bf16 a[192:207], v[28:31], v[48:51], a[192:207]
    v_mfma_f32_32x32x16_bf16 a[208:223], v[28:31], v[52:55], a[208:223]
    v_mfma_f32_32x32x16_bf16 a[224:239], v[28:31], v[56:59], a[224:239]
    v_mfma_f32_32x32x16_bf16 a[240:255], v[28:31], v[60:63], a[240:255]
    s_waitcnt lgkmcnt(0)
    v_mfma_f32_32x32x16_bf16 a[0:15], v[32:35], v[64:67], a[0:15]
    v_mfma_f32_32x32x16_bf16 a[16:31], v[32:35], v[68:71], a[16:31]
    v_mfma_f32_32x32x16_bf16 a[32:47], v[32:35], v[72:75], a[32:47]
    v_mfma_f32_32x32x16_bf16 a[48:63], v[32:35], v[76:79], a[48:63]
    v_mfma_f32_32x32x16_bf16 a[64:79], v[36:39], v[64:67], a[64:79]
    v_mfma_f32_32x32x16_bf16 a[80:95], v[36:39], v[68:71], a[80:95]
    v_mfma_f32_32x32x16_bf16 a[96:111], v[36:39], v[72:75], a[96:111]
    v_mfma_f32_32x32x16_bf16 a[112:127], v[36:39], v[76:79], a[112:127]
    v_mfma_f32_32x32x16_bf16 a[128:143], v[40:43], v[64:67], a[128:143]
    v_mfma_f32_32x32x16_bf16 a[144:159], v[40:43], v[68:71], a[144:159]
    v_mfma_f32_32x32x16_bf16 a[160:175], v[40:43], v[72:75], a[160:175]
    v_mfma_f32_32x32x16_bf16 a[176:191], v[40:43], v[76:79], a[176:191]
    v_mfma_f32_32x32x16_bf16 a[192:207], v[44:47], v[64:67], a[192:207]
    v_mfma_f32_32x32x16_bf16 a[208:223], v[44:47], v[68:71], a[208:223]
    v_mfma_f32_32x32x16_bf16 a[224:239], v[44:47], v[72:75], a[224:239]
    v_mfma_f32_32x32x16_bf16 a[240:255], v[44:47], v[76:79], a[240:255]
    s_waitcnt vmcnt(0)
    s_barrier
    ds_read_b128 v[16:19], v14 offset:0
    ds_read_b128 v[20:23], v14 offset:4096
    ds_read_b128 v[24:27], v14 offset:8192
    ds_read_b128 v[28:31], v14 offset:12288
    ds_read_b128 v[48:51], v15 offset:0
    ds_read_b128 v[52:55], v15 offset:4096
    ds_read_b128 v[56:59], v15 offset:8192
    ds_read_b128 v[60:63], v15 offset:12288
    s_add_u32 m0, s64, 0
    s_add_u32 s60, s62, 8192
    buffer_load_dwordx4 v4, s[36:39], s60 offen offset:0 lds
    buffer_load_dwordx4 v4, s[36:39], s60 offen offset:1024 lds
    buffer_load_dwordx4 v4, s[36:39], s60 offen offset:2048 lds
    buffer_load_dwordx4 v4, s[36:39], s60 offen offset:3072 lds
    s_add_u32 m0, s64, 4096
    s_add_u32 s60, s62, 36864
    buffer_load_dwordx4 v4, s[36:39], s60 offen offset:0 lds
    buffer_load_dwordx4 v4, s[36:39], s60 offen offset:1024 lds
    buffer_load_dwordx4 v4, s[36:39], s60 offen offset:2048 lds
    buffer_load_dwordx4 v4, s[36:39], s60 offen offset:3072 lds
    s_add_u32 m0, s65, 0
    s_add_u32 s60, s63, 8192
    buffer_load_dwordx4 v4, s[36:39], s60 offen offset:0 lds
    buffer_load_dwordx4 v4, s[36:39], s60 offen offset:1024 lds
    buffer_load_dwordx4 v4, s[36:39], s60 offen offset:2048 lds
    buffer_load_dwordx4 v4, s[36:39], s60 offen offset:3072 lds
    s_add_u32 m0, s65, 4096
    s_add_u32 s60, s63, 36864
    buffer_load_dwordx4 v4, s[36:39], s60 offen offset:0 lds
    buffer_load_dwordx4 v4, s[36:39], s60 offen offset:1024 lds
    buffer_load_dwordx4 v4, s[36:39], s60 offen offset:2048 lds
    buffer_load_dwordx4 v4, s[36:39], s60 offen offset:3072 lds
    ds_read_b128 v[32:35], v14 offset:1024
    ds_read_b128 v[36:39], v14 offset:5120
    ds_read_b128 v[40:43], v14 offset:9216
    ds_read_b128 v[44:47], v14 offset:13312
    ds_read_b128 v[64:67], v15 offset:1024
    ds_read_b128 v[68:71], v15 offset:5120
    ds_read_b128 v[72:75], v15 offset:9216
    ds_read_b128 v[76:79], v15 offset:13312
    s_waitcnt lgkmcnt(8)
    v_mfma_f32_32x32x16_bf16 a[0:15], v[16:19], v[48:51], a[0:15]
    v_mfma_f32_32x32x16_bf16 a[16:31], v[16:19], v[52:55], a[16:31]
    v_mfma_f32_32x32x16_bf16 a[32:47], v[16:19], v[56:59], a[32:47]
    v_mfma_f32_32x32x16_bf16 a[48:63], v[16:19], v[60:63], a[48:63]
    v_mfma_f32_32x32x16_bf16 a[64:79], v[20:23], v[48:51], a[64:79]
    v_mfma_f32_32x32x16_bf16 a[80:95], v[20:23], v[52:55], a[80:95]
    v_mfma_f32_32x32x16_bf16 a[96:111], v[20:23], v[56:59], a[96:111]
    v_mfma_f32_32x32x16_bf16 a[112:127], v[20:23], v[60:63], a[112:127]
    v_mfma_f32_32x32x16_bf16 a[128:143], v[24:27], v[48:51], a[128:143]
    v_mfma_f32_32x32x16_bf16 a[144:159], v[24:27], v[52:55], a[144:159]
    v_mfma_f32_32x32x16_bf16 a[160:175], v[24:27], v[56:59], a[160:175]
    v_mfma_f32_32x32x16_bf16 a[176:191], v[24:27], v[60:63], a[176:191]
    v_mfma_f32_32x32x16_bf16 a[192:207], v[28:31], v[48:51], a[192:207]
    v_mfma_f32_32x32x16_bf16 a[208:223], v[28:31], v[52:55], a[208:223]
    v_mfma_f32_32x32x16_bf16 a[224:239], v[28:31], v[56:59], a[224:239]
    v_mfma_f32_32x32x16_bf16 a[240:255], v[28:31], v[60:63], a[240:255]
    ds_read_b128 v[16:19], v14 offset:2048
    ds_read_b128 v[20:23], v14 offset:6144
    ds_read_b128 v[24:27], v14 offset:10240
    ds_read_b128 v[28:31], v14 offset:14336
    ds_read_b128 v[48:51], v15 offset:2048
    ds_read_b128 v[52:55], v15 offset:6144
    ds_read_b128 v[56:59], v15 offset:10240
    ds_read_b128 v[60:63], v15 offset:14336
    s_waitcnt lgkmcnt(8)
    v_mfma_f32_32x32x16_bf16 a[0:15], v[32:35], v[64:67], a[0:15]
    v_mfma_f32_32x32x16_bf16 a[16:31], v[32:35], v[68:71], a[16:31]
    v_mfma_f32_32x32x16_bf16 a[32:47], v[32:35], v[72:75], a[32:47]
    v_mfma_f32_32x32x16_bf16 a[48:63], v[32:35], v[76:79], a[48:63]
    v_mfma_f32_32x32x16_bf16 a[64:79], v[36:39], v[64:67], a[64:79]
    v_mfma_f32_32x32x16_bf16 a[80:95], v[36:39], v[68:71], a[80:95]
    v_mfma_f32_32x32x16_bf16 a[96:111], v[36:39], v[72:75], a[96:111]
    v_mfma_f32_32x32x16_bf16 a[112:127], v[36:39], v[76:79], a[112:127]
    v_mfma_f32_32x32x16_bf16 a[128:143], v[40:43], v[64:67], a[128:143]
    v_mfma_f32_32x32x16_bf16 a[144:159], v[40:43], v[68:71], a[144:159]
    v_mfma_f32_32x32x16_bf16 a[160:175], v[40:43], v[72:75], a[160:175]
    v_mfma_f32_32x32x16_bf16 a[176:191], v[40:43], v[76:79], a[176:191]
    v_mfma_f32_32x32x16_bf16 a[192:207], v[44:47], v[64:67], a[192:207]
    v_mfma_f32_32x32x16_bf16 a[208:223], v[44:47], v[68:71], a[208:223]
    v_mfma_f32_32x32x16_bf16 a[224:239], v[44:47], v[72:75], a[224:239]
    v_mfma_f32_32x32x16_bf16 a[240:255], v[44:47], v[76:79], a[240:255]
    ds_read_b128 v[32:35], v14 offset:3072
    ds_read_b128 v[36:39], v14 offset:7168
    ds_read_b128 v[40:43], v14 offset:11264
    ds_read_b128 v[44:47], v14 offset:15360
    ds_read_b128 v[64:67], v15 offset:3072
    ds_read_b128 v[68:71], v15 offset:7168
    ds_read_b128 v[72:75], v15 offset:11264
    ds_read_b128 v[76:79], v15 offset:15360
    s_waitcnt lgkmcnt(8)
    v_mfma_f32_32x32x16_bf16 a[0:15], v[16:19], v[48:51], a[0:15]
    v_mfma_f32_32x32x16_bf16 a[16:31], v[16:19], v[52:55], a[16:31]
    v_mfma_f32_32x32x16_bf16 a[32:47], v[16:19], v[56:59], a[32:47]
    v_mfma_f32_32x32x16_bf16 a[48:63], v[16:19], v[60:63], a[48:63]
    v_mfma_f32_32x32x16_bf16 a[64:79], v[20:23], v[48:51], a[64:79]
    v_mfma_f32_32x32x16_bf16 a[80:95], v[20:23], v[52:55], a[80:95]
    v_mfma_f32_32x32x16_bf16 a[96:111], v[20:23], v[56:59], a[96:111]
    v_mfma_f32_32x32x16_bf16 a[112:127], v[20:23], v[60:63], a[112:127]
    v_mfma_f32_32x32x16_bf16 a[128:143], v[24:27], v[48:51], a[128:143]
    v_mfma_f32_32x32x16_bf16 a[144:159], v[24:27], v[52:55], a[144:159]
    v_mfma_f32_32x32x16_bf16 a[160:175], v[24:27], v[56:59], a[160:175]
    v_mfma_f32_32x32x16_bf16 a[176:191], v[24:27], v[60:63], a[176:191]
    v_mfma_f32_32x32x16_bf16 a[192:207], v[28:31], v[48:51], a[192:207]
    v_mfma_f32_32x32x16_bf16 a[208:223], v[28:31], v[52:55], a[208:223]
    v_mfma_f32_32x32x16_bf16 a[224:239], v[28:31], v[56:59], a[224:239]
    v_mfma_f32_32x32x16_bf16 a[240:255], v[28:31], v[60:63], a[240:255]
    s_waitcnt lgkmcnt(0)
    v_mfma_f32_32x32x16_bf16 a[0:15], v[32:35], v[64:67], a[0:15]
    v_mfma_f32_32x32x16_bf16 a[16:31], v[32:35], v[68:71], a[16:31]
    v_mfma_f32_32x32x16_bf16 a[32:47], v[32:35], v[72:75], a[32:47]
    v_mfma_f32_32x32x16_bf16 a[48:63], v[32:35], v[76:79], a[48:63]
    v_mfma_f32_32x32x16_bf16 a[64:79], v[36:39], v[64:67], a[64:79]
    v_mfma_f32_32x32x16_bf16 a[80:95], v[36:39], v[68:71], a[80:95]
    v_mfma_f32_32x32x16_bf16 a[96:111], v[36:39], v[72:75], a[96:111]
    v_mfma_f32_32x32x16_bf16 a[112:127], v[36:39], v[76:79], a[112:127]
    v_mfma_f32_32x32x16_bf16 a[128:143], v[40:43], v[64:67], a[128:143]
    v_mfma_f32_32x32x16_bf16 a[144:159], v[40:43], v[68:71], a[144:159]
    v_mfma_f32_32x32x16_bf16 a[160:175], v[40:43], v[72:75], a[160:175]
    v_mfma_f32_32x32x16_bf16 a[176:191], v[40:43], v[76:79], a[176:191]
    v_mfma_f32_32x32x16_bf16 a[192:207], v[44:47], v[64:67], a[192:207]
    v_mfma_f32_32x32x16_bf16 a[208:223], v[44:47], v[68:71], a[208:223]
    v_mfma_f32_32x32x16_bf16 a[224:239], v[44:47], v[72:75], a[224:239]
    v_mfma_f32_32x32x16_bf16 a[240:255], v[44:47], v[76:79], a[240:255]
    s_waitcnt vmcnt(0)
    s_barrier
    ds_read_b128 v[16:19], v12 offset:0
    ds_read_b128 v[20:23], v12 offset:4096
    ds_read_b128 v[24:27], v12 offset:8192
    ds_read_b128 v[28:31], v12 offset:12288
    ds_read_b128 v[48:51], v13 offset:0
    ds_read_b128 v[52:55], v13 offset:4096
    ds_read_b128 v[56:59], v13 offset:8192
    ds_read_b128 v[60:63], v13 offset:12288
    s_add_u32 m0, s64, 65536
    s_add_u32 s60, s62, 12288
    buffer_load_dwordx4 v4, s[36:39], s60 offen offset:0 lds
    buffer_load_dwordx4 v4, s[36:39], s60 offen offset:1024 lds
    buffer_load_dwordx4 v4, s[36:39], s60 offen offset:2048 lds
    buffer_load_dwordx4 v4, s[36:39], s60 offen offset:3072 lds
    s_add_u32 m0, s64, 69632
    s_add_u32 s60, s62, 40960
    buffer_load_dwordx4 v4, s[36:39], s60 offen offset:0 lds
    buffer_load_dwordx4 v4, s[36:39], s60 offen offset:1024 lds
    buffer_load_dwordx4 v4, s[36:39], s60 offen offset:2048 lds
    buffer_load_dwordx4 v4, s[36:39], s60 offen offset:3072 lds
    s_add_u32 m0, s65, 65536
    s_add_u32 s60, s63, 12288
    buffer_load_dwordx4 v4, s[36:39], s60 offen offset:0 lds
    buffer_load_dwordx4 v4, s[36:39], s60 offen offset:1024 lds
    buffer_load_dwordx4 v4, s[36:39], s60 offen offset:2048 lds
    buffer_load_dwordx4 v4, s[36:39], s60 offen offset:3072 lds
    s_add_u32 m0, s65, 69632
    s_add_u32 s60, s63, 40960
    buffer_load_dwordx4 v4, s[36:39], s60 offen offset:0 lds
    buffer_load_dwordx4 v4, s[36:39], s60 offen offset:1024 lds
    buffer_load_dwordx4 v4, s[36:39], s60 offen offset:2048 lds
    buffer_load_dwordx4 v4, s[36:39], s60 offen offset:3072 lds
    ds_read_b128 v[32:35], v12 offset:1024
    ds_read_b128 v[36:39], v12 offset:5120
    ds_read_b128 v[40:43], v12 offset:9216
    ds_read_b128 v[44:47], v12 offset:13312
    ds_read_b128 v[64:67], v13 offset:1024
    ds_read_b128 v[68:71], v13 offset:5120
    ds_read_b128 v[72:75], v13 offset:9216
    ds_read_b128 v[76:79], v13 offset:13312
    s_waitcnt lgkmcnt(8)
    v_mfma_f32_32x32x16_bf16 a[0:15], v[16:19], v[48:51], a[0:15]
    v_mfma_f32_32x32x16_bf16 a[16:31], v[16:19], v[52:55], a[16:31]
    v_mfma_f32_32x32x16_bf16 a[32:47], v[16:19], v[56:59], a[32:47]
    v_mfma_f32_32x32x16_bf16 a[48:63], v[16:19], v[60:63], a[48:63]
    v_mfma_f32_32x32x16_bf16 a[64:79], v[20:23], v[48:51], a[64:79]
    v_mfma_f32_32x32x16_bf16 a[80:95], v[20:23], v[52:55], a[80:95]
    v_mfma_f32_32x32x16_bf16 a[96:111], v[20:23], v[56:59], a[96:111]
    v_mfma_f32_32x32x16_bf16 a[112:127], v[20:23], v[60:63], a[112:127]
    v_mfma_f32_32x32x16_bf16 a[128:143], v[24:27], v[48:51], a[128:143]
    v_mfma_f32_32x32x16_bf16 a[144:159], v[24:27], v[52:55], a[144:159]
    v_mfma_f32_32x32x16_bf16 a[160:175], v[24:27], v[56:59], a[160:175]
    v_mfma_f32_32x32x16_bf16 a[176:191], v[24:27], v[60:63], a[176:191]
    v_mfma_f32_32x32x16_bf16 a[192:207], v[28:31], v[48:51], a[192:207]
    v_mfma_f32_32x32x16_bf16 a[208:223], v[28:31], v[52:55], a[208:223]
    v_mfma_f32_32x32x16_bf16 a[224:239], v[28:31], v[56:59], a[224:239]
    v_mfma_f32_32x32x16_bf16 a[240:255], v[28:31], v[60:63], a[240:255]
    ds_read_b128 v[16:19], v12 offset:2048
    ds_read_b128 v[20:23], v12 offset:6144
    ds_read_b128 v[24:27], v12 offset:10240
    ds_read_b128 v[28:31], v12 offset:14336
    ds_read_b128 v[48:51], v13 offset:2048
    ds_read_b128 v[52:55], v13 offset:6144
    ds_read_b128 v[56:59], v13 offset:10240
    ds_read_b128 v[60:63], v13 offset:14336
    s_waitcnt lgkmcnt(8)
    v_mfma_f32_32x32x16_bf16 a[0:15], v[32:35], v[64:67], a[0:15]
    v_mfma_f32_32x32x16_bf16 a[16:31], v[32:35], v[68:71], a[16:31]
    v_mfma_f32_32x32x16_bf16 a[32:47], v[32:35], v[72:75], a[32:47]
    v_mfma_f32_32x32x16_bf16 a[48:63], v[32:35], v[76:79], a[48:63]
    v_mfma_f32_32x32x16_bf16 a[64:79], v[36:39], v[64:67], a[64:79]
    v_mfma_f32_32x32x16_bf16 a[80:95], v[36:39], v[68:71], a[80:95]
    v_mfma_f32_32x32x16_bf16 a[96:111], v[36:39], v[72:75], a[96:111]
    v_mfma_f32_32x32x16_bf16 a[112:127], v[36:39], v[76:79], a[112:127]
    v_mfma_f32_32x32x16_bf16 a[128:143], v[40:43], v[64:67], a[128:143]
    v_mfma_f32_32x32x16_bf16 a[144:159], v[40:43], v[68:71], a[144:159]
    v_mfma_f32_32x32x16_bf16 a[160:175], v[40:43], v[72:75], a[160:175]
    v_mfma_f32_32x32x16_bf16 a[176:191], v[40:43], v[76:79], a[176:191]
    v_mfma_f32_32x32x16_bf16 a[192:207], v[44:47], v[64:67], a[192:207]
    v_mfma_f32_32x32x16_bf16 a[208:223], v[44:47], v[68:71], a[208:223]
    v_mfma_f32_32x32x16_bf16 a[224:239], v[44:47], v[72:75], a[224:239]
    v_mfma_f32_32x32x16_bf16 a[240:255], v[44:47], v[76:79], a[240:255]
    ds_read_b128 v[32:35], v12 offset:3072
    ds_read_b128 v[36:39], v12 offset:7168
    ds_read_b128 v[40:43], v12 offset:11264
    ds_read_b128 v[44:47], v12 offset:15360
    ds_read_b128 v[64:67], v13 offset:3072
    ds_read_b128 v[68:71], v13 offset:7168
    ds_read_b128 v[72:75], v13 offset:11264
    ds_read_b128 v[76:79], v13 offset:15360
    s_waitcnt lgkmcnt(8)
    v_mfma_f32_32x32x16_bf16 a[0:15], v[16:19], v[48:51], a[0:15]
    v_mfma_f32_32x32x16_bf16 a[16:31], v[16:19], v[52:55], a[16:31]
    v_mfma_f32_32x32x16_bf16 a[32:47], v[16:19], v[56:59], a[32:47]
    v_mfma_f32_32x32x16_bf16 a[48:63], v[16:19], v[60:63], a[48:63]
    v_mfma_f32_32x32x16_bf16 a[64:79], v[20:23], v[48:51], a[64:79]
    v_mfma_f32_32x32x16_bf16 a[80:95], v[20:23], v[52:55], a[80:95]
    v_mfma_f32_32x32x16_bf16 a[96:111], v[20:23], v[56:59], a[96:111]
    v_mfma_f32_32x32x16_bf16 a[112:127], v[20:23], v[60:63], a[112:127]
    v_mfma_f32_32x32x16_bf16 a[128:143], v[24:27], v[48:51], a[128:143]
    v_mfma_f32_32x32x16_bf16 a[144:159], v[24:27], v[52:55], a[144:159]
    v_mfma_f32_32x32x16_bf16 a[160:175], v[24:27], v[56:59], a[160:175]
    v_mfma_f32_32x32x16_bf16 a[176:191], v[24:27], v[60:63], a[176:191]
    v_mfma_f32_32x32x16_bf16 a[192:207], v[28:31], v[48:51], a[192:207]
    v_mfma_f32_32x32x16_bf16 a[208:223], v[28:31], v[52:55], a[208:223]
    v_mfma_f32_32x32x16_bf16 a[224:239], v[28:31], v[56:59], a[224:239]
    v_mfma_f32_32x32x16_bf16 a[240:255], v[28:31], v[60:63], a[240:255]
    s_waitcnt lgkmcnt(0)
    v_mfma_f32_32x32x16_bf16 a[0:15], v[32:35], v[64:67], a[0:15]
    v_mfma_f32_32x32x16_bf16 a[16:31], v[32:35], v[68:71], a[16:31]
    v_mfma_f32_32x32x16_bf16 a[32:47], v[32:35], v[72:75], a[32:47]
    v_mfma_f32_32x32x16_bf16 a[48:63], v[32:35], v[76:79], a[48:63]
    v_mfma_f32_32x32x16_bf16 a[64:79], v[36:39], v[64:67], a[64:79]
    v_mfma_f32_32x32x16_bf16 a[80:95], v[36:39], v[68:71], a[80:95]
    v_mfma_f32_32x32x16_bf16 a[96:111], v[36:39], v[72:75], a[96:111]
    v_mfma_f32_32x32x16_bf16 a[112:127], v[36:39], v[76:79], a[112:127]
    v_mfma_f32_32x32x16_bf16 a[128:143], v[40:43], v[64:67], a[128:143]
    v_mfma_f32_32x32x16_bf16 a[144:159], v[40:43], v[68:71], a[144:159]
    v_mfma_f32_32x32x16_bf16 a[160:175], v[40:43], v[72:75], a[160:175]
    v_mfma_f32_32x32x16_bf16 a[176:191], v[40:43], v[76:79], a[176:191]
    v_mfma_f32_32x32x16_bf16 a[192:207], v[44:47], v[64:67], a[192:207]
    v_mfma_f32_32x32x16_bf16 a[208:223], v[44:47], v[68:71], a[208:223]
    v_mfma_f32_32x32x16_bf16 a[224:239], v[44:47], v[72:75], a[224:239]
    v_mfma_f32_32x32x16_bf16 a[240:255], v[44:47], v[76:79], a[240:255]
    s_waitcnt vmcnt(0)
    s_barrier
    ds_read_b128 v[16:19], v14 offset:0
    ds_read_b128 v[20:23], v14 offset:4096
    ds_read_b128 v[24:27], v14 offset:8192
    ds_read_b128 v[28:31], v14 offset:12288
    ds_read_b128 v[48:51], v15 offset:0
    ds_read_b128 v[52:55], v15 offset:4096
    ds_read_b128 v[56:59], v15 offset:8192
    ds_read_b128 v[60:63], v15 offset:12288
    s_add_u32 m0, s64, 0
    s_add_u32 s60, s62, 16384
    buffer_load_dwordx4 v4, s[36:39], s60 offen offset:0 lds
    buffer_load_dwordx4 v4, s[36:39], s60 offen offset:1024 lds
    buffer_load_dwordx4 v4, s[36:39], s60 offen offset:2048 lds
    buffer_load_dwordx4 v4, s[36:39], s60 offen offset:3072 lds
    s_add_u32 m0, s64, 4096
    s_add_u32 s60, s62, 45056
    buffer_load_dwordx4 v4, s[36:39], s60 offen offset:0 lds
    buffer_load_dwordx4 v4, s[36:39], s60 offen offset:1024 lds
    buffer_load_dwordx4 v4, s[36:39], s60 offen offset:2048 lds
    buffer_load_dwordx4 v4, s[36:39], s60 offen offset:3072 lds
    s_add_u32 m0, s65, 0
    s_add_u32 s60, s63, 16384
    buffer_load_dwordx4 v4, s[36:39], s60 offen offset:0 lds
    buffer_load_dwordx4 v4, s[36:39], s60 offen offset:1024 lds
    buffer_load_dwordx4 v4, s[36:39], s60 offen offset:2048 lds
    buffer_load_dwordx4 v4, s[36:39], s60 offen offset:3072 lds
    s_add_u32 m0, s65, 4096
    s_add_u32 s60, s63, 45056
    buffer_load_dwordx4 v4, s[36:39], s60 offen offset:0 lds
    buffer_load_dwordx4 v4, s[36:39], s60 offen offset:1024 lds
    buffer_load_dwordx4 v4, s[36:39], s60 offen offset:2048 lds
    buffer_load_dwordx4 v4, s[36:39], s60 offen offset:3072 lds
    ds_read_b128 v[32:35], v14 offset:1024
    ds_read_b128 v[36:39], v14 offset:5120
    ds_read_b128 v[40:43], v14 offset:9216
    ds_read_b128 v[44:47], v14 offset:13312
    ds_read_b128 v[64:67], v15 offset:1024
    ds_read_b128 v[68:71], v15 offset:5120
    ds_read_b128 v[72:75], v15 offset:9216
    ds_read_b128 v[76:79], v15 offset:13312
    s_waitcnt lgkmcnt(8)
    v_mfma_f32_32x32x16_bf16 a[0:15], v[16:19], v[48:51], a[0:15]
    v_mfma_f32_32x32x16_bf16 a[16:31], v[16:19], v[52:55], a[16:31]
    v_mfma_f32_32x32x16_bf16 a[32:47], v[16:19], v[56:59], a[32:47]
    v_mfma_f32_32x32x16_bf16 a[48:63], v[16:19], v[60:63], a[48:63]
    v_mfma_f32_32x32x16_bf16 a[64:79], v[20:23], v[48:51], a[64:79]
    v_mfma_f32_32x32x16_bf16 a[80:95], v[20:23], v[52:55], a[80:95]
    v_mfma_f32_32x32x16_bf16 a[96:111], v[20:23], v[56:59], a[96:111]
    v_mfma_f32_32x32x16_bf16 a[112:127], v[20:23], v[60:63], a[112:127]
    v_mfma_f32_32x32x16_bf16 a[128:143], v[24:27], v[48:51], a[128:143]
    v_mfma_f32_32x32x16_bf16 a[144:159], v[24:27], v[52:55], a[144:159]
    v_mfma_f32_32x32x16_bf16 a[160:175], v[24:27], v[56:59], a[160:175]
    v_mfma_f32_32x32x16_bf16 a[176:191], v[24:27], v[60:63], a[176:191]
    v_mfma_f32_32x32x16_bf16 a[192:207], v[28:31], v[48:51], a[192:207]
    v_mfma_f32_32x32x16_bf16 a[208:223], v[28:31], v[52:55], a[208:223]
    v_mfma_f32_32x32x16_bf16 a[224:239], v[28:31], v[56:59], a[224:239]
    v_mfma_f32_32x32x16_bf16 a[240:255], v[28:31], v[60:63], a[240:255]
    ds_read_b128 v[16:19], v14 offset:2048
    ds_read_b128 v[20:23], v14 offset:6144
    ds_read_b128 v[24:27], v14 offset:10240
    ds_read_b128 v[28:31], v14 offset:14336
    ds_read_b128 v[48:51], v15 offset:2048
    ds_read_b128 v[52:55], v15 offset:6144
    ds_read_b128 v[56:59], v15 offset:10240
    ds_read_b128 v[60:63], v15 offset:14336
    s_waitcnt lgkmcnt(8)
    v_mfma_f32_32x32x16_bf16 a[0:15], v[32:35], v[64:67], a[0:15]
    v_mfma_f32_32x32x16_bf16 a[16:31], v[32:35], v[68:71], a[16:31]
    v_mfma_f32_32x32x16_bf16 a[32:47], v[32:35], v[72:75], a[32:47]
    v_mfma_f32_32x32x16_bf16 a[48:63], v[32:35], v[76:79], a[48:63]
    v_mfma_f32_32x32x16_bf16 a[64:79], v[36:39], v[64:67], a[64:79]
    v_mfma_f32_32x32x16_bf16 a[80:95], v[36:39], v[68:71], a[80:95]
    v_mfma_f32_32x32x16_bf16 a[96:111], v[36:39], v[72:75], a[96:111]
    v_mfma_f32_32x32x16_bf16 a[112:127], v[36:39], v[76:79], a[112:127]
    v_mfma_f32_32x32x16_bf16 a[128:143], v[40:43], v[64:67], a[128:143]
    v_mfma_f32_32x32x16_bf16 a[144:159], v[40:43], v[68:71], a[144:159]
    v_mfma_f32_32x32x16_bf16 a[160:175], v[40:43], v[72:75], a[160:175]
    v_mfma_f32_32x32x16_bf16 a[176:191], v[40:43], v[76:79], a[176:191]
    v_mfma_f32_32x32x16_bf16 a[192:207], v[44:47], v[64:67], a[192:207]
    v_mfma_f32_32x32x16_bf16 a[208:223], v[44:47], v[68:71], a[208:223]
    v_mfma_f32_32x32x16_bf16 a[224:239], v[44:47], v[72:75], a[224:239]
    v_mfma_f32_32x32x16_bf16 a[240:255], v[44:47], v[76:79], a[240:255]
    ds_read_b128 v[32:35], v14 offset:3072
    ds_read_b128 v[36:39], v14 offset:7168
    ds_read_b128 v[40:43], v14 offset:11264
    ds_read_b128 v[44:47], v14 offset:15360
    ds_read_b128 v[64:67], v15 offset:3072
    ds_read_b128 v[68:71], v15 offset:7168
    ds_read_b128 v[72:75], v15 offset:11264
    ds_read_b128 v[76:79], v15 offset:15360
    s_waitcnt lgkmcnt(8)
    v_mfma_f32_32x32x16_bf16 a[0:15], v[16:19], v[48:51], a[0:15]
    v_mfma_f32_32x32x16_bf16 a[16:31], v[16:19], v[52:55], a[16:31]
    v_mfma_f32_32x32x16_bf16 a[32:47], v[16:19], v[56:59], a[32:47]
    v_mfma_f32_32x32x16_bf16 a[48:63], v[16:19], v[60:63], a[48:63]
    v_mfma_f32_32x32x16_bf16 a[64:79], v[20:23], v[48:51], a[64:79]
    v_mfma_f32_32x32x16_bf16 a[80:95], v[20:23], v[52:55], a[80:95]
    v_mfma_f32_32x32x16_bf16 a[96:111], v[20:23], v[56:59], a[96:111]
    v_mfma_f32_32x32x16_bf16 a[112:127], v[20:23], v[60:63], a[112:127]
    v_mfma_f32_32x32x16_bf16 a[128:143], v[24:27], v[48:51], a[128:143]
    v_mfma_f32_32x32x16_bf16 a[144:159], v[24:27], v[52:55], a[144:159]
    v_mfma_f32_32x32x16_bf16 a[160:175], v[24:27], v[56:59], a[160:175]
    v_mfma_f32_32x32x16_bf16 a[176:191], v[24:27], v[60:63], a[176:191]
    v_mfma_f32_32x32x16_bf16 a[192:207], v[28:31], v[48:51], a[192:207]
    v_mfma_f32_32x32x16_bf16 a[208:223], v[28:31], v[52:55], a[208:223]
    v_mfma_f32_32x32x16_bf16 a[224:239], v[28:31], v[56:59], a[224:239]
    v_mfma_f32_32x32x16_bf16 a[240:255], v[28:31], v[60:63], a[240:255]
    s_waitcnt lgkmcnt(0)
    v_mfma_f32_32x32x16_bf16 a[0:15], v[32:35], v[64:67], a[0:15]
    v_mfma_f32_32x32x16_bf16 a[16:31], v[32:35], v[68:71], a[16:31]
    v_mfma_f32_32x32x16_bf16 a[32:47], v[32:35], v[72:75], a[32:47]
    v_mfma_f32_32x32x16_bf16 a[48:63], v[32:35], v[76:79], a[48:63]
    v_mfma_f32_32x32x16_bf16 a[64:79], v[36:39], v[64:67], a[64:79]
    v_mfma_f32_32x32x16_bf16 a[80:95], v[36:39], v[68:71], a[80:95]
    v_mfma_f32_32x32x16_bf16 a[96:111], v[36:39], v[72:75], a[96:111]
    v_mfma_f32_32x32x16_bf16 a[112:127], v[36:39], v[76:79], a[112:127]
    v_mfma_f32_32x32x16_bf16 a[128:143], v[40:43], v[64:67], a[128:143]
    v_mfma_f32_32x32x16_bf16 a[144:159], v[40:43], v[68:71], a[144:159]
    v_mfma_f32_32x32x16_bf16 a[160:175], v[40:43], v[72:75], a[160:175]
    v_mfma_f32_32x32x16_bf16 a[176:191], v[40:43], v[76:79], a[176:191]
    v_mfma_f32_32x32x16_bf16 a[192:207], v[44:47], v[64:67], a[192:207]
    v_mfma_f32_32x32x16_bf16 a[208:223], v[44:47], v[68:71], a[208:223]
    v_mfma_f32_32x32x16_bf16 a[224:239], v[44:47], v[72:75], a[224:239]
    v_mfma_f32_32x32x16_bf16 a[240:255], v[44:47], v[76:79], a[240:255]
    s_waitcnt vmcnt(0)
    s_barrier
    ds_read_b128 v[16:19], v12 offset:0
    ds_read_b128 v[20:23], v12 offset:4096
    ds_read_b128 v[24:27], v12 offset:8192
    ds_read_b128 v[28:31], v12 offset:12288
    ds_read_b128 v[48:51], v13 offset:0
    ds_read_b128 v[52:55], v13 offset:4096
    ds_read_b128 v[56:59], v13 offset:8192
    ds_read_b128 v[60:63], v13 offset:12288
    s_add_u32 m0, s64, 65536
    s_add_u32 s60, s62, 20480
    buffer_load_dwordx4 v4, s[36:39], s60 offen offset:0 lds
    buffer_load_dwordx4 v4, s[36:39], s60 offen offset:1024 lds
    buffer_load_dwordx4 v4, s[36:39], s60 offen offset:2048 lds
    buffer_load_dwordx4 v4, s[36:39], s60 offen offset:3072 lds
    s_add_u32 m0, s64, 69632
    s_add_u32 s60, s62, 49152
    buffer_load_dwordx4 v4, s[36:39], s60 offen offset:0 lds
    buffer_load_dwordx4 v4, s[36:39], s60 offen offset:1024 lds
    buffer_load_dwordx4 v4, s[36:39], s60 offen offset:2048 lds
    buffer_load_dwordx4 v4, s[36:39], s60 offen offset:3072 lds
    s_add_u32 m0, s65, 65536
    s_add_u32 s60, s63, 20480
    buffer_load_dwordx4 v4, s[36:39], s60 offen offset:0 lds
    buffer_load_dwordx4 v4, s[36:39], s60 offen offset:1024 lds
    buffer_load_dwordx4 v4, s[36:39], s60 offen offset:2048 lds
    buffer_load_dwordx4 v4, s[36:39], s60 offen offset:3072 lds
    s_add_u32 m0, s65, 69632
    s_add_u32 s60, s63, 49152
    buffer_load_dwordx4 v4, s[36:39], s60 offen offset:0 lds
    buffer_load_dwordx4 v4, s[36:39], s60 offen offset:1024 lds
    buffer_load_dwordx4 v4, s[36:39], s60 offen offset:2048 lds
    buffer_load_dwordx4 v4, s[36:39], s60 offen offset:3072 lds
    ds_read_b128 v[32:35], v12 offset:1024
    ds_read_b128 v[36:39], v12 offset:5120
    ds_read_b128 v[40:43], v12 offset:9216
    ds_read_b128 v[44:47], v12 offset:13312
    ds_read_b128 v[64:67], v13 offset:1024
    ds_read_b128 v[68:71], v13 offset:5120
    ds_read_b128 v[72:75], v13 offset:9216
    ds_read_b128 v[76:79], v13 offset:13312
    s_waitcnt lgkmcnt(8)
    v_mfma_f32_32x32x16_bf16 a[0:15], v[16:19], v[48:51], a[0:15]
    v_mfma_f32_32x32x16_bf16 a[16:31], v[16:19], v[52:55], a[16:31]
    v_mfma_f32_32x32x16_bf16 a[32:47], v[16:19], v[56:59], a[32:47]
    v_mfma_f32_32x32x16_bf16 a[48:63], v[16:19], v[60:63], a[48:63]
    v_mfma_f32_32x32x16_bf16 a[64:79], v[20:23], v[48:51], a[64:79]
    v_mfma_f32_32x32x16_bf16 a[80:95], v[20:23], v[52:55], a[80:95]
    v_mfma_f32_32x32x16_bf16 a[96:111], v[20:23], v[56:59], a[96:111]
    v_mfma_f32_32x32x16_bf16 a[112:127], v[20:23], v[60:63], a[112:127]
    v_mfma_f32_32x32x16_bf16 a[128:143], v[24:27], v[48:51], a[128:143]
    v_mfma_f32_32x32x16_bf16 a[144:159], v[24:27], v[52:55], a[144:159]
    v_mfma_f32_32x32x16_bf16 a[160:175], v[24:27], v[56:59], a[160:175]
    v_mfma_f32_32x32x16_bf16 a[176:191], v[24:27], v[60:63], a[176:191]
    v_mfma_f32_32x32x16_bf16 a[192:207], v[28:31], v[48:51], a[192:207]
    v_mfma_f32_32x32x16_bf16 a[208:223], v[28:31], v[52:55], a[208:223]
    v_mfma_f32_32x32x16_bf16 a[224:239], v[28:31], v[56:59], a[224:239]
    v_mfma_f32_32x32x16_bf16 a[240:255], v[28:31], v[60:63], a[240:255]
    ds_read_b128 v[16:19], v12 offset:2048
    ds_read_b128 v[20:23], v12 offset:6144
    ds_read_b128 v[24:27], v12 offset:10240
    ds_read_b128 v[28:31], v12 offset:14336
    ds_read_b128 v[48:51], v13 offset:2048
    ds_read_b128 v[52:55], v13 offset:6144
    ds_read_b128 v[56:59], v13 offset:10240
    ds_read_b128 v[60:63], v13 offset:14336
    s_waitcnt lgkmcnt(8)
    v_mfma_f32_32x32x16_bf16 a[0:15], v[32:35], v[64:67], a[0:15]
    v_mfma_f32_32x32x16_bf16 a[16:31], v[32:35], v[68:71], a[16:31]
    v_mfma_f32_32x32x16_bf16 a[32:47], v[32:35], v[72:75], a[32:47]
    v_mfma_f32_32x32x16_bf16 a[48:63], v[32:35], v[76:79], a[48:63]
    v_mfma_f32_32x32x16_bf16 a[64:79], v[36:39], v[64:67], a[64:79]
    v_mfma_f32_32x32x16_bf16 a[80:95], v[36:39], v[68:71], a[80:95]
    v_mfma_f32_32x32x16_bf16 a[96:111], v[36:39], v[72:75], a[96:111]
    v_mfma_f32_32x32x16_bf16 a[112:127], v[36:39], v[76:79], a[112:127]
    v_mfma_f32_32x32x16_bf16 a[128:143], v[40:43], v[64:67], a[128:143]
    v_mfma_f32_32x32x16_bf16 a[144:159], v[40:43], v[68:71], a[144:159]
    v_mfma_f32_32x32x16_bf16 a[160:175], v[40:43], v[72:75], a[160:175]
    v_mfma_f32_32x32x16_bf16 a[176:191], v[40:43], v[76:79], a[176:191]
    v_mfma_f32_32x32x16_bf16 a[192:207], v[44:47], v[64:67], a[192:207]
    v_mfma_f32_32x32x16_bf16 a[208:223], v[44:47], v[68:71], a[208:223]
    v_mfma_f32_32x32x16_bf16 a[224:239], v[44:47], v[72:75], a[224:239]
    v_mfma_f32_32x32x16_bf16 a[240:255], v[44:47], v[76:79], a[240:255]
    ds_read_b128 v[32:35], v12 offset:3072
    ds_read_b128 v[36:39], v12 offset:7168
    ds_read_b128 v[40:43], v12 offset:11264
    ds_read_b128 v[44:47], v12 offset:15360
    ds_read_b128 v[64:67], v13 offset:3072
    ds_read_b128 v[68:71], v13 offset:7168
    ds_read_b128 v[72:75], v13 offset:11264
    ds_read_b128 v[76:79], v13 offset:15360
    s_waitcnt lgkmcnt(8)
    v_mfma_f32_32x32x16_bf16 a[0:15], v[16:19], v[48:51], a[0:15]
    v_mfma_f32_32x32x16_bf16 a[16:31], v[16:19], v[52:55], a[16:31]
    v_mfma_f32_32x32x16_bf16 a[32:47], v[16:19], v[56:59], a[32:47]
    v_mfma_f32_32x32x16_bf16 a[48:63], v[16:19], v[60:63], a[48:63]
    v_mfma_f32_32x32x16_bf16 a[64:79], v[20:23], v[48:51], a[64:79]
    v_mfma_f32_32x32x16_bf16 a[80:95], v[20:23], v[52:55], a[80:95]
    v_mfma_f32_32x32x16_bf16 a[96:111], v[20:23], v[56:59], a[96:111]
    v_mfma_f32_32x32x16_bf16 a[112:127], v[20:23], v[60:63], a[112:127]
    v_mfma_f32_32x32x16_bf16 a[128:143], v[24:27], v[48:51], a[128:143]
    v_mfma_f32_32x32x16_bf16 a[144:159], v[24:27], v[52:55], a[144:159]
    v_mfma_f32_32x32x16_bf16 a[160:175], v[24:27], v[56:59], a[160:175]
    v_mfma_f32_32x32x16_bf16 a[176:191], v[24:27], v[60:63], a[176:191]
    v_mfma_f32_32x32x16_bf16 a[192:207], v[28:31], v[48:51], a[192:207]
    v_mfma_f32_32x32x16_bf16 a[208:223], v[28:31], v[52:55], a[208:223]
    v_mfma_f32_32x32x16_bf16 a[224:239], v[28:31], v[56:59], a[224:239]
    v_mfma_f32_32x32x16_bf16 a[240:255], v[28:31], v[60:63], a[240:255]
    s_waitcnt lgkmcnt(0)
    v_mfma_f32_32x32x16_bf16 a[0:15], v[32:35], v[64:67], a[0:15]
    v_mfma_f32_32x32x16_bf16 a[16:31], v[32:35], v[68:71], a[16:31]
    v_mfma_f32_32x32x16_bf16 a[32:47], v[32:35], v[72:75], a[32:47]
    v_mfma_f32_32x32x16_bf16 a[48:63], v[32:35], v[76:79], a[48:63]
    v_mfma_f32_32x32x16_bf16 a[64:79], v[36:39], v[64:67], a[64:79]
    v_mfma_f32_32x32x16_bf16 a[80:95], v[36:39], v[68:71], a[80:95]
    v_mfma_f32_32x32x16_bf16 a[96:111], v[36:39], v[72:75], a[96:111]
    v_mfma_f32_32x32x16_bf16 a[112:127], v[36:39], v[76:79], a[112:127]
    v_mfma_f32_32x32x16_bf16 a[128:143], v[40:43], v[64:67], a[128:143]
    v_mfma_f32_32x32x16_bf16 a[144:159], v[40:43], v[68:71], a[144:159]
    v_mfma_f32_32x32x16_bf16 a[160:175], v[40:43], v[72:75], a[160:175]
    v_mfma_f32_32x32x16_bf16 a[176:191], v[40:43], v[76:79], a[176:191]
    v_mfma_f32_32x32x16_bf16 a[192:207], v[44:47], v[64:67], a[192:207]
    v_mfma_f32_32x32x16_bf16 a[208:223], v[44:47], v[68:71], a[208:223]
    v_mfma_f32_32x32x16_bf16 a[224:239], v[44:47], v[72:75], a[224:239]
    v_mfma_f32_32x32x16_bf16 a[240:255], v[44:47], v[76:79], a[240:255]
    s_waitcnt vmcnt(0)
    s_barrier
    ds_read_b128 v[16:19], v14 offset:0
    ds_read_b128 v[20:23], v14 offset:4096
    ds_read_b128 v[24:27], v14 offset:8192
    ds_read_b128 v[28:31], v14 offset:12288
    ds_read_b128 v[48:51], v15 offset:0
    ds_read_b128 v[52:55], v15 offset:4096
    ds_read_b128 v[56:59], v15 offset:8192
    ds_read_b128 v[60:63], v15 offset:12288
    s_add_u32 m0, s64, 0
    s_add_u32 s60, s62, 24576
    buffer_load_dwordx4 v4, s[36:39], s60 offen offset:0 lds
    buffer_load_dwordx4 v4, s[36:39], s60 offen offset:1024 lds
    buffer_load_dwordx4 v4, s[36:39], s60 offen offset:2048 lds
    buffer_load_dwordx4 v4, s[36:39], s60 offen offset:3072 lds
    s_add_u32 m0, s64, 4096
    s_add_u32 s60, s62, 53248
    buffer_load_dwordx4 v4, s[36:39], s60 offen offset:0 lds
    buffer_load_dwordx4 v4, s[36:39], s60 offen offset:1024 lds
    buffer_load_dwordx4 v4, s[36:39], s60 offen offset:2048 lds
    buffer_load_dwordx4 v4, s[36:39], s60 offen offset:3072 lds
    s_add_u32 m0, s65, 0
    s_add_u32 s60, s63, 24576
    buffer_load_dwordx4 v4, s[36:39], s60 offen offset:0 lds
    buffer_load_dwordx4 v4, s[36:39], s60 offen offset:1024 lds
    buffer_load_dwordx4 v4, s[36:39], s60 offen offset:2048 lds
    buffer_load_dwordx4 v4, s[36:39], s60 offen offset:3072 lds
    s_add_u32 m0, s65, 4096
    s_add_u32 s60, s63, 53248
    buffer_load_dwordx4 v4, s[36:39], s60 offen offset:0 lds
    buffer_load_dwordx4 v4, s[36:39], s60 offen offset:1024 lds
    buffer_load_dwordx4 v4, s[36:39], s60 offen offset:2048 lds
    buffer_load_dwordx4 v4, s[36:39], s60 offen offset:3072 lds
    ds_read_b128 v[32:35], v14 offset:1024
    ds_read_b128 v[36:39], v14 offset:5120
    ds_read_b128 v[40:43], v14 offset:9216
    ds_read_b128 v[44:47], v14 offset:13312
    ds_read_b128 v[64:67], v15 offset:1024
    ds_read_b128 v[68:71], v15 offset:5120
    ds_read_b128 v[72:75], v15 offset:9216
    ds_read_b128 v[76:79], v15 offset:13312
    s_waitcnt lgkmcnt(8)
    v_mfma_f32_32x32x16_bf16 a[0:15], v[16:19], v[48:51], a[0:15]
    v_mfma_f32_32x32x16_bf16 a[16:31], v[16:19], v[52:55], a[16:31]
    v_mfma_f32_32x32x16_bf16 a[32:47], v[16:19], v[56:59], a[32:47]
    v_mfma_f32_32x32x16_bf16 a[48:63], v[16:19], v[60:63], a[48:63]
    v_mfma_f32_32x32x16_bf16 a[64:79], v[20:23], v[48:51], a[64:79]
    v_mfma_f32_32x32x16_bf16 a[80:95], v[20:23], v[52:55], a[80:95]
    v_mfma_f32_32x32x16_bf16 a[96:111], v[20:23], v[56:59], a[96:111]
    v_mfma_f32_32x32x16_bf16 a[112:127], v[20:23], v[60:63], a[112:127]
    v_mfma_f32_32x32x16_bf16 a[128:143], v[24:27], v[48:51], a[128:143]
    v_mfma_f32_32x32x16_bf16 a[144:159], v[24:27], v[52:55], a[144:159]
    v_mfma_f32_32x32x16_bf16 a[160:175], v[24:27], v[56:59], a[160:175]
    v_mfma_f32_32x32x16_bf16 a[176:191], v[24:27], v[60:63], a[176:191]
    v_mfma_f32_32x32x16_bf16 a[192:207], v[28:31], v[48:51], a[192:207]
    v_mfma_f32_32x32x16_bf16 a[208:223], v[28:31], v[52:55], a[208:223]
    v_mfma_f32_32x32x16_bf16 a[224:239], v[28:31], v[56:59], a[224:239]
    v_mfma_f32_32x32x16_bf16 a[240:255], v[28:31], v[60:63], a[240:255]
    ds_read_b128 v[16:19], v14 offset:2048
    ds_read_b128 v[20:23], v14 offset:6144
    ds_read_b128 v[24:27], v14 offset:10240
    ds_read_b128 v[28:31], v14 offset:14336
    ds_read_b128 v[48:51], v15 offset:2048
    ds_read_b128 v[52:55], v15 offset:6144
    ds_read_b128 v[56:59], v15 offset:10240
    ds_read_b128 v[60:63], v15 offset:14336
    s_waitcnt lgkmcnt(8)
    v_mfma_f32_32x32x16_bf16 a[0:15], v[32:35], v[64:67], a[0:15]
    v_mfma_f32_32x32x16_bf16 a[16:31], v[32:35], v[68:71], a[16:31]
    v_mfma_f32_32x32x16_bf16 a[32:47], v[32:35], v[72:75], a[32:47]
    v_mfma_f32_32x32x16_bf16 a[48:63], v[32:35], v[76:79], a[48:63]
    v_mfma_f32_32x32x16_bf16 a[64:79], v[36:39], v[64:67], a[64:79]
    v_mfma_f32_32x32x16_bf16 a[80:95], v[36:39], v[68:71], a[80:95]
    v_mfma_f32_32x32x16_bf16 a[96:111], v[36:39], v[72:75], a[96:111]
    v_mfma_f32_32x32x16_bf16 a[112:127], v[36:39], v[76:79], a[112:127]
    v_mfma_f32_32x32x16_bf16 a[128:143], v[40:43], v[64:67], a[128:143]
    v_mfma_f32_32x32x16_bf16 a[144:159], v[40:43], v[68:71], a[144:159]
    v_mfma_f32_32x32x16_bf16 a[160:175], v[40:43], v[72:75], a[160:175]
    v_mfma_f32_32x32x16_bf16 a[176:191], v[40:43], v[76:79], a[176:191]
    v_mfma_f32_32x32x16_bf16 a[192:207], v[44:47], v[64:67], a[192:207]
    v_mfma_f32_32x32x16_bf16 a[208:223], v[44:47], v[68:71], a[208:223]
    v_mfma_f32_32x32x16_bf16 a[224:239], v[44:47], v[72:75], a[224:239]
    v_mfma_f32_32x32x16_bf16 a[240:255], v[44:47], v[76:79], a[240:255]
    ds_read_b128 v[32:35], v14 offset:3072
    ds_read_b128 v[36:39], v14 offset:7168
    ds_read_b128 v[40:43], v14 offset:11264
    ds_read_b128 v[44:47], v14 offset:15360
    ds_read_b128 v[64:67], v15 offset:3072
    ds_read_b128 v[68:71], v15 offset:7168
    ds_read_b128 v[72:75], v15 offset:11264
    ds_read_b128 v[76:79], v15 offset:15360
    s_waitcnt lgkmcnt(8)
    v_mfma_f32_32x32x16_bf16 a[0:15], v[16:19], v[48:51], a[0:15]
    v_mfma_f32_32x32x16_bf16 a[16:31], v[16:19], v[52:55], a[16:31]
    v_mfma_f32_32x32x16_bf16 a[32:47], v[16:19], v[56:59], a[32:47]
    v_mfma_f32_32x32x16_bf16 a[48:63], v[16:19], v[60:63], a[48:63]
    v_mfma_f32_32x32x16_bf16 a[64:79], v[20:23], v[48:51], a[64:79]
    v_mfma_f32_32x32x16_bf16 a[80:95], v[20:23], v[52:55], a[80:95]
    v_mfma_f32_32x32x16_bf16 a[96:111], v[20:23], v[56:59], a[96:111]
    v_mfma_f32_32x32x16_bf16 a[112:127], v[20:23], v[60:63], a[112:127]
    v_mfma_f32_32x32x16_bf16 a[128:143], v[24:27], v[48:51], a[128:143]
    v_mfma_f32_32x32x16_bf16 a[144:159], v[24:27], v[52:55], a[144:159]
    v_mfma_f32_32x32x16_bf16 a[160:175], v[24:27], v[56:59], a[160:175]
    v_mfma_f32_32x32x16_bf16 a[176:191], v[24:27], v[60:63], a[176:191]
    v_mfma_f32_32x32x16_bf16 a[192:207], v[28:31], v[48:51], a[192:207]
    v_mfma_f32_32x32x16_bf16 a[208:223], v[28:31], v[52:55], a[208:223]
    v_mfma_f32_32x32x16_bf16 a[224:239], v[28:31], v[56:59], a[224:239]
    v_mfma_f32_32x32x16_bf16 a[240:255], v[28:31], v[60:63], a[240:255]
    s_waitcnt lgkmcnt(0)
    v_mfma_f32_32x32x16_bf16 a[0:15], v[32:35], v[64:67], a[0:15]
    v_mfma_f32_32x32x16_bf16 a[16:31], v[32:35], v[68:71], a[16:31]
    v_mfma_f32_32x32x16_bf16 a[32:47], v[32:35], v[72:75], a[32:47]
    v_mfma_f32_32x32x16_bf16 a[48:63], v[32:35], v[76:79], a[48:63]
    v_mfma_f32_32x32x16_bf16 a[64:79], v[36:39], v[64:67], a[64:79]
    v_mfma_f32_32x32x16_bf16 a[80:95], v[36:39], v[68:71], a[80:95]
    v_mfma_f32_32x32x16_bf16 a[96:111], v[36:39], v[72:75], a[96:111]
    v_mfma_f32_32x32x16_bf16 a[112:127], v[36:39], v[76:79], a[112:127]
    v_mfma_f32_32x32x16_bf16 a[128:143], v[40:43], v[64:67], a[128:143]
    v_mfma_f32_32x32x16_bf16 a[144:159], v[40:43], v[68:71], a[144:159]
    v_mfma_f32_32x32x16_bf16 a[160:175], v[40:43], v[72:75], a[160:175]
    v_mfma_f32_32x32x16_bf16 a[176:191], v[40:43], v[76:79], a[176:191]
    v_mfma_f32_32x32x16_bf16 a[192:207], v[44:47], v[64:67], a[192:207]
    v_mfma_f32_32x32x16_bf16 a[208:223], v[44:47], v[68:71], a[208:223]
    v_mfma_f32_32x32x16_bf16 a[224:239], v[44:47], v[72:75], a[224:239]
    v_mfma_f32_32x32x16_bf16 a[240:255], v[44:47], v[76:79], a[240:255]
    s_waitcnt vmcnt(0)
    s_barrier
    ds_read_b128 v[16:19], v12 offset:0
    ds_read_b128 v[20:23], v12 offset:4096
    ds_read_b128 v[24:27], v12 offset:8192
    ds_read_b128 v[28:31], v12 offset:12288
    ds_read_b128 v[48:51], v13 offset:0
    ds_read_b128 v[52:55], v13 offset:4096
    ds_read_b128 v[56:59], v13 offset:8192
    ds_read_b128 v[60:63], v13 offset:12288
    ds_read_b128 v[32:35], v12 offset:1024
    ds_read_b128 v[36:39], v12 offset:5120
    ds_read_b128 v[40:43], v12 offset:9216
    ds_read_b128 v[44:47], v12 offset:13312
    ds_read_b128 v[64:67], v13 offset:1024
    ds_read_b128 v[68:71], v13 offset:5120
    ds_read_b128 v[72:75], v13 offset:9216
    ds_read_b128 v[76:79], v13 offset:13312
    s_waitcnt lgkmcnt(8)
    v_mfma_f32_32x32x16_bf16 a[0:15], v[16:19], v[48:51], a[0:15]
    v_mfma_f32_32x32x16_bf16 a[16:31], v[16:19], v[52:55], a[16:31]
    v_mfma_f32_32x32x16_bf16 a[32:47], v[16:19], v[56:59], a[32:47]
    v_mfma_f32_32x32x16_bf16 a[48:63], v[16:19], v[60:63], a[48:63]
    v_mfma_f32_32x32x16_bf16 a[64:79], v[20:23], v[48:51], a[64:79]
    v_mfma_f32_32x32x16_bf16 a[80:95], v[20:23], v[52:55], a[80:95]
    v_mfma_f32_32x32x16_bf16 a[96:111], v[20:23], v[56:59], a[96:111]
    v_mfma_f32_32x32x16_bf16 a[112:127], v[20:23], v[60:63], a[112:127]
    v_mfma_f32_32x32x16_bf16 a[128:143], v[24:27], v[48:51], a[128:143]
    v_mfma_f32_32x32x16_bf16 a[144:159], v[24:27], v[52:55], a[144:159]
    v_mfma_f32_32x32x16_bf16 a[160:175], v[24:27], v[56:59], a[160:175]
    v_mfma_f32_32x32x16_bf16 a[176:191], v[24:27], v[60:63], a[176:191]
    v_mfma_f32_32x32x16_bf16 a[192:207], v[28:31], v[48:51], a[192:207]
    v_mfma_f32_32x32x16_bf16 a[208:223], v[28:31], v[52:55], a[208:223]
    v_mfma_f32_32x32x16_bf16 a[224:239], v[28:31], v[56:59], a[224:239]
    v_mfma_f32_32x32x16_bf16 a[240:255], v[28:31], v[60:63], a[240:255]
    ds_read_b128 v[16:19], v12 offset:2048
    ds_read_b128 v[20:23], v12 offset:6144
    ds_read_b128 v[24:27], v12 offset:10240
    ds_read_b128 v[28:31], v12 offset:14336
    ds_read_b128 v[48:51], v13 offset:2048
    ds_read_b128 v[52:55], v13 offset:6144
    ds_read_b128 v[56:59], v13 offset:10240
    ds_read_b128 v[60:63], v13 offset:14336
    s_waitcnt lgkmcnt(8)
    v_mfma_f32_32x32x16_bf16 a[0:15], v[32:35], v[64:67], a[0:15]
    v_mfma_f32_32x32x16_bf16 a[16:31], v[32:35], v[68:71], a[16:31]
    v_mfma_f32_32x32x16_bf16 a[32:47], v[32:35], v[72:75], a[32:47]
    v_mfma_f32_32x32x16_bf16 a[48:63], v[32:35], v[76:79], a[48:63]
    v_mfma_f32_32x32x16_bf16 a[64:79], v[36:39], v[64:67], a[64:79]
    v_mfma_f32_32x32x16_bf16 a[80:95], v[36:39], v[68:71], a[80:95]
    v_mfma_f32_32x32x16_bf16 a[96:111], v[36:39], v[72:75], a[96:111]
    v_mfma_f32_32x32x16_bf16 a[112:127], v[36:39], v[76:79], a[112:127]
    v_mfma_f32_32x32x16_bf16 a[128:143], v[40:43], v[64:67], a[128:143]
    v_mfma_f32_32x32x16_bf16 a[144:159], v[40:43], v[68:71], a[144:159]
    v_mfma_f32_32x32x16_bf16 a[160:175], v[40:43], v[72:75], a[160:175]
    v_mfma_f32_32x32x16_bf16 a[176:191], v[40:43], v[76:79], a[176:191]
    v_mfma_f32_32x32x16_bf16 a[192:207], v[44:47], v[64:67], a[192:207]
    v_mfma_f32_32x32x16_bf16 a[208:223], v[44:47], v[68:71], a[208:223]
    v_mfma_f32_32x32x16_bf16 a[224:239], v[44:47], v[72:75], a[224:239]
    v_mfma_f32_32x32x16_bf16 a[240:255], v[44:47], v[76:79], a[240:255]
    ds_read_b128 v[32:35], v12 offset:3072
    ds_read_b128 v[36:39], v12 offset:7168
    ds_read_b128 v[40:43], v12 offset:11264
    ds_read_b128 v[44:47], v12 offset:15360
    ds_read_b128 v[64:67], v13 offset:3072
    ds_read_b128 v[68:71], v13 offset:7168
    ds_read_b128 v[72:75], v13 offset:11264
    ds_read_b128 v[76:79], v13 offset:15360
    s_waitcnt lgkmcnt(8)
    v_mfma_f32_32x32x16_bf16 a[0:15], v[16:19], v[48:51], a[0:15]
    v_mfma_f32_32x32x16_bf16 a[16:31], v[16:19], v[52:55], a[16:31]
    v_mfma_f32_32x32x16_bf16 a[32:47], v[16:19], v[56:59], a[32:47]
    v_mfma_f32_32x32x16_bf16 a[48:63], v[16:19], v[60:63], a[48:63]
    v_mfma_f32_32x32x16_bf16 a[64:79], v[20:23], v[48:51], a[64:79]
    v_mfma_f32_32x32x16_bf16 a[80:95], v[20:23], v[52:55], a[80:95]
    v_mfma_f32_32x32x16_bf16 a[96:111], v[20:23], v[56:59], a[96:111]
    v_mfma_f32_32x32x16_bf16 a[112:127], v[20:23], v[60:63], a[112:127]
    v_mfma_f32_32x32x16_bf16 a[128:143], v[24:27], v[48:51], a[128:143]
    v_mfma_f32_32x32x16_bf16 a[144:159], v[24:27], v[52:55], a[144:159]
    v_mfma_f32_32x32x16_bf16 a[160:175], v[24:27], v[56:59], a[160:175]
    v_mfma_f32_32x32x16_bf16 a[176:191], v[24:27], v[60:63], a[176:191]
    v_mfma_f32_32x32x16_bf16 a[192:207], v[28:31], v[48:51], a[192:207]
    v_mfma_f32_32x32x16_bf16 a[208:223], v[28:31], v[52:55], a[208:223]
    v_mfma_f32_32x32x16_bf16 a[224:239], v[28:31], v[56:59], a[224:239]
    v_mfma_f32_32x32x16_bf16 a[240:255], v[28:31], v[60:63], a[240:255]
    s_waitcnt lgkmcnt(0)
    v_mfma_f32_32x32x16_bf16 a[0:15], v[32:35], v[64:67], a[0:15]
    v_mfma_f32_32x32x16_bf16 a[16:31], v[32:35], v[68:71], a[16:31]
    v_mfma_f32_32x32x16_bf16 a[32:47], v[32:35], v[72:75], a[32:47]
    v_mfma_f32_32x32x16_bf16 a[48:63], v[32:35], v[76:79], a[48:63]
    v_mfma_f32_32x32x16_bf16 a[64:79], v[36:39], v[64:67], a[64:79]
    v_mfma_f32_32x32x16_bf16 a[80:95], v[36:39], v[68:71], a[80:95]
    v_mfma_f32_32x32x16_bf16 a[96:111], v[36:39], v[72:75], a[96:111]
    v_mfma_f32_32x32x16_bf16 a[112:127], v[36:39], v[76:79], a[112:127]
    v_mfma_f32_32x32x16_bf16 a[128:143], v[40:43], v[64:67], a[128:143]
    v_mfma_f32_32x32x16_bf16 a[144:159], v[40:43], v[68:71], a[144:159]
    v_mfma_f32_32x32x16_bf16 a[160:175], v[40:43], v[72:75], a[160:175]
    v_mfma_f32_32x32x16_bf16 a[176:191], v[40:43], v[76:79], a[176:191]
    v_mfma_f32_32x32x16_bf16 a[192:207], v[44:47], v[64:67], a[192:207]
    v_mfma_f32_32x32x16_bf16 a[208:223], v[44:47], v[68:71], a[208:223]
    v_mfma_f32_32x32x16_bf16 a[224:239], v[44:47], v[72:75], a[224:239]
    v_mfma_f32_32x32x16_bf16 a[240:255], v[44:47], v[76:79], a[240:255]
    s_lshl_b32 s54, s54, 1
    s_and_b32 s58, s40, 1
    s_add_u32 s54, s54, s58
    s_lshl_b32 s55, s55, 1
    s_lshr_b32 s58, s40, 1
    s_add_u32 s55, s55, s58
    v_and_b32 v6, 15, v2
    v_lshl_add_u32 v6, v3, 4, v6
    v_lshlrev_b32 v6, 4, v6
    v_mul_u32_u24 v7, 16*14*1024, v5
    v_add_u32 v7, v7, v6
    s_nop 7
    s_nop 7
    s_lshl_b32 s58, s55, 2
    s_add_u32 s58, s58, 0
    s_mul_i32 s59, s58, 4682
    s_lshr_b32 s59, s59, 16
    s_mul_i32 s61, s59, 14
    s_sub_u32 s61, s58, s61
    s_mul_i32 s59, s59, 14
    s_add_u32 s59, s59, s61
    s_lshl_b32 s61, s54, 3
    s_mul_i32 s61, s61, 16*14
    s_add_u32 s59, s59, s61
    s_lshl_b32 s59, s59, 10
    s_add_u32 s59, s59, 50331648
    v_accvgpr_read_b32 v16, a0
    v_accvgpr_read_b32 v17, a1
    v_accvgpr_read_b32 v18, a2
    v_accvgpr_read_b32 v19, a3
    v_accvgpr_read_b32 v20, a4
    v_accvgpr_read_b32 v21, a5
    v_accvgpr_read_b32 v22, a6
    v_accvgpr_read_b32 v23, a7
    v_accvgpr_read_b32 v24, a8
    v_accvgpr_read_b32 v25, a9
    v_accvgpr_read_b32 v26, a10
    v_accvgpr_read_b32 v27, a11
    v_accvgpr_read_b32 v28, a12
    v_accvgpr_read_b32 v29, a13
    v_accvgpr_read_b32 v30, a14
    v_accvgpr_read_b32 v31, a15
    v_cvt_pk_bf16_f32 v32, v16, v17
    v_cvt_pk_bf16_f32 v33, v18, v19
    v_cvt_pk_bf16_f32 v34, v20, v21
    v_cvt_pk_bf16_f32 v35, v22, v23
    v_cvt_pk_bf16_f32 v36, v24, v25
    v_cvt_pk_bf16_f32 v37, v26, v27
    v_cvt_pk_bf16_f32 v38, v28, v29
    v_cvt_pk_bf16_f32 v39, v30, v31
    s_add_u32 s61, s59, 0
    s_nop 0
    v_permlane32_swap_b32 v32, v34
    v_permlane32_swap_b32 v33, v35
    v_permlane32_swap_b32 v36, v38
    v_permlane32_swap_b32 v37, v39
    buffer_store_dwordx4 v[32:35], v7, s[36:39], s61 offen offset:0 sc1
    buffer_store_dwordx4 v[36:39], v7, s[36:39], s61 offen offset:512 sc1
    s_nop 1
    v_accvgpr_read_b32 v16, a16
    v_accvgpr_read_b32 v17, a17
    v_accvgpr_read_b32 v18, a18
    v_accvgpr_read_b32 v19, a19
    v_accvgpr_read_b32 v20, a20
    v_accvgpr_read_b32 v21, a21
    v_accvgpr_read_b32 v22, a22
    v_accvgpr_read_b32 v23, a23
    v_accvgpr_read_b32 v24, a24
    v_accvgpr_read_b32 v25, a25
    v_accvgpr_read_b32 v26, a26
    v_accvgpr_read_b32 v27, a27
    v_accvgpr_read_b32 v28, a28
    v_accvgpr_read_b32 v29, a29
    v_accvgpr_read_b32 v30, a30
    v_accvgpr_read_b32 v31, a31
    v_cvt_pk_bf16_f32 v32, v16, v17
    v_cvt_pk_bf16_f32 v33, v18, v19
    v_cvt_pk_bf16_f32 v34, v20, v21
    v_cvt_pk_bf16_f32 v35, v22, v23
    v_cvt_pk_bf16_f32 v36, v24, v25
    v_cvt_pk_bf16_f32 v37, v26, v27
    v_cvt_pk_bf16_f32 v38, v28, v29
    v_cvt_pk_bf16_f32 v39, v30, v31
    s_add_u32 s61, s59, 458752
    s_nop 0
    v_permlane32_swap_b32 v32, v34
    v_permlane32_swap_b32 v33, v35
    v_permlane32_swap_b32 v36, v38
    v_permlane32_swap_b32 v37, v39
    buffer_store_dwordx4 v[32:35], v7, s[36:39], s61 offen offset:0 sc1
    buffer_store_dwordx4 v[36:39], v7, s[36:39], s61 offen offset:512 sc1
    s_nop 1
    v_accvgpr_read_b32 v16, a32
    v_accvgpr_read_b32 v17, a33
    v_accvgpr_read_b32 v18, a34
    v_accvgpr_read_b32 v19, a35
    v_accvgpr_read_b32 v20, a36
    v_accvgpr_read_b32 v21, a37
    v_accvgpr_read_b32 v22, a38
    v_accvgpr_read_b32 v23, a39
    v_accvgpr_read_b32 v24, a40
    v_accvgpr_read_b32 v25, a41
    v_accvgpr_read_b32 v26, a42
    v_accvgpr_read_b32 v27, a43
    v_accvgpr_read_b32 v28, a44
    v_accvgpr_read_b32 v29, a45
    v_accvgpr_read_b32 v30, a46
    v_accvgpr_read_b32 v31, a47
    v_cvt_pk_bf16_f32 v32, v16, v17
    v_cvt_pk_bf16_f32 v33, v18, v19
    v_cvt_pk_bf16_f32 v34, v20, v21
    v_cvt_pk_bf16_f32 v35, v22, v23
    v_cvt_pk_bf16_f32 v36, v24, v25
    v_cvt_pk_bf16_f32 v37, v26, v27
    v_cvt_pk_bf16_f32 v38, v28, v29
    v_cvt_pk_bf16_f32 v39, v30, v31
    s_add_u32 s61, s59, 917504
    s_nop 0
    v_permlane32_swap_b32 v32, v34
    v_permlane32_swap_b32 v33, v35
    v_permlane32_swap_b32 v36, v38
    v_permlane32_swap_b32 v37, v39
    buffer_store_dwordx4 v[32:35], v7, s[36:39], s61 offen offset:0 sc1
    buffer_store_dwordx4 v[36:39], v7, s[36:39], s61 offen offset:512 sc1
    s_nop 1
    v_accvgpr_read_b32 v16, a48
    v_accvgpr_read_b32 v17, a49
    v_accvgpr_read_b32 v18, a50
    v_accvgpr_read_b32 v19, a51
    v_accvgpr_read_b32 v20, a52
    v_accvgpr_read_b32 v21, a53
    v_accvgpr_read_b32 v22, a54
    v_accvgpr_read_b32 v23, a55
    v_accvgpr_read_b32 v24, a56
    v_accvgpr_read_b32 v25, a57
    v_accvgpr_read_b32 v26, a58
    v_accvgpr_read_b32 v27, a59
    v_accvgpr_read_b32 v28, a60
    v_accvgpr_read_b32 v29, a61
    v_accvgpr_read_b32 v30, a62
    v_accvgpr_read_b32 v31, a63
    v_cvt_pk_bf16_f32 v32, v16, v17
    v_cvt_pk_bf16_f32 v33, v18, v19
    v_cvt_pk_bf16_f32 v34, v20, v21
    v_cvt_pk_bf16_f32 v35, v22, v23
    v_cvt_pk_bf16_f32 v36, v24, v25
    v_cvt_pk_bf16_f32 v37, v26, v27
    v_cvt_pk_bf16_f32 v38, v28, v29
    v_cvt_pk_bf16_f32 v39, v30, v31
    s_add_u32 s61, s59, 1376256
    s_nop 0
    v_permlane32_swap_b32 v32, v34
    v_permlane32_swap_b32 v33, v35
    v_permlane32_swap_b32 v36, v38
    v_permlane32_swap_b32 v37, v39
    buffer_store_dwordx4 v[32:35], v7, s[36:39], s61 offen offset:0 sc1
    buffer_store_dwordx4 v[36:39], v7, s[36:39], s61 offen offset:512 sc1
    s_nop 1
    s_lshl_b32 s58, s55, 2
    s_add_u32 s58, s58, 1
    s_mul_i32 s59, s58, 4682
    s_lshr_b32 s59, s59, 16
    s_mul_i32 s61, s59, 14
    s_sub_u32 s61, s58, s61
    s_mul_i32 s59, s59, 14
    s_add_u32 s59, s59, s61
    s_lshl_b32 s61, s54, 3
    s_mul_i32 s61, s61, 16*14
    s_add_u32 s59, s59, s61
    s_lshl_b32 s59, s59, 10
    s_add_u32 s59, s59, 50331648
    v_accvgpr_read_b32 v16, a64
    v_accvgpr_read_b32 v17, a65
    v_accvgpr_read_b32 v18, a66
    v_accvgpr_read_b32 v19, a67
    v_accvgpr_read_b32 v20, a68
    v_accvgpr_read_b32 v21, a69
    v_accvgpr_read_b32 v22, a70
    v_accvgpr_read_b32 v23, a71
    v_accvgpr_read_b32 v24, a72
    v_accvgpr_read_b32 v25, a73
    v_accvgpr_read_b32 v26, a74
    v_accvgpr_read_b32 v27, a75
    v_accvgpr_read_b32 v28, a76
    v_accvgpr_read_b32 v29, a77
    v_accvgpr_read_b32 v30, a78
    v_accvgpr_read_b32 v31, a79
    v_cvt_pk_bf16_f32 v32, v16, v17
    v_cvt_pk_bf16_f32 v33, v18, v19
    v_cvt_pk_bf16_f32 v34, v20, v21
    v_cvt_pk_bf16_f32 v35, v22, v23
    v_cvt_pk_bf16_f32 v36, v24, v25
    v_cvt_pk_bf16_f32 v37, v26, v27
    v_cvt_pk_bf16_f32 v38, v28, v29
    v_cvt_pk_bf16_f32 v39, v30, v31
    s_add_u32 s61, s59, 0
    s_nop 0
    v_permlane32_swap_b32 v32, v34
    v_permlane32_swap_b32 v33, v35
    v_permlane32_swap_b32 v36, v38
    v_permlane32_swap_b32 v37, v39
    buffer_store_dwordx4 v[32:35], v7, s[36:39], s61 offen offset:0 sc1
    buffer_store_dwordx4 v[36:39], v7, s[36:39], s61 offen offset:512 sc1
    s_nop 1
    v_accvgpr_read_b32 v16, a80
    v_accvgpr_read_b32 v17, a81
    v_accvgpr_read_b32 v18, a82
    v_accvgpr_read_b32 v19, a83
    v_accvgpr_read_b32 v20, a84
    v_accvgpr_read_b32 v21, a85
    v_accvgpr_read_b32 v22, a86
    v_accvgpr_read_b32 v23, a87
    v_accvgpr_read_b32 v24, a88
    v_accvgpr_read_b32 v25, a89
    v_accvgpr_read_b32 v26, a90
    v_accvgpr_read_b32 v27, a91
    v_accvgpr_read_b32 v28, a92
    v_accvgpr_read_b32 v29, a93
    v_accvgpr_read_b32 v30, a94
    v_accvgpr_read_b32 v31, a95
    v_cvt_pk_bf16_f32 v32, v16, v17
    v_cvt_pk_bf16_f32 v33, v18, v19
    v_cvt_pk_bf16_f32 v34, v20, v21
    v_cvt_pk_bf16_f32 v35, v22, v23
    v_cvt_pk_bf16_f32 v36, v24, v25
    v_cvt_pk_bf16_f32 v37, v26, v27
    v_cvt_pk_bf16_f32 v38, v28, v29
    v_cvt_pk_bf16_f32 v39, v30, v31
    s_add_u32 s61, s59, 458752
    s_nop 0
    v_permlane32_swap_b32 v32, v34
    v_permlane32_swap_b32 v33, v35
    v_permlane32_swap_b32 v36, v38
    v_permlane32_swap_b32 v37, v39
    buffer_store_dwordx4 v[32:35], v7, s[36:39], s61 offen offset:0 sc1
    buffer_store_dwordx4 v[36:39], v7, s[36:39], s61 offen offset:512 sc1
    s_nop 1
    v_accvgpr_read_b32 v16, a96
    v_accvgpr_read_b32 v17, a97
    v_accvgpr_read_b32 v18, a98
    v_accvgpr_read_b32 v19, a99
    v_accvgpr_read_b32 v20, a100
    v_accvgpr_read_b32 v21, a101
    v_accvgpr_read_b32 v22, a102
    v_accvgpr_read_b32 v23, a103
    v_accvgpr_read_b32 v24, a104
    v_accvgpr_read_b32 v25, a105
    v_accvgpr_read_b32 v26, a106
    v_accvgpr_read_b32 v27, a107
    v_accvgpr_read_b32 v28, a108
    v_accvgpr_read_b32 v29, a109
    v_accvgpr_read_b32 v30, a110
    v_accvgpr_read_b32 v31, a111
    v_cvt_pk_bf16_f32 v32, v16, v17
    v_cvt_pk_bf16_f32 v33, v18, v19
    v_cvt_pk_bf16_f32 v34, v20, v21
    v_cvt_pk_bf16_f32 v35, v22, v23
    v_cvt_pk_bf16_f32 v36, v24, v25
    v_cvt_pk_bf16_f32 v37, v26, v27
    v_cvt_pk_bf16_f32 v38, v28, v29
    v_cvt_pk_bf16_f32 v39, v30, v31
    s_add_u32 s61, s59, 917504
    s_nop 0
    v_permlane32_swap_b32 v32, v34
    v_permlane32_swap_b32 v33, v35
    v_permlane32_swap_b32 v36, v38
    v_permlane32_swap_b32 v37, v39
    buffer_store_dwordx4 v[32:35], v7, s[36:39], s61 offen offset:0 sc1
    buffer_store_dwordx4 v[36:39], v7, s[36:39], s61 offen offset:512 sc1
    s_nop 1
    v_accvgpr_read_b32 v16, a112
    v_accvgpr_read_b32 v17, a113
    v_accvgpr_read_b32 v18, a114
    v_accvgpr_read_b32 v19, a115
    v_accvgpr_read_b32 v20, a116
    v_accvgpr_read_b32 v21, a117
    v_accvgpr_read_b32 v22, a118
    v_accvgpr_read_b32 v23, a119
    v_accvgpr_read_b32 v24, a120
    v_accvgpr_read_b32 v25, a121
    v_accvgpr_read_b32 v26, a122
    v_accvgpr_read_b32 v27, a123
    v_accvgpr_read_b32 v28, a124
    v_accvgpr_read_b32 v29, a125
    v_accvgpr_read_b32 v30, a126
    v_accvgpr_read_b32 v31, a127
    v_cvt_pk_bf16_f32 v32, v16, v17
    v_cvt_pk_bf16_f32 v33, v18, v19
    v_cvt_pk_bf16_f32 v34, v20, v21
    v_cvt_pk_bf16_f32 v35, v22, v23
    v_cvt_pk_bf16_f32 v36, v24, v25
    v_cvt_pk_bf16_f32 v37, v26, v27
    v_cvt_pk_bf16_f32 v38, v28, v29
    v_cvt_pk_bf16_f32 v39, v30, v31
    s_add_u32 s61, s59, 1376256
    s_nop 0
    v_permlane32_swap_b32 v32, v34
    v_permlane32_swap_b32 v33, v35
    v_permlane32_swap_b32 v36, v38
    v_permlane32_swap_b32 v37, v39
    buffer_store_dwordx4 v[32:35], v7, s[36:39], s61 offen offset:0 sc1
    buffer_store_dwordx4 v[36:39], v7, s[36:39], s61 offen offset:512 sc1
    s_nop 1
    s_lshl_b32 s58, s55, 2
    s_add_u32 s58, s58, 2
    s_mul_i32 s59, s58, 4682
    s_lshr_b32 s59, s59, 16
    s_mul_i32 s61, s59, 14
    s_sub_u32 s61, s58, s61
    s_mul_i32 s59, s59, 14
    s_add_u32 s59, s59, s61
    s_lshl_b32 s61, s54, 3
    s_mul_i32 s61, s61, 16*14
    s_add_u32 s59, s59, s61
    s_lshl_b32 s59, s59, 10
    s_add_u32 s59, s59, 50331648
    v_accvgpr_read_b32 v16, a128
    v_accvgpr_read_b32 v17, a129
    v_accvgpr_read_b32 v18, a130
    v_accvgpr_read_b32 v19, a131
    v_accvgpr_read_b32 v20, a132
    v_accvgpr_read_b32 v21, a133
    v_accvgpr_read_b32 v22, a134
    v_accvgpr_read_b32 v23, a135
    v_accvgpr_read_b32 v24, a136
    v_accvgpr_read_b32 v25, a137
    v_accvgpr_read_b32 v26, a138
    v_accvgpr_read_b32 v27, a139
    v_accvgpr_read_b32 v28, a140
    v_accvgpr_read_b32 v29, a141
    v_accvgpr_read_b32 v30, a142
    v_accvgpr_read_b32 v31, a143
    v_cvt_pk_bf16_f32 v32, v16, v17
    v_cvt_pk_bf16_f32 v33, v18, v19
    v_cvt_pk_bf16_f32 v34, v20, v21
    v_cvt_pk_bf16_f32 v35, v22, v23
    v_cvt_pk_bf16_f32 v36, v24, v25
    v_cvt_pk_bf16_f32 v37, v26, v27
    v_cvt_pk_bf16_f32 v38, v28, v29
    v_cvt_pk_bf16_f32 v39, v30, v31
    s_add_u32 s61, s59, 0
    s_nop 0
    v_permlane32_swap_b32 v32, v34
    v_permlane32_swap_b32 v33, v35
    v_permlane32_swap_b32 v36, v38
    v_permlane32_swap_b32 v37, v39
    buffer_store_dwordx4 v[32:35], v7, s[36:39], s61 offen offset:0 sc1
    buffer_store_dwordx4 v[36:39], v7, s[36:39], s61 offen offset:512 sc1
    s_nop 1
    v_accvgpr_read_b32 v16, a144
    v_accvgpr_read_b32 v17, a145
    v_accvgpr_read_b32 v18, a146
    v_accvgpr_read_b32 v19, a147
    v_accvgpr_read_b32 v20, a148
    v_accvgpr_read_b32 v21, a149
    v_accvgpr_read_b32 v22, a150
    v_accvgpr_read_b32 v23, a151
    v_accvgpr_read_b32 v24, a152
    v_accvgpr_read_b32 v25, a153
    v_accvgpr_read_b32 v26, a154
    v_accvgpr_read_b32 v27, a155
    v_accvgpr_read_b32 v28, a156
    v_accvgpr_read_b32 v29, a157
    v_accvgpr_read_b32 v30, a158
    v_accvgpr_read_b32 v31, a159
    v_cvt_pk_bf16_f32 v32, v16, v17
    v_cvt_pk_bf16_f32 v33, v18, v19
    v_cvt_pk_bf16_f32 v34, v20, v21
    v_cvt_pk_bf16_f32 v35, v22, v23
    v_cvt_pk_bf16_f32 v36, v24, v25
    v_cvt_pk_bf16_f32 v37, v26, v27
    v_cvt_pk_bf16_f32 v38, v28, v29
    v_cvt_pk_bf16_f32 v39, v30, v31
    s_add_u32 s61, s59, 458752
    s_nop 0
    v_permlane32_swap_b32 v32, v34
    v_permlane32_swap_b32 v33, v35
    v_permlane32_swap_b32 v36, v38
    v_permlane32_swap_b32 v37, v39
    buffer_store_dwordx4 v[32:35], v7, s[36:39], s61 offen offset:0 sc1
    buffer_store_dwordx4 v[36:39], v7, s[36:39], s61 offen offset:512 sc1
    s_nop 1
    v_accvgpr_read_b32 v16, a160
    v_accvgpr_read_b32 v17, a161
    v_accvgpr_read_b32 v18, a162
    v_accvgpr_read_b32 v19, a163
    v_accvgpr_read_b32 v20, a164
    v_accvgpr_read_b32 v21, a165
    v_accvgpr_read_b32 v22, a166
    v_accvgpr_read_b32 v23, a167
    v_accvgpr_read_b32 v24, a168
    v_accvgpr_read_b32 v25, a169
    v_accvgpr_read_b32 v26, a170
    v_accvgpr_read_b32 v27, a171
    v_accvgpr_read_b32 v28, a172
    v_accvgpr_read_b32 v29, a173
    v_accvgpr_read_b32 v30, a174
    v_accvgpr_read_b32 v31, a175
    v_cvt_pk_bf16_f32 v32, v16, v17
    v_cvt_pk_bf16_f32 v33, v18, v19
    v_cvt_pk_bf16_f32 v34, v20, v21
    v_cvt_pk_bf16_f32 v35, v22, v23
    v_cvt_pk_bf16_f32 v36, v24, v25
    v_cvt_pk_bf16_f32 v37, v26, v27
    v_cvt_pk_bf16_f32 v38, v28, v29
    v_cvt_pk_bf16_f32 v39, v30, v31
    s_add_u32 s61, s59, 917504
    s_nop 0
    v_permlane32_swap_b32 v32, v34
    v_permlane32_swap_b32 v33, v35
    v_permlane32_swap_b32 v36, v38
    v_permlane32_swap_b32 v37, v39
    buffer_store_dwordx4 v[32:35], v7, s[36:39], s61 offen offset:0 sc1
    buffer_store_dwordx4 v[36:39], v7, s[36:39], s61 offen offset:512 sc1
    s_nop 1
    v_accvgpr_read_b32 v16, a176
    v_accvgpr_read_b32 v17, a177
    v_accvgpr_read_b32 v18, a178
    v_accvgpr_read_b32 v19, a179
    v_accvgpr_read_b32 v20, a180
    v_accvgpr_read_b32 v21, a181
    v_accvgpr_read_b32 v22, a182
    v_accvgpr_read_b32 v23, a183
    v_accvgpr_read_b32 v24, a184
    v_accvgpr_read_b32 v25, a185
    v_accvgpr_read_b32 v26, a186
    v_accvgpr_read_b32 v27, a187
    v_accvgpr_read_b32 v28, a188
    v_accvgpr_read_b32 v29, a189
    v_accvgpr_read_b32 v30, a190
    v_accvgpr_read_b32 v31, a191
    v_cvt_pk_bf16_f32 v32, v16, v17
    v_cvt_pk_bf16_f32 v33, v18, v19
    v_cvt_pk_bf16_f32 v34, v20, v21
    v_cvt_pk_bf16_f32 v35, v22, v23
    v_cvt_pk_bf16_f32 v36, v24, v25
    v_cvt_pk_bf16_f32 v37, v26, v27
    v_cvt_pk_bf16_f32 v38, v28, v29
    v_cvt_pk_bf16_f32 v39, v30, v31
    s_add_u32 s61, s59, 1376256
    s_nop 0
    v_permlane32_swap_b32 v32, v34
    v_permlane32_swap_b32 v33, v35
    v_permlane32_swap_b32 v36, v38
    v_permlane32_swap_b32 v37, v39
    buffer_store_dwordx4 v[32:35], v7, s[36:39], s61 offen offset:0 sc1
    buffer_store_dwordx4 v[36:39], v7, s[36:39], s61 offen offset:512 sc1
    s_nop 1
    s_lshl_b32 s58, s55, 2
    s_add_u32 s58, s58, 3
    s_mul_i32 s59, s58, 4682
    s_lshr_b32 s59, s59, 16
    s_mul_i32 s61, s59, 14
    s_sub_u32 s61, s58, s61
    s_mul_i32 s59, s59, 14
    s_add_u32 s59, s59, s61
    s_lshl_b32 s61, s54, 3
    s_mul_i32 s61, s61, 16*14
    s_add_u32 s59, s59, s61
    s_lshl_b32 s59, s59, 10
    s_add_u32 s59, s59, 50331648
    v_accvgpr_read_b32 v16, a192
    v_accvgpr_read_b32 v17, a193
    v_accvgpr_read_b32 v18, a194
    v_accvgpr_read_b32 v19, a195
    v_accvgpr_read_b32 v20, a196
    v_accvgpr_read_b32 v21, a197
    v_accvgpr_read_b32 v22, a198
    v_accvgpr_read_b32 v23, a199
    v_accvgpr_read_b32 v24, a200
    v_accvgpr_read_b32 v25, a201
    v_accvgpr_read_b32 v26, a202
    v_accvgpr_read_b32 v27, a203
    v_accvgpr_read_b32 v28, a204
    v_accvgpr_read_b32 v29, a205
    v_accvgpr_read_b32 v30, a206
    v_accvgpr_read_b32 v31, a207
    v_cvt_pk_bf16_f32 v32, v16, v17
    v_cvt_pk_bf16_f32 v33, v18, v19
    v_cvt_pk_bf16_f32 v34, v20, v21
    v_cvt_pk_bf16_f32 v35, v22, v23
    v_cvt_pk_bf16_f32 v36, v24, v25
    v_cvt_pk_bf16_f32 v37, v26, v27
    v_cvt_pk_bf16_f32 v38, v28, v29
    v_cvt_pk_bf16_f32 v39, v30, v31
    s_add_u32 s61, s59, 0
    s_nop 0
    v_permlane32_swap_b32 v32, v34
    v_permlane32_swap_b32 v33, v35
    v_permlane32_swap_b32 v36, v38
    v_permlane32_swap_b32 v37, v39
    buffer_store_dwordx4 v[32:35], v7, s[36:39], s61 offen offset:0 sc1
    buffer_store_dwordx4 v[36:39], v7, s[36:39], s61 offen offset:512 sc1
    s_nop 1
    v_accvgpr_read_b32 v16, a208
    v_accvgpr_read_b32 v17, a209
    v_accvgpr_read_b32 v18, a210
    v_accvgpr_read_b32 v19, a211
    v_accvgpr_read_b32 v20, a212
    v_accvgpr_read_b32 v21, a213
    v_accvgpr_read_b32 v22, a214
    v_accvgpr_read_b32 v23, a215
    v_accvgpr_read_b32 v24, a216
    v_accvgpr_read_b32 v25, a217
    v_accvgpr_read_b32 v26, a218
    v_accvgpr_read_b32 v27, a219
    v_accvgpr_read_b32 v28, a220
    v_accvgpr_read_b32 v29, a221
    v_accvgpr_read_b32 v30, a222
    v_accvgpr_read_b32 v31, a223
    v_cvt_pk_bf16_f32 v32, v16, v17
    v_cvt_pk_bf16_f32 v33, v18, v19
    v_cvt_pk_bf16_f32 v34, v20, v21
    v_cvt_pk_bf16_f32 v35, v22, v23
    v_cvt_pk_bf16_f32 v36, v24, v25
    v_cvt_pk_bf16_f32 v37, v26, v27
    v_cvt_pk_bf16_f32 v38, v28, v29
    v_cvt_pk_bf16_f32 v39, v30, v31
    s_add_u32 s61, s59, 458752
    s_nop 0
    v_permlane32_swap_b32 v32, v34
    v_permlane32_swap_b32 v33, v35
    v_permlane32_swap_b32 v36, v38
    v_permlane32_swap_b32 v37, v39
    buffer_store_dwordx4 v[32:35], v7, s[36:39], s61 offen offset:0 sc1
    buffer_store_dwordx4 v[36:39], v7, s[36:39], s61 offen offset:512 sc1
    s_nop 1
    v_accvgpr_read_b32 v16, a224
    v_accvgpr_read_b32 v17, a225
    v_accvgpr_read_b32 v18, a226
    v_accvgpr_read_b32 v19, a227
    v_accvgpr_read_b32 v20, a228
    v_accvgpr_read_b32 v21, a229
    v_accvgpr_read_b32 v22, a230
    v_accvgpr_read_b32 v23, a231
    v_accvgpr_read_b32 v24, a232
    v_accvgpr_read_b32 v25, a233
    v_accvgpr_read_b32 v26, a234
    v_accvgpr_read_b32 v27, a235
    v_accvgpr_read_b32 v28, a236
    v_accvgpr_read_b32 v29, a237
    v_accvgpr_read_b32 v30, a238
    v_accvgpr_read_b32 v31, a239
    v_cvt_pk_bf16_f32 v32, v16, v17
    v_cvt_pk_bf16_f32 v33, v18, v19
    v_cvt_pk_bf16_f32 v34, v20, v21
    v_cvt_pk_bf16_f32 v35, v22, v23
    v_cvt_pk_bf16_f32 v36, v24, v25
    v_cvt_pk_bf16_f32 v37, v26, v27
    v_cvt_pk_bf16_f32 v38, v28, v29
    v_cvt_pk_bf16_f32 v39, v30, v31
    s_add_u32 s61, s59, 917504
    s_nop 0
    v_permlane32_swap_b32 v32, v34
    v_permlane32_swap_b32 v33, v35
    v_permlane32_swap_b32 v36, v38
    v_permlane32_swap_b32 v37, v39
    buffer_store_dwordx4 v[32:35], v7, s[36:39], s61 offen offset:0 sc1
    buffer_store_dwordx4 v[36:39], v7, s[36:39], s61 offen offset:512 sc1
    s_nop 1
    v_accvgpr_read_b32 v16, a240
    v_accvgpr_read_b32 v17, a241
    v_accvgpr_read_b32 v18, a242
    v_accvgpr_read_b32 v19, a243
    v_accvgpr_read_b32 v20, a244
    v_accvgpr_read_b32 v21, a245
    v_accvgpr_read_b32 v22, a246
    v_accvgpr_read_b32 v23, a247
    v_accvgpr_read_b32 v24, a248
    v_accvgpr_read_b32 v25, a249
    v_accvgpr_read_b32 v26, a250
    v_accvgpr_read_b32 v27, a251
    v_accvgpr_read_b32 v28, a252
    v_accvgpr_read_b32 v29, a253
    v_accvgpr_read_b32 v30, a254
    v_accvgpr_read_b32 v31, a255
    v_cvt_pk_bf16_f32 v32, v16, v17
    v_cvt_pk_bf16_f32 v33, v18, v19
    v_cvt_pk_bf16_f32 v34, v20, v21
    v_cvt_pk_bf16_f32 v35, v22, v23
    v_cvt_pk_bf16_f32 v36, v24, v25
    v_cvt_pk_bf16_f32 v37, v26, v27
    v_cvt_pk_bf16_f32 v38, v28, v29
    v_cvt_pk_bf16_f32 v39, v30, v31
    s_add_u32 s61, s59, 1376256
    s_nop 0
    v_permlane32_swap_b32 v32, v34
    v_permlane32_swap_b32 v33, v35
    v_permlane32_swap_b32 v36, v38
    v_permlane32_swap_b32 v37, v39
    buffer_store_dwordx4 v[32:35], v7, s[36:39], s61 offen offset:0 sc1
    buffer_store_dwordx4 v[36:39], v7, s[36:39], s61 offen offset:512 sc1
    s_nop 1
    s_waitcnt vmcnt(0)
    s_lshl_b32 s58, s54, 7
    s_add_u32 s58, s58, 24199168
    s_mov_b64 exec, 1
    v_mov_b32 v8, 0
    v_mov_b32 v9, 1
    buffer_atomic_add v9, v8, s[36:39], s58 offen
    s_mov_b64 exec, -1
    s_branch W_NEXT
W_TOK:
    s_cmp_eq_u32 s40, 0
    s_cbranch_scc0 W_TB
    s_mov_b64 exec, 1
    s_mov_b32 s50, 24198272
    v_mov_b32 v8, 0
    v_mov_b32 v9, 1
    buffer_atomic_add v9, v8, s[36:39], s50 offen sc0
    s_waitcnt vmcnt(0)
    v_mov_b32 v8, 140016
    ds_write_b32 v8, v9
    s_waitcnt lgkmcnt(0)
    s_mov_b64 exec, -1
W_TB:
    s_barrier
    v_mov_b32 v8, 140016
    ds_read_b32 v9, v8
    s_waitcnt lgkmcnt(0)
    v_readfirstlane_b32 s66, v9
    s_lshl_b32 s66, s66, 2
    s_add_u32 s66, s66, s40
    s_cmp_lt_u32 s66, 128
    s_cbranch_scc1 TKP_S
    s_cmp_lt_u32 s66, 184
    s_cbranch_scc1 TKP_V
    s_cmp_lt_u32 s66, 520
    s_cbranch_scc1 TKP_F1
    s_cmp_lt_u32 s66, 856
    s_cbranch_scc1 TKP_F2
    s_endpgm
TKP_S:
    s_lshr_b32 s67, s66, 4
    s_and_b32 s68, s66, 15
    s_mov_b32 s69, 8
TKL_S:
    v_and_b32 v2, 15, v1
    v_lshrrev_b32 v3, 4, v1
    v_lshlrev_b32 v4, 4, v1
    v_and_b32 v5, 7, v2
    v_lshl_add_u32 v5, v3, 4, v5
    v_lshlrev_b32 v5, 4, v5
    s_mul_i32 s50, s67, 7168
    s_add_u32 s50, s50, 25690112
    s_mul_i32 s51, s67, 2*14*1024
    s_add_u32 s51, s51, 2097152
    s_lshl_b32 s52, s67, 5
    s_add_u32 s52, s52, s68
    s_mul_i32 s52, s52, 14*1024
    s_add_u32 s52, s52, 50331648
    s_add_u32 s53, s52, 229376
    v_mov_b32 v8, 0
    s_lshr_b32 s46, s67, 2
    s_lshl_b32 s46, s46, 7
    s_add_u32 s46, s46, 24199168
TK_S_W2:
    s_sub_u32 s99, s99, 1
    s_cbranch_scc1 K2_ABORT
    buffer_load_dword v9, v8, s[36:39], s46 offen sc1
    s_waitcnt vmcnt(0)
    v_readfirstlane_b32 s47, v9
    s_cmp_ge_u32 s47, 56
    s_cbranch_scc1 TK_S_W2_OK
    s_sleep 8
    s_branch TK_S_W2
TK_S_W2_OK:
    s_add_u32 s60, s51, 0
    buffer_load_dwordx4 a[112:115], v4, s[36:39], s60 offen offset:0
    buffer_load_dwordx4 a[116:119], v4, s[36:39], s60 offen offset:1024
    buffer_load_dwordx4 a[120:123], v4, s[36:39], s60 offen offset:2048
    buffer_load_dwordx4 a[124:127], v4, s[36:39], s60 offen offset:3072
    s_add_u32 s60, s51, 4096
    buffer_load_dwordx4 a[128:131], v4, s[36:39], s60 offen offset:0
    buffer_load_dwordx4 a[132:135], v4, s[36:39], s60 offen offset:1024
    buffer_load_dwordx4 a[136:139], v4, s[36:39], s60 offen offset:2048
    buffer_load_dwordx4 a[140:143], v4, s[36:39], s60 offen offset:3072
    s_add_u32 s60, s51, 8192
    buffer_load_dwordx4 a[144:147], v4, s[36:39], s60 offen offset:0
    buffer_load_dwordx4 a[148:151], v4, s[36:39], s60 offen offset:1024
    buffer_load_dwordx4 a[152:155], v4, s[36:39], s60 offen offset:2048
    buffer_load_dwordx4 a[156:159], v4, s[36:39], s60 offen offset:3072
    s_add_u32 s60, s51, 12288
    buffer_load_dwordx4 a[160:163], v4, s[36:39], s60 offen offset:0
    buffer_load_dwordx4 a[164:167], v4, s[36:39], s60 offen offset:1024
    buffer_load_dwordx4 a[168:171], v4, s[36:39], s60 offen offset:2048
    buffer_load_dwordx4 a[172:175], v4, s[36:39], s60 offen offset:3072
    s_add_u32 s60, s51, 16384
    buffer_load_dwordx4 a[176:179], v4, s[36:39], s60 offen offset:0
    buffer_load_dwordx4 a[180:183], v4, s[36:39], s60 offen offset:1024
    buffer_load_dwordx4 a[184:187], v4, s[36:39], s60 offen offset:2048
    buffer_load_dwordx4 a[188:191], v4, s[36:39], s60 offen offset:3072
    s_add_u32 s60, s51, 20480
    buffer_load_dwordx4 a[192:195], v4, s[36:39], s60 offen offset:0
    buffer_load_dwordx4 a[196:199], v4, s[36:39], s60 offen offset:1024
    buffer_load_dwordx4 a[200:203], v4, s[36:39], s60 offen offset:2048
    buffer_load_dwordx4 a[204:207], v4, s[36:39], s60 offen offset:3072
    s_add_u32 s60, s51, 24576
    buffer_load_dwordx4 a[208:211], v4, s[36:39], s60 offen offset:0
    buffer_load_dwordx4 a[212:215], v4, s[36:39], s60 offen offset:1024
    buffer_load_dwordx4 a[216:219], v4, s[36:39], s60 offen offset:2048
    buffer_load_dwordx4 a[220:223], v4, s[36:39], s60 offen offset:3072
    s_add_u32 s60, s52, 0
    buffer_load_dwordx4 a[0:3], v4, s[36:39], s60 offen offset:0 sc1
    buffer_load_dwordx4 a[4:7], v4, s[36:39], s60 offen offset:1024 sc1
    buffer_load_dwordx4 a[8:11], v4, s[36:39], s60 offen offset:2048 sc1
    buffer_load_dwordx4 a[12:15], v4, s[36:39], s60 offen offset:3072 sc1
    s_add_u32 s60, s52, 4096
    buffer_load_dwordx4 a[16:19], v4, s[36:39], s60 offen offset:0 sc1
    buffer_load_dwordx4 a[20:23], v4, s[36:39], s60 offen offset:1024 sc1
    buffer_load_dwordx4 a[24:27], v4, s[36:39], s60 offen offset:2048 sc1
    buffer_load_dwordx4 a[28:31], v4, s[36:39], s60 offen offset:3072 sc1
    s_add_u32 s60, s52, 8192
    buffer_load_dwordx4 a[32:35], v4, s[36:39], s60 offen offset:0 sc1
    buffer_load_dwordx4 a[36:39], v4, s[36:39], s60 offen offset:1024 sc1
    buffer_load_dwordx4 a[40:43], v4, s[36:39], s60 offen offset:2048 sc1
    buffer_load_dwordx4 a[44:47], v4, s[36:39], s60 offen offset:3072 sc1
    s_add_u32 s60, s52, 12288
    buffer_load_dwordx4 a[48:51], v4, s[36:39], s60 offen offset:0 sc1
    buffer_load_dwordx4 a[52:55], v4, s[36:39], s60 offen offset:1024 sc1
    s_add_u32 s60, s53, 0
    buffer_load_dwordx4 a[56:59], v4, s[36:39], s60 offen offset:0 sc1
    buffer_load_dwordx4 a[60:63], v4, s[36:39], s60 offen offset:1024 sc1
    buffer_load_dwordx4 a[64:67], v4, s[36:39], s60 offen offset:2048 sc1
    buffer_load_dwordx4 a[68:71], v4, s[36:39], s60 offen offset:3072 sc1
    s_add_u32 s60, s53, 4096
    buffer_load_dwordx4 a[72:75], v4, s[36:39], s60 offen offset:0 sc1
    buffer_load_dwordx4 a[76:79], v4, s[36:39], s60 offen offset:1024 sc1
    buffer_load_dwordx4 a[80:83], v4, s[36:39], s60 offen offset:2048 sc1
    buffer_load_dwordx4 a[84:87], v4, s[36:39], s60 offen offset:3072 sc1
    s_add_u32 s60, s53, 8192
    buffer_load_dwordx4 a[88:91], v4, s[36:39], s60 offen offset:0 sc1
    buffer_load_dwordx4 a[92:95], v4, s[36:39], s60 offen offset:1024 sc1
    buffer_load_dwordx4 a[96:99], v4, s[36:39], s60 offen offset:2048 sc1
    buffer_load_dwordx4 a[100:103], v4, s[36:39], s60 offen offset:3072 sc1
    s_add_u32 s60, s53, 12288
    buffer_load_dwordx4 a[104:107], v4, s[36:39], s60 offen offset:0 sc1
    buffer_load_dwordx4 a[108:111], v4, s[36:39], s60 offen offset:1024 sc1
    s_waitcnt vmcnt(0)
    v_mfma_f32_16x16x32_bf16 v[16:19], a[112:115], a[0:3], 0
    v_mfma_f32_16x16x32_bf16 v[20:23], a[112:115], a[56:59], 0
    v_mfma_f32_16x16x32_bf16 v[28:31], a[168:171], a[56:59], 0
    v_mfma_f32_16x16x32_bf16 v[16:19], a[116:119], a[4:7], v[16:19]
    v_mfma_f32_16x16x32_bf16 v[20:23], a[116:119], a[60:63], v[20:23]
    v_mfma_f32_16x16x32_bf16 v[28:31], a[172:175], a[60:63], v[28:31]
    v_mfma_f32_16x16x32_bf16 v[16:19], a[120:123], a[8:11], v[16:19]
    v_mfma_f32_16x16x32_bf16 v[20:23], a[120:123], a[64:67], v[20:23]
    v_mfma_f32_16x16x32_bf16 v[28:31], a[176:179], a[64:67], v[28:31]
    v_mfma_f32_16x16x32_bf16 v[16:19], a[124:127], a[12:15], v[16:19]
    v_mfma_f32_16x16x32_bf16 v[20:23], a[124:127], a[68:71], v[20:23]
    v_mfma_f32_16x16x32_bf16 v[28:31], a[180:183], a[68:71], v[28:31]
    v_mfma_f32_16x16x32_bf16 v[16:19], a[128:131], a[16:19], v[16:19]
    v_mfma_f32_16x16x32_bf16 v[20:23], a[128:131], a[72:75], v[20:23]
    v_mfma_f32_16x16x32_bf16 v[28:31], a[184:187], a[72:75], v[28:31]
    v_mfma_f32_16x16x32_bf16 v[16:19], a[132:135], a[20:23], v[16:19]
    v_mfma_f32_16x16x32_bf16 v[20:23], a[132:135], a[76:79], v[20:23]
    v_mfma_f32_16x16x32_bf16 v[28:31], a[188:191], a[76:79], v[28:31]
    v_mfma_f32_16x16x32_bf16 v[16:19], a[136:139], a[24:27], v[16:19]
    v_mfma_f32_16x16x32_bf16 v[20:23], a[136:139], a[80:83], v[20:23]
    v_mfma_f32_16x16x32_bf16 v[28:31], a[192:195], a[80:83], v[28:31]
    v_mfma_f32_16x16x32_bf16 v[16:19], a[140:143], a[28:31], v[16:19]
    v_mfma_f32_16x16x32_bf16 v[20:23], a[140:143], a[84:87], v[20:23]
    v_mfma_f32_16x16x32_bf16 v[28:31], a[196:199], a[84:87], v[28:31]
    v_mfma_f32_16x16x32_bf16 v[16:19], a[144:147], a[32:35], v[16:19]
    v_mfma_f32_16x16x32_bf16 v[20:23], a[144:147], a[88:91], v[20:23]
    v_mfma_f32_16x16x32_bf16 v[28:31], a[200:203], a[88:91], v[28:31]
    v_mfma_f32_16x16x32_bf16 v[16:19], a[148:151], a[36:39], v[16:19]
    v_mfma_f32_16x16x32_bf16 v[20:23], a[148:151], a[92:95], v[20:23]
    v_mfma_f32_16x16x32_bf16 v[28:31], a[204:207], a[92:95], v[28:31]
    v_mfma_f32_16x16x32_bf16 v[16:19], a[152:155], a[40:43], v[16:19]
    v_mfma_f32_16x16x32_bf16 v[20:23], a[152:155], a[96:99], v[20:23]
    v_mfma_f32_16x16x32_bf16 v[28:31], a[208:211], a[96:99], v[28:31]
    v_mfma_f32_16x16x32_bf16 v[16:19], a[156:159], a[44:47], v[16:19]
    v_mfma_f32_16x16x32_bf16 v[20:23], a[156:159], a[100:103], v[20:23]
    v_mfma_f32_16x16x32_bf16 v[28:31], a[212:215], a[100:103], v[28:31]
    v_mfma_f32_16x16x32_bf16 v[16:19], a[160:163], a[48:51], v[16:19]
    v_mfma_f32_16x16x32_bf16 v[20:23], a[160:163], a[104:107], v[20:23]
    v_mfma_f32_16x16x32_bf16 v[28:31], a[216:219], a[104:107], v[28:31]
    v_mfma_f32_16x16x32_bf16 v[16:19], a[164:167], a[52:55], v[16:19]
    v_mfma_f32_16x16x32_bf16 v[20:23], a[164:167], a[108:111], v[20:23]
    v_mfma_f32_16x16x32_bf16 v[28:31], a[220:223], a[108:111], v[28:31]
    v_mov_b32 v200, 0
    s_lshl_b32 s46, s67, 7
    s_add_u32 s46, s46, 24233984
    v_mov_b32 v40, v8
    v_mov_b32 v41, v9
    v_mov_b32 v8, 0
TK_S_W1:
    s_sub_u32 s99, s99, 1
    s_cbranch_scc1 K2_ABORT
    buffer_load_dword v9, v8, s[36:39], s46 offen sc1
    s_waitcnt vmcnt(0)
    v_readfirstlane_b32 s47, v9
    s_cmp_ge_u32 s47, 1
    s_cbranch_scc1 TK_S_W1_OK
    s_sleep 8
    s_branch TK_S_W1
TK_S_W1_OK:
    s_add_u32 s60, s50, 0
    buffer_load_dwordx4 v[48:51], v5, s[36:39], s60 offen sc1
    s_add_u32 s60, s50, 128
    buffer_load_dwordx4 v[52:55], v5, s[36:39], s60 offen sc1
    s_add_u32 s60, s50, 1024
    buffer_load_dwordx4 v[56:59], v5, s[36:39], s60 offen sc1
    s_add_u32 s60, s50, 1152
    buffer_load_dwordx4 v[60:63], v5, s[36:39], s60 offen sc1
    s_add_u32 s60, s50, 2048
    buffer_load_dwordx4 v[64:67], v5, s[36:39], s60 offen sc1
    s_add_u32 s60, s50, 2176
    buffer_load_dwordx4 v[68:71], v5, s[36:39], s60 offen sc1
    s_add_u32 s60, s50, 3072
    buffer_load_dwordx4 v[72:75], v5, s[36:39], s60 offen sc1
    s_add_u32 s60, s50, 3200
    buffer_load_dwordx4 v[76:79], v5, s[36:39], s60 offen sc1
    s_add_u32 s60, s50, 4096
    buffer_load_dwordx4 v[80:83], v5, s[36:39], s60 offen sc1
    s_add_u32 s60, s50, 4224
    buffer_load_dwordx4 v[84:87], v5, s[36:39], s60 offen sc1
    s_add_u32 s60, s50, 5120
    buffer_load_dwordx4 v[88:91], v5, s[36:39], s60 offen sc1
    s_add_u32 s60, s50, 5248
    buffer_load_dwordx4 v[92:95], v5, s[36:39], s60 offen sc1
    s_add_u32 s60, s50, 6144
    buffer_load_dwordx4 v[96:99], v5, s[36:39], s60 offen sc1
    s_add_u32 s60, s50, 6272
    buffer_load_dwordx4 v[100:103], v5, s[36:39], s60 offen sc1
    s_waitcnt vmcnt(13)
    v_mfma_f32_16x16x32_bf16 v[8:11], v[48:51], a[0:3], 0
    v_mfma_f32_16x16x32_bf16 v[12:15], v[48:51], a[56:59], 0
    s_waitcnt vmcnt(12)
    v_mfma_f32_16x16x32_bf16 v[8:11], v[52:55], a[4:7], v[8:11]
    v_mfma_f32_16x16x32_bf16 v[12:15], v[52:55], a[60:63], v[12:15]
    s_waitcnt vmcnt(11)
    v_mfma_f32_16x16x32_bf16 v[8:11], v[56:59], a[8:11], v[8:11]
    v_mfma_f32_16x16x32_bf16 v[12:15], v[56:59], a[64:67], v[12:15]
    s_waitcnt vmcnt(10)
    v_mfma_f32_16x16x32_bf16 v[8:11], v[60:63], a[12:15], v[8:11]
    v_mfma_f32_16x16x32_bf16 v[12:15], v[60:63], a[68:71], v[12:15]
    s_waitcnt vmcnt(9)
    v_mfma_f32_16x16x32_bf16 v[8:11], v[64:67], a[16:19], v[8:11]
    v_mfma_f32_16x16x32_bf16 v[12:15], v[64:67], a[72:75], v[12:15]
    s_waitcnt vmcnt(8)
    v_mfma_f32_16x16x32_bf16 v[8:11], v[68:71], a[20:23], v[8:11]
    v_mfma_f32_16x16x32_bf16 v[12:15], v[68:71], a[76:79], v[12:15]
    s_waitcnt vmcnt(7)
    v_mfma_f32_16x16x32_bf16 v[8:11], v[72:75], a[24:27], v[8:11]
    v_mfma_f32_16x16x32_bf16 v[12:15], v[72:75], a[80:83], v[12:15]
    s_waitcnt vmcnt(6)
    v_mfma_f32_16x16x32_bf16 v[8:11], v[76:79], a[28:31], v[8:11]
    v_mfma_f32_16x16x32_bf16 v[12:15], v[76:79], a[84:87], v[12:15]
    s_waitcnt vmcnt(5)
    v_mfma_f32_16x16x32_bf16 v[8:11], v[80:83], a[32:35], v[8:11]
    v_mfma_f32_16x16x32_bf16 v[12:15], v[80:83], a[88:91], v[12:15]
    s_waitcnt vmcnt(4)
    v_mfma_f32_16x16x32_bf16 v[8:11], v[84:87], a[36:39], v[8:11]
    v_mfma_f32_16x16x32_bf16 v[12:15], v[84:87], a[92:95], v[12:15]
    s_waitcnt vmcnt(3)
    v_mfma_f32_16x16x32_bf16 v[8:11], v[88:91], a[40:43], v[8:11]
    v_mfma_f32_16x16x32_bf16 v[12:15], v[88:91], a[96:99], v[12:15]
    s_waitcnt vmcnt(2)
    v_mfma_f32_16x16x32_bf16 v[8:11], v[92:95], a[44:47], v[8:11]
    v_mfma_f32_16x16x32_bf16 v[12:15], v[92:95], a[100:103], v[12:15]
    s_waitcnt vmcnt(1)
    v_mfma_f32_16x16x32_bf16 v[8:11], v[96:99], a[48:51], v[8:11]
    v_mfma_f32_16x16x32_bf16 v[12:15], v[96:99], a[104:107], v[12:15]
    s_waitcnt vmcnt(0)
    v_mfma_f32_16x16x32_bf16 v[8:11], v[100:103], a[52:55], v[8:11]
    v_mfma_f32_16x16x32_bf16 v[12:15], v[100:103], a[108:111], v[12:15]
    v_mov_b32 v6, 0xff7fffff
    s_mov_b32 s53, 0x3fb8aa3b
    v_lshrrev_b32 v7, 1, v3
    v_lshl_add_u32 v7, v7, 4, v2
    v_lshlrev_b32 v7, 4, v7
    v_and_b32 v200, 1, v3
    v_lshl_add_u32 v7, v200, 3, v7
    s_and_b32 s54, s68, 3
    s_lshl_b32 s54, s54, 8
    v_lshlrev_b32 v201, 4, v2
    v_lshl_add_u32 v201, v3, 3, v201
    v_add_u32 v201, s54, v201
    s_lshl_b32 s55, s67, 4
    s_add_u32 s55, s55, s68
    s_lshl_b32 s55, s55, 11
    s_add_u32 s55, s55, 35651584
    s_lshl_b32 s56, s67, 2
    s_lshr_b32 s57, s68, 2
    s_add_u32 s56, s56, s57
    s_lshl_b32 s56, s56, 11
    s_add_u32 s56, s56, 37748736
    v_cmp_gt_u32 s[58:59], 2, v3
    v_lshlrev_b32 v33, 2, v3
    v_cndmask_b32 v8, v6, v8, s[58:59]
    v_cndmask_b32 v9, v6, v9, s[58:59]
    v_cndmask_b32 v10, v6, v10, s[58:59]
    v_cndmask_b32 v11, v6, v11, s[58:59]
    v_add_u32 v34, 0, v33
    v_cmp_le_u32 vcc, v34, v2
    s_nop 1
    v_cndmask_b32 v16, v6, v16, vcc
    v_add_u32 v34, 1, v33
    v_cmp_le_u32 vcc, v34, v2
    s_nop 1
    v_cndmask_b32 v17, v6, v17, vcc
    v_add_u32 v34, 2, v33
    v_cmp_le_u32 vcc, v34, v2
    s_nop 1
    v_cndmask_b32 v18, v6, v18, vcc
    v_add_u32 v34, 3, v33
    v_cmp_le_u32 vcc, v34, v2
    s_nop 1
    v_cndmask_b32 v19, v6, v19, vcc
    v_max3_f32 v35, v8, v9, v10
    v_max3_f32 v35, v35, v11, v16
    v_max3_f32 v35, v35, v17, v18
    v_max_f32 v35, v35, v19
    v_mov_b32 v36, v35
    s_nop 1
    v_permlane16_swap_b32 v35, v36
    s_nop 1
    v_max_f32 v35, v35, v36
    v_mov_b32 v36, v35
    s_nop 1
    v_permlane32_swap_b32 v35, v36
    s_nop 1
    v_max_f32 v35, v35, v36
    v_mul_f32 v35, s53, v35
    v_fma_f32 v8, v8, s53, -v35
    v_fma_f32 v9, v9, s53, -v35
    v_fma_f32 v10, v10, s53, -v35
    v_fma_f32 v11, v11, s53, -v35
    v_fma_f32 v16, v16, s53, -v35
    v_fma_f32 v17, v17, s53, -v35
    v_fma_f32 v18, v18, s53, -v35
    v_fma_f32 v19, v19, s53, -v35
    v_exp_f32 v8, v8
    v_exp_f32 v9, v9
    v_exp_f32 v10, v10
    v_exp_f32 v11, v11
    v_exp_f32 v16, v16
    v_exp_f32 v17, v17
    v_exp_f32 v18, v18
    v_exp_f32 v19, v19
    s_nop 0
    v_add_f32 v36, v8, v9
    v_add_f32 v36, v36, v10
    v_add_f32 v36, v36, v11
    v_add_f32 v36, v36, v16
    v_add_f32 v36, v36, v17
    v_add_f32 v36, v36, v18
    v_add_f32 v36, v36, v19
    v_mov_b32 v37, v36
    s_nop 1
    v_permlane16_swap_b32 v36, v37
    s_nop 1
    v_add_f32 v36, v36, v37
    v_mov_b32 v37, v36
    s_nop 1
    v_permlane32_swap_b32 v36, v37
    s_nop 1
    v_add_f32 v36, v36, v37
    v_rcp_f32 v36, v36
    s_nop 0
    v_mul_f32 v8, v8, v36
    v_mul_f32 v9, v9, v36
    v_mul_f32 v10, v10, v36
    v_mul_f32 v11, v11, v36
    v_mul_f32 v16, v16, v36
    v_mul_f32 v17, v17, v36
    v_mul_f32 v18, v18, v36
    v_mul_f32 v19, v19, v36
    v_cvt_pk_bf16_f32 v38, v8, v9
    v_cvt_pk_bf16_f32 v39, v10, v11
    v_cvt_pk_bf16_f32 v40, v16, v17
    v_cvt_pk_bf16_f32 v41, v18, v19
    v_mov_b32 v42, 0
    v_mov_b32 v43, 0
    buffer_store_dwordx2 v[40:41], v7, s[36:39], s55 offen offset:0 sc1
    buffer_store_dwordx2 v[42:43], v7, s[36:39], s55 offen offset:512 sc1
    s_mov_b64 exec, s[58:59]
    buffer_store_dwordx2 v[38:39], v201, s[36:39], s56 offen offset:0 sc1
    s_mov_b64 exec, -1
    s_nop 1
    v_cndmask_b32 v12, v6, v12, s[58:59]
    v_cndmask_b32 v13, v6, v13, s[58:59]
    v_cndmask_b32 v14, v6, v14, s[58:59]
    v_cndmask_b32 v15, v6, v15, s[58:59]
    v_add_u32 v34, 0, v33
    v_cmp_le_u32 vcc, v34, v2
    s_nop 1
    v_cndmask_b32 v28, v6, v28, vcc
    v_add_u32 v34, 1, v33
    v_cmp_le_u32 vcc, v34, v2
    s_nop 1
    v_cndmask_b32 v29, v6, v29, vcc
    v_add_u32 v34, 2, v33
    v_cmp_le_u32 vcc, v34, v2
    s_nop 1
    v_cndmask_b32 v30, v6, v30, vcc
    v_add_u32 v34, 3, v33
    v_cmp_le_u32 vcc, v34, v2
    s_nop 1
    v_cndmask_b32 v31, v6, v31, vcc
    v_max3_f32 v35, v12, v13, v14
    v_max3_f32 v35, v35, v15, v20
    v_max3_f32 v35, v35, v21, v22
    v_max3_f32 v35, v35, v23, v28
    v_max3_f32 v35, v35, v29, v30
    v_max_f32 v35, v35, v31
    v_mov_b32 v36, v35
    s_nop 1
    v_permlane16_swap_b32 v35, v36
    s_nop 1
    v_max_f32 v35, v35, v36
    v_mov_b32 v36, v35
    s_nop 1
    v_permlane32_swap_b32 v35, v36
    s_nop 1
    v_max_f32 v35, v35, v36
    v_mul_f32 v35, s53, v35
    v_fma_f32 v12, v12, s53, -v35
    v_fma_f32 v13, v13, s53, -v35
    v_fma_f32 v14, v14, s53, -v35
    v_fma_f32 v15, v15, s53, -v35
    v_fma_f32 v20, v20, s53, -v35
    v_fma_f32 v21, v21, s53, -v35
    v_fma_f32 v22, v22, s53, -v35
    v_fma_f32 v23, v23, s53, -v35
    v_fma_f32 v28, v28, s53, -v35
    v_fma_f32 v29, v29, s53, -v35
    v_fma_f32 v30, v30, s53, -v35
    v_fma_f32 v31, v31, s53, -v35
    v_exp_f32 v12, v12
    v_exp_f32 v13, v13
    v_exp_f32 v14, v14
    v_exp_f32 v15, v15
    v_exp_f32 v20, v20
    v_exp_f32 v21, v21
    v_exp_f32 v22, v22
    v_exp_f32 v23, v23
    v_exp_f32 v28, v28
    v_exp_f32 v29, v29
    v_exp_f32 v30, v30
    v_exp_f32 v31, v31
    s_nop 0
    v_add_f32 v36, v12, v13
    v_add_f32 v36, v36, v14
    v_add_f32 v36, v36, v15
    v_add_f32 v36, v36, v20
    v_add_f32 v36, v36, v21
    v_add_f32 v36, v36, v22
    v_add_f32 v36, v36, v23
    v_add_f32 v36, v36, v28
    v_add_f32 v36, v36, v29
    v_add_f32 v36, v36, v30
    v_add_f32 v36, v36, v31
    v_mov_b32 v37, v36
    s_nop 1
    v_permlane16_swap_b32 v36, v37
    s_nop 1
    v_add_f32 v36, v36, v37
    v_mov_b32 v37, v36
    s_nop 1
    v_permlane32_swap_b32 v36, v37
    s_nop 1
    v_add_f32 v36, v36, v37
    v_rcp_f32 v36, v36
    s_nop 0
    v_mul_f32 v12, v12, v36
    v_mul_f32 v13, v13, v36
    v_mul_f32 v14, v14, v36
    v_mul_f32 v15, v15, v36
    v_mul_f32 v20, v20, v36
    v_mul_f32 v21, v21, v36
    v_mul_f32 v22, v22, v36
    v_mul_f32 v23, v23, v36
    v_mul_f32 v28, v28, v36
    v_mul_f32 v29, v29, v36
    v_mul_f32 v30, v30, v36
    v_mul_f32 v31, v31, v36
    v_cvt_pk_bf16_f32 v38, v12, v13
    v_cvt_pk_bf16_f32 v39, v14, v15
    v_cvt_pk_bf16_f32 v40, v20, v21
    v_cvt_pk_bf16_f32 v41, v22, v23
    v_cvt_pk_bf16_f32 v42, v28, v29
    v_cvt_pk_bf16_f32 v43, v30, v31
    buffer_store_dwordx2 v[40:41], v7, s[36:39], s55 offen offset:1024 sc1
    buffer_store_dwordx2 v[42:43], v7, s[36:39], s55 offen offset:1536 sc1
    s_mov_b64 exec, s[58:59]
    buffer_store_dwordx2 v[38:39], v201, s[36:39], s56 offen offset:1024 sc1
    s_mov_b64 exec, -1
    s_nop 1
    s_lshl_b32 s46, s67, 7
    s_add_u32 s46, s46, 24207360
    s_waitcnt vmcnt(0)
    s_mov_b64 exec, 1
    v_mov_b32 v8, 0
    v_mov_b32 v9, 1
    buffer_atomic_add v9, v8, s[36:39], s46 offen
    s_mov_b64 exec, -1
    s_add_u32 s67, s67, s69
    s_cmp_lt_u32 s67, 64
    s_cbranch_scc1 TKL_S
    s_endpgm
TKP_V:
    s_sub_u32 s66, s66, 128
    s_mul_i32 s67, s66, 9363
    s_lshr_b32 s67, s67, 16
    s_mul_i32 s68, s67, 7
    s_sub_u32 s68, s66, s68
    s_mov_b32 s69, 8
TKL_V:
    v_and_b32 v2, 15, v1
    v_lshrrev_b32 v3, 4, v1
    v_lshlrev_b32 v4, 4, v1
    s_lshl_b32 s50, s68, 2
    s_lshl_b32 s51, s67, 2
    s_mul_i32 s51, s51, 28
    s_add_u32 s51, s51, s50
    s_lshl_b32 s51, s51, 10
    s_add_u32 s51, s51, 27262976
    s_lshl_b32 s52, s67, 4
    s_mul_i32 s52, s52, 28
    s_add_u32 s52, s52, s50
    s_lshl_b32 s52, s52, 10
    s_add_u32 s52, s52, 83886080
    s_lshl_b32 s53, s67, 13
    s_add_u32 s53, s53, 37748736
    s_lshl_b32 s54, s67, 15
    s_add_u32 s54, s54, 35651584
    v_mov_b32 v8, 0
    s_lshr_b32 s46, s67, 2
    s_lshl_b32 s46, s46, 7
    s_add_u32 s46, s46, 24182784
TK_V_W2:
    s_sub_u32 s99, s99, 1
    s_cbranch_scc1 K2_ABORT
    buffer_load_dword v9, v8, s[36:39], s46 offen sc1
    s_waitcnt vmcnt(0)
    v_readfirstlane_b32 s47, v9
    s_cmp_ge_u32 s47, 224
    s_cbranch_scc1 TK_V_W2_OK
    s_sleep 8
    s_branch TK_V_W2
TK_V_W2_OK:
    s_add_u32 s60, s52, 0
    buffer_load_dwordx4 a[0:3], v4, s[36:39], s60 offen offset:0 sc1
    buffer_load_dwordx4 a[4:7], v4, s[36:39], s60 offen offset:1024 sc1
    buffer_load_dwordx4 a[8:11], v4, s[36:39], s60 offen offset:2048 sc1
    buffer_load_dwordx4 a[12:15], v4, s[36:39], s60 offen offset:3072 sc1
    s_add_u32 s60, s52, 28672
    buffer_load_dwordx4 a[16:19], v4, s[36:39], s60 offen offset:0 sc1
    buffer_load_dwordx4 a[20:23], v4, s[36:39], s60 offen offset:1024 sc1
    buffer_load_dwordx4 a[24:27], v4, s[36:39], s60 offen offset:2048 sc1
    buffer_load_dwordx4 a[28:31], v4, s[36:39], s60 offen offset:3072 sc1
    s_add_u32 s60, s52, 57344
    buffer_load_dwordx4 a[32:35], v4, s[36:39], s60 offen offset:0 sc1
    buffer_load_dwordx4 a[36:39], v4, s[36:39], s60 offen offset:1024 sc1
    buffer_load_dwordx4 a[40:43], v4, s[36:39], s60 offen offset:2048 sc1
    buffer_load_dwordx4 a[44:47], v4, s[36:39], s60 offen offset:3072 sc1
    s_add_u32 s60, s52, 86016
    buffer_load_dwordx4 a[48:51], v4, s[36:39], s60 offen offset:0 sc1
    buffer_load_dwordx4 a[52:55], v4, s[36:39], s60 offen offset:1024 sc1
    buffer_load_dwordx4 a[56:59], v4, s[36:39], s60 offen offset:2048 sc1
    buffer_load_dwordx4 a[60:63], v4, s[36:39], s60 offen offset:3072 sc1
    s_add_u32 s60, s52, 114688
    buffer_load_dwordx4 a[64:67], v4, s[36:39], s60 offen offset:0 sc1
    buffer_load_dwordx4 a[68:71], v4, s[36:39], s60 offen offset:1024 sc1
    buffer_load_dwordx4 a[72:75], v4, s[36:39], s60 offen offset:2048 sc1
    buffer_load_dwordx4 a[76:79], v4, s[36:39], s60 offen offset:3072 sc1
    s_add_u32 s60, s52, 143360
    buffer_load_dwordx4 a[80:83], v4, s[36:39], s60 offen offset:0 sc1
    buffer_load_dwordx4 a[84:87], v4, s[36:39], s60 offen offset:1024 sc1
    buffer_load_dwordx4 a[88:91], v4, s[36:39], s60 offen offset:2048 sc1
    buffer_load_dwordx4 a[92:95], v4, s[36:39], s60 offen offset:3072 sc1
    s_add_u32 s60, s52, 172032
    buffer_load_dwordx4 a[96:99], v4, s[36:39], s60 offen offset:0 sc1
    buffer_load_dwordx4 a[100:103], v4, s[36:39], s60 offen offset:1024 sc1
    buffer_load_dwordx4 a[104:107], v4, s[36:39], s60 offen offset:2048 sc1
    buffer_load_dwordx4 a[108:111], v4, s[36:39], s60 offen offset:3072 sc1
    s_add_u32 s60, s52, 200704
    buffer_load_dwordx4 a[112:115], v4, s[36:39], s60 offen offset:0 sc1
    buffer_load_dwordx4 a[116:119], v4, s[36:39], s60 offen offset:1024 sc1
    buffer_load_dwordx4 a[120:123], v4, s[36:39], s60 offen offset:2048 sc1
    buffer_load_dwordx4 a[124:127], v4, s[36:39], s60 offen offset:3072 sc1
    s_add_u32 s60, s52, 229376
    buffer_load_dwordx4 a[128:131], v4, s[36:39], s60 offen offset:0 sc1
    buffer_load_dwordx4 a[132:135], v4, s[36:39], s60 offen offset:1024 sc1
    buffer_load_dwordx4 a[136:139], v4, s[36:39], s60 offen offset:2048 sc1
    buffer_load_dwordx4 a[140:143], v4, s[36:39], s60 offen offset:3072 sc1
    s_add_u32 s60, s52, 258048
    buffer_load_dwordx4 a[144:147], v4, s[36:39], s60 offen offset:0 sc1
    buffer_load_dwordx4 a[148:151], v4, s[36:39], s60 offen offset:1024 sc1
    buffer_load_dwordx4 a[152:155], v4, s[36:39], s60 offen offset:2048 sc1
    buffer_load_dwordx4 a[156:159], v4, s[36:39], s60 offen offset:3072 sc1
    s_add_u32 s60, s52, 286720
    buffer_load_dwordx4 a[160:163], v4, s[36:39], s60 offen offset:0 sc1
    buffer_load_dwordx4 a[164:167], v4, s[36:39], s60 offen offset:1024 sc1
    buffer_load_dwordx4 a[168:171], v4, s[36:39], s60 offen offset:2048 sc1
    buffer_load_dwordx4 a[172:175], v4, s[36:39], s60 offen offset:3072 sc1
    s_add_u32 s60, s52, 315392
    buffer_load_dwordx4 a[176:179], v4, s[36:39], s60 offen offset:0 sc1
    buffer_load_dwordx4 a[180:183], v4, s[36:39], s60 offen offset:1024 sc1
    buffer_load_dwordx4 a[184:187], v4, s[36:39], s60 offen offset:2048 sc1
    buffer_load_dwordx4 a[188:191], v4, s[36:39], s60 offen offset:3072 sc1
    s_add_u32 s60, s52, 344064
    buffer_load_dwordx4 a[192:195], v4, s[36:39], s60 offen offset:0 sc1
    buffer_load_dwordx4 a[196:199], v4, s[36:39], s60 offen offset:1024 sc1
    buffer_load_dwordx4 a[200:203], v4, s[36:39], s60 offen offset:2048 sc1
    buffer_load_dwordx4 a[204:207], v4, s[36:39], s60 offen offset:3072 sc1
    s_add_u32 s60, s52, 372736
    buffer_load_dwordx4 a[208:211], v4, s[36:39], s60 offen offset:0 sc1
    buffer_load_dwordx4 a[212:215], v4, s[36:39], s60 offen offset:1024 sc1
    buffer_load_dwordx4 a[216:219], v4, s[36:39], s60 offen offset:2048 sc1
    buffer_load_dwordx4 a[220:223], v4, s[36:39], s60 offen offset:3072 sc1
    s_add_u32 s60, s52, 401408
    buffer_load_dwordx4 a[224:227], v4, s[36:39], s60 offen offset:0 sc1
    buffer_load_dwordx4 a[228:231], v4, s[36:39], s60 offen offset:1024 sc1
    buffer_load_dwordx4 a[232:235], v4, s[36:39], s60 offen offset:2048 sc1
    buffer_load_dwordx4 a[236:239], v4, s[36:39], s60 offen offset:3072 sc1
    s_add_u32 s60, s52, 430080
    buffer_load_dwordx4 a[240:243], v4, s[36:39], s60 offen offset:0 sc1
    buffer_load_dwordx4 a[244:247], v4, s[36:39], s60 offen offset:1024 sc1
    buffer_load_dwordx4 a[248:251], v4, s[36:39], s60 offen offset:2048 sc1
    buffer_load_dwordx4 a[252:255], v4, s[36:39], s60 offen offset:3072 sc1
    v_mul_u32_u24 v5, 896, v2
    v_lshl_add_u32 v5, v3, 3, v5
    s_mul_i32 s55, s67, 32*896
    s_lshl_b32 s56, s68, 7
    s_add_u32 s55, s55, s56
    s_mov_b32 s44, s8
    s_and_b32 s45, s9, 0xffff
    s_mov_b32 s46, 1835008
    s_mov_b32 s47, 0x00020000
    s_add_u32 s60, s55, 0
    buffer_load_dwordx2 v[240:241], v5, s[44:47], s60 offen offset:0
    s_add_u32 s60, s55, 0
    buffer_load_dwordx2 v[242:243], v5, s[44:47], s60 offen offset:32
    s_add_u32 s60, s55, 0
    buffer_load_dwordx2 v[244:245], v5, s[44:47], s60 offen offset:64
    s_add_u32 s60, s55, 0
    buffer_load_dwordx2 v[246:247], v5, s[44:47], s60 offen offset:96
    s_add_u32 s60, s55, 14336
    buffer_load_dwordx2 v[248:249], v5, s[44:47], s60 offen offset:0
    s_add_u32 s60, s55, 14336
    buffer_load_dwordx2 v[250:251], v5, s[44:47], s60 offen offset:32
    s_add_u32 s60, s55, 14336
    buffer_load_dwordx2 v[252:253], v5, s[44:47], s60 offen offset:64
    s_add_u32 s60, s55, 14336
    buffer_load_dwordx2 v[254:255], v5, s[44:47], s60 offen offset:96
    s_lshl_b32 s46, s67, 7
    s_add_u32 s46, s46, 24207360
TK_V_W1:
    s_sub_u32 s99, s99, 1
    s_cbranch_scc1 K2_ABORT
    buffer_load_dword v9, v8, s[36:39], s46 offen sc1
    s_waitcnt vmcnt(0)
    v_readfirstlane_b32 s47, v9
    s_cmp_ge_u32 s47, 16
    s_cbranch_scc1 TK_V_W1_OK
    s_sleep 8
    s_branch TK_V_W1
TK_V_W1_OK:
    s_add_u32 s60, s54, 0
    buffer_load_dwordx4 v[48:51], v4, s[36:39], s60 offen offset:0 sc1
    buffer_load_dwordx4 v[52:55], v4, s[36:39], s60 offen offset:1024 sc1
    buffer_load_dwordx4 v[56:59], v4, s[36:39], s60 offen offset:2048 sc1
    buffer_load_dwordx4 v[60:63], v4, s[36:39], s60 offen offset:3072 sc1
    s_add_u32 s60, s54, 4096
    buffer_load_dwordx4 v[64:67], v4, s[36:39], s60 offen offset:0 sc1
    buffer_load_dwordx4 v[68:71], v4, s[36:39], s60 offen offset:1024 sc1
    buffer_load_dwordx4 v[72:75], v4, s[36:39], s60 offen offset:2048 sc1
    buffer_load_dwordx4 v[76:79], v4, s[36:39], s60 offen offset:3072 sc1
    s_add_u32 s60, s54, 8192
    buffer_load_dwordx4 v[80:83], v4, s[36:39], s60 offen offset:0 sc1
    buffer_load_dwordx4 v[84:87], v4, s[36:39], s60 offen offset:1024 sc1
    buffer_load_dwordx4 v[88:91], v4, s[36:39], s60 offen offset:2048 sc1
    buffer_load_dwordx4 v[92:95], v4, s[36:39], s60 offen offset:3072 sc1
    s_add_u32 s60, s54, 12288
    buffer_load_dwordx4 v[96:99], v4, s[36:39], s60 offen offset:0 sc1
    buffer_load_dwordx4 v[100:103], v4, s[36:39], s60 offen offset:1024 sc1
    buffer_load_dwordx4 v[104:107], v4, s[36:39], s60 offen offset:2048 sc1
    buffer_load_dwordx4 v[108:111], v4, s[36:39], s60 offen offset:3072 sc1
    s_add_u32 s60, s54, 16384
    buffer_load_dwordx4 v[112:115], v4, s[36:39], s60 offen offset:0 sc1
    buffer_load_dwordx4 v[116:119], v4, s[36:39], s60 offen offset:1024 sc1
    buffer_load_dwordx4 v[120:123], v4, s[36:39], s60 offen offset:2048 sc1
    buffer_load_dwordx4 v[124:127], v4, s[36:39], s60 offen offset:3072 sc1
    s_add_u32 s60, s54, 20480
    buffer_load_dwordx4 v[128:131], v4, s[36:39], s60 offen offset:0 sc1
    buffer_load_dwordx4 v[132:135], v4, s[36:39], s60 offen offset:1024 sc1
    buffer_load_dwordx4 v[136:139], v4, s[36:39], s60 offen offset:2048 sc1
    buffer_load_dwordx4 v[140:143], v4, s[36:39], s60 offen offset:3072 sc1
    s_add_u32 s60, s54, 24576
    buffer_load_dwordx4 v[144:147], v4, s[36:39], s60 offen offset:0 sc1
    buffer_load_dwordx4 v[148:151], v4, s[36:39], s60 offen offset:1024 sc1
    buffer_load_dwordx4 v[152:155], v4, s[36:39], s60 offen offset:2048 sc1
    buffer_load_dwordx4 v[156:159], v4, s[36:39], s60 offen offset:3072 sc1
    s_add_u32 s60, s54, 28672
    buffer_load_dwordx4 v[160:163], v4, s[36:39], s60 offen offset:0 sc1
    buffer_load_dwordx4 v[164:167], v4, s[36:39], s60 offen offset:1024 sc1
    buffer_load_dwordx4 v[168:171], v4, s[36:39], s60 offen offset:2048 sc1
    buffer_load_dwordx4 v[172:175], v4, s[36:39], s60 offen offset:3072 sc1
    s_add_u32 s60, s53, 0
    buffer_load_dwordx4 v[176:179], v4, s[36:39], s60 offen offset:0 sc1
    buffer_load_dwordx4 v[180:183], v4, s[36:39], s60 offen offset:1024 sc1
    buffer_load_dwordx4 v[184:187], v4, s[36:39], s60 offen offset:2048 sc1
    buffer_load_dwordx4 v[188:191], v4, s[36:39], s60 offen offset:3072 sc1
    s_add_u32 s60, s53, 4096
    buffer_load_dwordx4 v[192:195], v4, s[36:39], s60 offen offset:0 sc1
    buffer_load_dwordx4 v[196:199], v4, s[36:39], s60 offen offset:1024 sc1
    buffer_load_dwordx4 v[200:203], v4, s[36:39], s60 offen offset:2048 sc1
    buffer_load_dwordx4 v[204:207], v4, s[36:39], s60 offen offset:3072 sc1
    s_waitcnt vmcnt(38)
    v_mfma_f32_16x16x32_bf16 v[16:19], a[0:3], v[48:51], 0
    v_mfma_f32_16x16x32_bf16 v[20:23], a[0:3], v[52:55], 0
    v_mfma_f32_16x16x32_bf16 v[24:27], a[4:7], v[48:51], 0
    v_mfma_f32_16x16x32_bf16 v[28:31], a[4:7], v[52:55], 0
    v_mfma_f32_16x16x32_bf16 v[32:35], a[8:11], v[48:51], 0
    v_mfma_f32_16x16x32_bf16 v[36:39], a[8:11], v[52:55], 0
    v_mfma_f32_16x16x32_bf16 v[40:43], a[12:15], v[48:51], 0
    v_mfma_f32_16x16x32_bf16 v[44:47], a[12:15], v[52:55], 0
    s_waitcnt vmcnt(36)
    v_mfma_f32_16x16x32_bf16 v[16:19], a[16:19], v[56:59], v[16:19]
    v_mfma_f32_16x16x32_bf16 v[20:23], a[16:19], v[60:63], v[20:23]
    v_mfma_f32_16x16x32_bf16 v[24:27], a[20:23], v[56:59], v[24:27]
    v_mfma_f32_16x16x32_bf16 v[28:31], a[20:23], v[60:63], v[28:31]
    v_mfma_f32_16x16x32_bf16 v[32:35], a[24:27], v[56:59], v[32:35]
    v_mfma_f32_16x16x32_bf16 v[36:39], a[24:27], v[60:63], v[36:39]
    v_mfma_f32_16x16x32_bf16 v[40:43], a[28:31], v[56:59], v[40:43]
    v_mfma_f32_16x16x32_bf16 v[44:47], a[28:31], v[60:63], v[44:47]
    s_waitcnt vmcnt(34)
    v_mfma_f32_16x16x32_bf16 v[16:19], a[32:35], v[64:67], v[16:19]
    v_mfma_f32_16x16x32_bf16 v[20:23], a[32:35], v[68:71], v[20:23]
    v_mfma_f32_16x16x32_bf16 v[24:27], a[36:39], v[64:67], v[24:27]
    v_mfma_f32_16x16x32_bf16 v[28:31], a[36:39], v[68:71], v[28:31]
    v_mfma_f32_16x16x32_bf16 v[32:35], a[40:43], v[64:67], v[32:35]
    v_mfma_f32_16x16x32_bf16 v[36:39], a[40:43], v[68:71], v[36:39]
    v_mfma_f32_16x16x32_bf16 v[40:43], a[44:47], v[64:67], v[40:43]
    v_mfma_f32_16x16x32_bf16 v[44:47], a[44:47], v[68:71], v[44:47]
    s_waitcnt vmcnt(32)
    v_mfma_f32_16x16x32_bf16 v[16:19], a[48:51], v[72:75], v[16:19]
    v_mfma_f32_16x16x32_bf16 v[20:23], a[48:51], v[76:79], v[20:23]
    v_mfma_f32_16x16x32_bf16 v[24:27], a[52:55], v[72:75], v[24:27]
    v_mfma_f32_16x16x32_bf16 v[28:31], a[52:55], v[76:79], v[28:31]
    v_mfma_f32_16x16x32_bf16 v[32:35], a[56:59], v[72:75], v[32:35]
    v_mfma_f32_16x16x32_bf16 v[36:39], a[56:59], v[76:79], v[36:39]
    v_mfma_f32_16x16x32_bf16 v[40:43], a[60:63], v[72:75], v[40:43]
    v_mfma_f32_16x16x32_bf16 v[44:47], a[60:63], v[76:79], v[44:47]
    s_waitcnt vmcnt(30)
    v_mfma_f32_16x16x32_bf16 v[16:19], a[64:67], v[80:83], v[16:19]
    v_mfma_f32_16x16x32_bf16 v[20:23], a[64:67], v[84:87], v[20:23]
    v_mfma_f32_16x16x32_bf16 v[24:27], a[68:71], v[80:83], v[24:27]
    v_mfma_f32_16x16x32_bf16 v[28:31], a[68:71], v[84:87], v[28:31]
    v_mfma_f32_16x16x32_bf16 v[32:35], a[72:75], v[80:83], v[32:35]
    v_mfma_f32_16x16x32_bf16 v[36:39], a[72:75], v[84:87], v[36:39]
    v_mfma_f32_16x16x32_bf16 v[40:43], a[76:79], v[80:83], v[40:43]
    v_mfma_f32_16x16x32_bf16 v[44:47], a[76:79], v[84:87], v[44:47]
    s_waitcnt vmcnt(28)
    v_mfma_f32_16x16x32_bf16 v[16:19], a[80:83], v[88:91], v[16:19]
    v_mfma_f32_16x16x32_bf16 v[20:23], a[80:83], v[92:95], v[20:23]
    v_mfma_f32_16x16x32_bf16 v[24:27], a[84:87], v[88:91], v[24:27]
    v_mfma_f32_16x16x32_bf16 v[28:31], a[84:87], v[92:95], v[28:31]
    v_mfma_f32_16x16x32_bf16 v[32:35], a[88:91], v[88:91], v[32:35]
    v_mfma_f32_16x16x32_bf16 v[36:39], a[88:91], v[92:95], v[36:39]
    v_mfma_f32_16x16x32_bf16 v[40:43], a[92:95], v[88:91], v[40:43]
    v_mfma_f32_16x16x32_bf16 v[44:47], a[92:95], v[92:95], v[44:47]
    s_waitcnt vmcnt(26)
    v_mfma_f32_16x16x32_bf16 v[16:19], a[96:99], v[96:99], v[16:19]
    v_mfma_f32_16x16x32_bf16 v[20:23], a[96:99], v[100:103], v[20:23]
    v_mfma_f32_16x16x32_bf16 v[24:27], a[100:103], v[96:99], v[24:27]
    v_mfma_f32_16x16x32_bf16 v[28:31], a[100:103], v[100:103], v[28:31]
    v_mfma_f32_16x16x32_bf16 v[32:35], a[104:107], v[96:99], v[32:35]
    v_mfma_f32_16x16x32_bf16 v[36:39], a[104:107], v[100:103], v[36:39]
    v_mfma_f32_16x16x32_bf16 v[40:43], a[108:111], v[96:99], v[40:43]
    v_mfma_f32_16x16x32_bf16 v[44:47], a[108:111], v[100:103], v[44:47]
    s_waitcnt vmcnt(24)
    v_mfma_f32_16x16x32_bf16 v[16:19], a[112:115], v[104:107], v[16:19]
    v_mfma_f32_16x16x32_bf16 v[20:23], a[112:115], v[108:111], v[20:23]
    v_mfma_f32_16x16x32_bf16 v[24:27], a[116:119], v[104:107], v[24:27]
    v_mfma_f32_16x16x32_bf16 v[28:31], a[116:119], v[108:111], v[28:31]
    v_mfma_f32_16x16x32_bf16 v[32:35], a[120:123], v[104:107], v[32:35]
    v_mfma_f32_16x16x32_bf16 v[36:39], a[120:123], v[108:111], v[36:39]
    v_mfma_f32_16x16x32_bf16 v[40:43], a[124:127], v[104:107], v[40:43]
    v_mfma_f32_16x16x32_bf16 v[44:47], a[124:127], v[108:111], v[44:47]
    s_waitcnt vmcnt(22)
    v_mfma_f32_16x16x32_bf16 v[16:19], a[128:131], v[112:115], v[16:19]
    v_mfma_f32_16x16x32_bf16 v[20:23], a[128:131], v[116:119], v[20:23]
    v_mfma_f32_16x16x32_bf16 v[24:27], a[132:135], v[112:115], v[24:27]
    v_mfma_f32_16x16x32_bf16 v[28:31], a[132:135], v[116:119], v[28:31]
    v_mfma_f32_16x16x32_bf16 v[32:35], a[136:139], v[112:115], v[32:35]
    v_mfma_f32_16x16x32_bf16 v[36:39], a[136:139], v[116:119], v[36:39]
    v_mfma_f32_16x16x32_bf16 v[40:43], a[140:143], v[112:115], v[40:43]
    v_mfma_f32_16x16x32_bf16 v[44:47], a[140:143], v[116:119], v[44:47]
    s_waitcnt vmcnt(20)
    v_mfma_f32_16x16x32_bf16 v[16:19], a[144:147], v[120:123], v[16:19]
    v_mfma_f32_16x16x32_bf16 v[20:23], a[144:147], v[124:127], v[20:23]
    v_mfma_f32_16x16x32_bf16 v[24:27], a[148:151], v[120:123], v[24:27]
    v_mfma_f32_16x16x32_bf16 v[28:31], a[148:151], v[124:127], v[28:31]
    v_mfma_f32_16x16x32_bf16 v[32:35], a[152:155], v[120:123], v[32:35]
    v_mfma_f32_16x16x32_bf16 v[36:39], a[152:155], v[124:127], v[36:39]
    v_mfma_f32_16x16x32_bf16 v[40:43], a[156:159], v[120:123], v[40:43]
    v_mfma_f32_16x16x32_bf16 v[44:47], a[156:159], v[124:127], v[44:47]
    s_waitcnt vmcnt(18)
    v_mfma_f32_16x16x32_bf16 v[16:19], a[160:163], v[128:131], v[16:19]
    v_mfma_f32_16x16x32_bf16 v[20:23], a[160:163], v[132:135], v[20:23]
    v_mfma_f32_16x16x32_bf16 v[24:27], a[164:167], v[128:131], v[24:27]
    v_mfma_f32_16x16x32_bf16 v[28:31], a[164:167], v[132:135], v[28:31]
    v_mfma_f32_16x16x32_bf16 v[32:35], a[168:171], v[128:131], v[32:35]
    v_mfma_f32_16x16x32_bf16 v[36:39], a[168:171], v[132:135], v[36:39]
    v_mfma_f32_16x16x32_bf16 v[40:43], a[172:175], v[128:131], v[40:43]
    v_mfma_f32_16x16x32_bf16 v[44:47], a[172:175], v[132:135], v[44:47]
    s_waitcnt vmcnt(16)
    v_mfma_f32_16x16x32_bf16 v[16:19], a[176:179], v[136:139], v[16:19]
    v_mfma_f32_16x16x32_bf16 v[20:23], a[176:179], v[140:143], v[20:23]
    v_mfma_f32_16x16x32_bf16 v[24:27], a[180:183], v[136:139], v[24:27]
    v_mfma_f32_16x16x32_bf16 v[28:31], a[180:183], v[140:143], v[28:31]
    v_mfma_f32_16x16x32_bf16 v[32:35], a[184:187], v[136:139], v[32:35]
    v_mfma_f32_16x16x32_bf16 v[36:39], a[184:187], v[140:143], v[36:39]
    v_mfma_f32_16x16x32_bf16 v[40:43], a[188:191], v[136:139], v[40:43]
    v_mfma_f32_16x16x32_bf16 v[44:47], a[188:191], v[140:143], v[44:47]
    s_waitcnt vmcnt(14)
    v_mfma_f32_16x16x32_bf16 v[16:19], a[192:195], v[144:147], v[16:19]
    v_mfma_f32_16x16x32_bf16 v[20:23], a[192:195], v[148:151], v[20:23]
    v_mfma_f32_16x16x32_bf16 v[24:27], a[196:199], v[144:147], v[24:27]
    v_mfma_f32_16x16x32_bf16 v[28:31], a[196:199], v[148:151], v[28:31]
    v_mfma_f32_16x16x32_bf16 v[32:35], a[200:203], v[144:147], v[32:35]
    v_mfma_f32_16x16x32_bf16 v[36:39], a[200:203], v[148:151], v[36:39]
    v_mfma_f32_16x16x32_bf16 v[40:43], a[204:207], v[144:147], v[40:43]
    v_mfma_f32_16x16x32_bf16 v[44:47], a[204:207], v[148:151], v[44:47]
    s_waitcnt vmcnt(12)
    v_mfma_f32_16x16x32_bf16 v[16:19], a[208:211], v[152:155], v[16:19]
    v_mfma_f32_16x16x32_bf16 v[20:23], a[208:211], v[156:159], v[20:23]
    v_mfma_f32_16x16x32_bf16 v[24:27], a[212:215], v[152:155], v[24:27]
    v_mfma_f32_16x16x32_bf16 v[28:31], a[212:215], v[156:159], v[28:31]
    v_mfma_f32_16x16x32_bf16 v[32:35], a[216:219], v[152:155], v[32:35]
    v_mfma_f32_16x16x32_bf16 v[36:39], a[216:219], v[156:159], v[36:39]
    v_mfma_f32_16x16x32_bf16 v[40:43], a[220:223], v[152:155], v[40:43]
    v_mfma_f32_16x16x32_bf16 v[44:47], a[220:223], v[156:159], v[44:47]
    s_waitcnt vmcnt(10)
    v_mfma_f32_16x16x32_bf16 v[16:19], a[224:227], v[160:163], v[16:19]
    v_mfma_f32_16x16x32_bf16 v[20:23], a[224:227], v[164:167], v[20:23]
    v_mfma_f32_16x16x32_bf16 v[24:27], a[228:231], v[160:163], v[24:27]
    v_mfma_f32_16x16x32_bf16 v[28:31], a[228:231], v[164:167], v[28:31]
    v_mfma_f32_16x16x32_bf16 v[32:35], a[232:235], v[160:163], v[32:35]
    v_mfma_f32_16x16x32_bf16 v[36:39], a[232:235], v[164:167], v[36:39]
    v_mfma_f32_16x16x32_bf16 v[40:43], a[236:239], v[160:163], v[40:43]
    v_mfma_f32_16x16x32_bf16 v[44:47], a[236:239], v[164:167], v[44:47]
    s_waitcnt vmcnt(8)
    v_mfma_f32_16x16x32_bf16 v[16:19], a[240:243], v[168:171], v[16:19]
    v_mfma_f32_16x16x32_bf16 v[20:23], a[240:243], v[172:175], v[20:23]
    v_mfma_f32_16x16x32_bf16 v[24:27], a[244:247], v[168:171], v[24:27]
    v_mfma_f32_16x16x32_bf16 v[28:31], a[244:247], v[172:175], v[28:31]
    v_mfma_f32_16x16x32_bf16 v[32:35], a[248:251], v[168:171], v[32:35]
    v_mfma_f32_16x16x32_bf16 v[36:39], a[248:251], v[172:175], v[36:39]
    v_mfma_f32_16x16x32_bf16 v[40:43], a[252:255], v[168:171], v[40:43]
    v_mfma_f32_16x16x32_bf16 v[44:47], a[252:255], v[172:175], v[44:47]
    v_mov_b32 v8, 0
    s_lshl_b32 s46, s67, 7
    s_add_u32 s46, s46, 24186880
    s_cmp_eq_u32 s67, 63
    s_cselect_b32 s45, 14, 1
TK_V_W3:
    s_sub_u32 s99, s99, 1
    s_cbranch_scc1 K2_ABORT
    buffer_load_dword v9, v8, s[36:39], s46 offen sc1
    s_waitcnt vmcnt(0)
    v_readfirstlane_b32 s47, v9
    s_cmp_ge_u32 s47, s45
    s_cbranch_scc1 TK_V_W3_OK
    s_sleep 8
    s_branch TK_V_W3
TK_V_W3_OK:
    s_add_u32 s60, s51, 0
    buffer_load_dwordx4 v[48:51], v4, s[36:39], s60 offen offset:0 sc1
    buffer_load_dwordx4 v[52:55], v4, s[36:39], s60 offen offset:1024 sc1
    buffer_load_dwordx4 v[56:59], v4, s[36:39], s60 offen offset:2048 sc1
    buffer_load_dwordx4 v[60:63], v4, s[36:39], s60 offen offset:3072 sc1
    s_add_u32 s60, s51, 28672
    buffer_load_dwordx4 v[64:67], v4, s[36:39], s60 offen offset:0 sc1
    buffer_load_dwordx4 v[68:71], v4, s[36:39], s60 offen offset:1024 sc1
    buffer_load_dwordx4 v[72:75], v4, s[36:39], s60 offen offset:2048 sc1
    buffer_load_dwordx4 v[76:79], v4, s[36:39], s60 offen offset:3072 sc1
    s_add_u32 s60, s51, 57344
    buffer_load_dwordx4 v[80:83], v4, s[36:39], s60 offen offset:0 sc1
    buffer_load_dwordx4 v[84:87], v4, s[36:39], s60 offen offset:1024 sc1
    buffer_load_dwordx4 v[88:91], v4, s[36:39], s60 offen offset:2048 sc1
    buffer_load_dwordx4 v[92:95], v4, s[36:39], s60 offen offset:3072 sc1
    s_add_u32 s60, s51, 86016
    buffer_load_dwordx4 v[96:99], v4, s[36:39], s60 offen offset:0 sc1
    buffer_load_dwordx4 v[100:103], v4, s[36:39], s60 offen offset:1024 sc1
    buffer_load_dwordx4 v[104:107], v4, s[36:39], s60 offen offset:2048 sc1
    buffer_load_dwordx4 v[108:111], v4, s[36:39], s60 offen offset:3072 sc1
    s_waitcnt vmcnt(12)
    v_mfma_f32_16x16x32_bf16 v[16:19], v[48:51], v[176:179], v[16:19]
    v_mfma_f32_16x16x32_bf16 v[20:23], v[48:51], v[180:183], v[20:23]
    v_mfma_f32_16x16x32_bf16 v[24:27], v[52:55], v[176:179], v[24:27]
    v_mfma_f32_16x16x32_bf16 v[28:31], v[52:55], v[180:183], v[28:31]
    v_mfma_f32_16x16x32_bf16 v[32:35], v[56:59], v[176:179], v[32:35]
    v_mfma_f32_16x16x32_bf16 v[36:39], v[56:59], v[180:183], v[36:39]
    v_mfma_f32_16x16x32_bf16 v[40:43], v[60:63], v[176:179], v[40:43]
    v_mfma_f32_16x16x32_bf16 v[44:47], v[60:63], v[180:183], v[44:47]
    s_waitcnt vmcnt(8)
    v_mfma_f32_16x16x32_bf16 v[16:19], v[64:67], v[184:187], v[16:19]
    v_mfma_f32_16x16x32_bf16 v[20:23], v[64:67], v[188:191], v[20:23]
    v_mfma_f32_16x16x32_bf16 v[24:27], v[68:71], v[184:187], v[24:27]
    v_mfma_f32_16x16x32_bf16 v[28:31], v[68:71], v[188:191], v[28:31]
    v_mfma_f32_16x16x32_bf16 v[32:35], v[72:75], v[184:187], v[32:35]
    v_mfma_f32_16x16x32_bf16 v[36:39], v[72:75], v[188:191], v[36:39]
    v_mfma_f32_16x16x32_bf16 v[40:43], v[76:79], v[184:187], v[40:43]
    v_mfma_f32_16x16x32_bf16 v[44:47], v[76:79], v[188:191], v[44:47]
    s_waitcnt vmcnt(4)
    v_mfma_f32_16x16x32_bf16 v[16:19], v[80:83], v[192:195], v[16:19]
    v_mfma_f32_16x16x32_bf16 v[20:23], v[80:83], v[196:199], v[20:23]
    v_mfma_f32_16x16x32_bf16 v[24:27], v[84:87], v[192:195], v[24:27]
    v_mfma_f32_16x16x32_bf16 v[28:31], v[84:87], v[196:199], v[28:31]
    v_mfma_f32_16x16x32_bf16 v[32:35], v[88:91], v[192:195], v[32:35]
    v_mfma_f32_16x16x32_bf16 v[36:39], v[88:91], v[196:199], v[36:39]
    v_mfma_f32_16x16x32_bf16 v[40:43], v[92:95], v[192:195], v[40:43]
    v_mfma_f32_16x16x32_bf16 v[44:47], v[92:95], v[196:199], v[44:47]
    s_waitcnt vmcnt(0)
    v_mfma_f32_16x16x32_bf16 v[16:19], v[96:99], v[200:203], v[16:19]
    v_mfma_f32_16x16x32_bf16 v[20:23], v[96:99], v[204:207], v[20:23]
    v_mfma_f32_16x16x32_bf16 v[24:27], v[100:103], v[200:203], v[24:27]
    v_mfma_f32_16x16x32_bf16 v[28:31], v[100:103], v[204:207], v[28:31]
    v_mfma_f32_16x16x32_bf16 v[32:35], v[104:107], v[200:203], v[32:35]
    v_mfma_f32_16x16x32_bf16 v[36:39], v[104:107], v[204:207], v[36:39]
    v_mfma_f32_16x16x32_bf16 v[40:43], v[108:111], v[200:203], v[40:43]
    v_mfma_f32_16x16x32_bf16 v[44:47], v[108:111], v[204:207], v[44:47]
    v_lshrrev_b32 v6, 1, v3
    v_lshl_add_u32 v6, v6, 5, v2
    v_lshlrev_b32 v6, 4, v6
    v_and_b32 v7, 1, v3
    v_lshl_add_u32 v6, v7, 3, v6
    s_mul_i32 s56, s67, 28
    s_add_u32 s56, s56, s50
    s_lshl_b32 s56, s56, 10
    s_add_u32 s56, s56, 38797312
    v_mul_u32_u24 v7, 56, v2
    s_mul_i32 s57, s67, 32*56
    s_lshl_b32 s58, s68, 3
    s_add_u32 s57, s57, s58
    s_add_u32 s57, s57, 40894464
    v_cmp_eq_u32 s[58:59], 0, v3
    v_cvt_pk_bf16_f32 v60, v16, v17
    v_cvt_pk_bf16_f32 v61, v18, v19
    v_lshlrev_b32 v62, 16, v60
    v_and_b32 v63, 0xffff0000, v60
    v_lshlrev_b32 v64, 16, v61
    v_and_b32 v65, 0xffff0000, v61
    v_lshlrev_b32 v66, 16, v240
    v_and_b32 v67, 0xffff0000, v240
    v_lshlrev_b32 v68, 16, v241
    v_and_b32 v69, 0xffff0000, v241
    v_add_f32 v62, v62, v66
    v_add_f32 v63, v63, v67
    v_add_f32 v64, v64, v68
    v_add_f32 v65, v65, v69
    v_cvt_pk_bf16_f32 v70, v62, v63
    v_cvt_pk_bf16_f32 v71, v64, v65
    buffer_store_dwordx2 v[70:71], v6, s[36:39], s56 offen offset:0 sc1
    v_lshlrev_b32 v120, 16, v70
    v_and_b32 v121, 0xffff0000, v70
    v_lshlrev_b32 v122, 16, v71
    v_and_b32 v123, 0xffff0000, v71
    v_cvt_pk_bf16_f32 v60, v24, v25
    v_cvt_pk_bf16_f32 v61, v26, v27
    v_lshlrev_b32 v62, 16, v60
    v_and_b32 v63, 0xffff0000, v60
    v_lshlrev_b32 v64, 16, v61
    v_and_b32 v65, 0xffff0000, v61
    v_lshlrev_b32 v66, 16, v242
    v_and_b32 v67, 0xffff0000, v242
    v_lshlrev_b32 v68, 16, v243
    v_and_b32 v69, 0xffff0000, v243
    v_add_f32 v62, v62, v66
    v_add_f32 v63, v63, v67
    v_add_f32 v64, v64, v68
    v_add_f32 v65, v65, v69
    v_cvt_pk_bf16_f32 v72, v62, v63
    v_cvt_pk_bf16_f32 v73, v64, v65
    buffer_store_dwordx2 v[72:73], v6, s[36:39], s56 offen offset:1024 sc1
    v_lshlrev_b32 v124, 16, v72
    v_and_b32 v125, 0xffff0000, v72
    v_lshlrev_b32 v126, 16, v73
    v_and_b32 v127, 0xffff0000, v73
    v_cvt_pk_bf16_f32 v60, v32, v33
    v_cvt_pk_bf16_f32 v61, v34, v35
    v_lshlrev_b32 v62, 16, v60
    v_and_b32 v63, 0xffff0000, v60
    v_lshlrev_b32 v64, 16, v61
    v_and_b32 v65, 0xffff0000, v61
    v_lshlrev_b32 v66, 16, v244
    v_and_b32 v67, 0xffff0000, v244
    v_lshlrev_b32 v68, 16, v245
    v_and_b32 v69, 0xffff0000, v245
    v_add_f32 v62, v62, v66
    v_add_f32 v63, v63, v67
    v_add_f32 v64, v64, v68
    v_add_f32 v65, v65, v69
    v_cvt_pk_bf16_f32 v74, v62, v63
    v_cvt_pk_bf16_f32 v75, v64, v65
    buffer_store_dwordx2 v[74:75], v6, s[36:39], s56 offen offset:2048 sc1
    v_lshlrev_b32 v128, 16, v74
    v_and_b32 v129, 0xffff0000, v74
    v_lshlrev_b32 v130, 16, v75
    v_and_b32 v131, 0xffff0000, v75
    v_cvt_pk_bf16_f32 v60, v40, v41
    v_cvt_pk_bf16_f32 v61, v42, v43
    v_lshlrev_b32 v62, 16, v60
    v_and_b32 v63, 0xffff0000, v60
    v_lshlrev_b32 v64, 16, v61
    v_and_b32 v65, 0xffff0000, v61
    v_lshlrev_b32 v66, 16, v246
    v_and_b32 v67, 0xffff0000, v246
    v_lshlrev_b32 v68, 16, v247
    v_and_b32 v69, 0xffff0000, v247
    v_add_f32 v62, v62, v66
    v_add_f32 v63, v63, v67
    v_add_f32 v64, v64, v68
    v_add_f32 v65, v65, v69
    v_cvt_pk_bf16_f32 v76, v62, v63
    v_cvt_pk_bf16_f32 v77, v64, v65
    buffer_store_dwordx2 v[76:77], v6, s[36:39], s56 offen offset:3072 sc1
    v_lshlrev_b32 v132, 16, v76
    v_and_b32 v133, 0xffff0000, v76
    v_lshlrev_b32 v134, 16, v77
    v_and_b32 v135, 0xffff0000, v77
    v_add_f32 v80, v120, v121
    v_add_f32 v80, v80, v122
    v_add_f32 v80, v80, v123
    v_add_f32 v80, v80, v124
    v_add_f32 v80, v80, v125
    v_add_f32 v80, v80, v126
    v_add_f32 v80, v80, v127
    v_add_f32 v80, v80, v128
    v_add_f32 v80, v80, v129
    v_add_f32 v80, v80, v130
    v_add_f32 v80, v80, v131
    v_add_f32 v80, v80, v132
    v_add_f32 v80, v80, v133
    v_add_f32 v80, v80, v134
    v_add_f32 v80, v80, v135
    v_mov_b32 v81, v80
    s_nop 1
    v_permlane16_swap_b32 v80, v81
    s_nop 1
    v_add_f32 v80, v80, v81
    v_mov_b32 v81, v80
    s_nop 1
    v_permlane32_swap_b32 v80, v81
    s_nop 1
    v_add_f32 v80, v80, v81
    v_mul_f32 v80, 0x3c800000, v80
    v_sub_f32 v82, v120, v80
    v_mul_f32 v81, v82, v82
    v_sub_f32 v82, v121, v80
    v_fmac_f32 v81, v82, v82
    v_sub_f32 v82, v122, v80
    v_fmac_f32 v81, v82, v82
    v_sub_f32 v82, v123, v80
    v_fmac_f32 v81, v82, v82
    v_sub_f32 v82, v124, v80
    v_fmac_f32 v81, v82, v82
    v_sub_f32 v82, v125, v80
    v_fmac_f32 v81, v82, v82
    v_sub_f32 v82, v126, v80
    v_fmac_f32 v81, v82, v82
    v_sub_f32 v82, v127, v80
    v_fmac_f32 v81, v82, v82
    v_sub_f32 v82, v128, v80
    v_fmac_f32 v81, v82, v82
    v_sub_f32 v82, v129, v80
    v_fmac_f32 v81, v82, v82
    v_sub_f32 v82, v130, v80
    v_fmac_f32 v81, v82, v82
    v_sub_f32 v82, v131, v80
    v_fmac_f32 v81, v82, v82
    v_sub_f32 v82, v132, v80
    v_fmac_f32 v81, v82, v82
    v_sub_f32 v82, v133, v80
    v_fmac_f32 v81, v82, v82
    v_sub_f32 v82, v134, v80
    v_fmac_f32 v81, v82, v82
    v_sub_f32 v82, v135, v80
    v_fmac_f32 v81, v82, v82
    v_mov_b32 v84, v80
    v_mov_b32 v82, v81
    s_nop 1
    v_permlane16_swap_b32 v81, v82
    s_nop 1
    v_add_f32 v81, v81, v82
    v_mov_b32 v82, v81
    s_nop 1
    v_permlane32_swap_b32 v81, v82
    s_nop 1
    v_add_f32 v81, v81, v82
    v_mov_b32 v85, v81
    s_mov_b64 exec, s[58:59]
    s_add_u32 s60, s57, 0
    buffer_store_dwordx2 v[84:85], v7, s[36:39], s60 offen sc1
    s_mov_b64 exec, -1
    v_cvt_pk_bf16_f32 v60, v20, v21
    v_cvt_pk_bf16_f32 v61, v22, v23
    v_lshlrev_b32 v62, 16, v60
    v_and_b32 v63, 0xffff0000, v60
    v_lshlrev_b32 v64, 16, v61
    v_and_b32 v65, 0xffff0000, v61
    v_lshlrev_b32 v66, 16, v248
    v_and_b32 v67, 0xffff0000, v248
    v_lshlrev_b32 v68, 16, v249
    v_and_b32 v69, 0xffff0000, v249
    v_add_f32 v62, v62, v66
    v_add_f32 v63, v63, v67
    v_add_f32 v64, v64, v68
    v_add_f32 v65, v65, v69
    v_cvt_pk_bf16_f32 v70, v62, v63
    v_cvt_pk_bf16_f32 v71, v64, v65
    buffer_store_dwordx2 v[70:71], v6, s[36:39], s56 offen offset:256 sc1
    v_lshlrev_b32 v120, 16, v70
    v_and_b32 v121, 0xffff0000, v70
    v_lshlrev_b32 v122, 16, v71
    v_and_b32 v123, 0xffff0000, v71
    v_cvt_pk_bf16_f32 v60, v28, v29
    v_cvt_pk_bf16_f32 v61, v30, v31
    v_lshlrev_b32 v62, 16, v60
    v_and_b32 v63, 0xffff0000, v60
    v_lshlrev_b32 v64, 16, v61
    v_and_b32 v65, 0xffff0000, v61
    v_lshlrev_b32 v66, 16, v250
    v_and_b32 v67, 0xffff0000, v250
    v_lshlrev_b32 v68, 16, v251
    v_and_b32 v69, 0xffff0000, v251
    v_add_f32 v62, v62, v66
    v_add_f32 v63, v63, v67
    v_add_f32 v64, v64, v68
    v_add_f32 v65, v65, v69
    v_cvt_pk_bf16_f32 v72, v62, v63
    v_cvt_pk_bf16_f32 v73, v64, v65
    buffer_store_dwordx2 v[72:73], v6, s[36:39], s56 offen offset:1280 sc1
    v_lshlrev_b32 v124, 16, v72
    v_and_b32 v125, 0xffff0000, v72
    v_lshlrev_b32 v126, 16, v73
    v_and_b32 v127, 0xffff0000, v73
    v_cvt_pk_bf16_f32 v60, v36, v37
    v_cvt_pk_bf16_f32 v61, v38, v39
    v_lshlrev_b32 v62, 16, v60
    v_and_b32 v63, 0xffff0000, v60
    v_lshlrev_b32 v64, 16, v61
    v_and_b32 v65, 0xffff0000, v61
    v_lshlrev_b32 v66, 16, v252
    v_and_b32 v67, 0xffff0000, v252
    v_lshlrev_b32 v68, 16, v253
    v_and_b32 v69, 0xffff0000, v253
    v_add_f32 v62, v62, v66
    v_add_f32 v63, v63, v67
    v_add_f32 v64, v64, v68
    v_add_f32 v65, v65, v69
    v_cvt_pk_bf16_f32 v74, v62, v63
    v_cvt_pk_bf16_f32 v75, v64, v65
    buffer_store_dwordx2 v[74:75], v6, s[36:39], s56 offen offset:2304 sc1
    v_lshlrev_b32 v128, 16, v74
    v_and_b32 v129, 0xffff0000, v74
    v_lshlrev_b32 v130, 16, v75
    v_and_b32 v131, 0xffff0000, v75
    v_cvt_pk_bf16_f32 v60, v44, v45
    v_cvt_pk_bf16_f32 v61, v46, v47
    v_lshlrev_b32 v62, 16, v60
    v_and_b32 v63, 0xffff0000, v60
    v_lshlrev_b32 v64, 16, v61
    v_and_b32 v65, 0xffff0000, v61
    v_lshlrev_b32 v66, 16, v254
    v_and_b32 v67, 0xffff0000, v254
    v_lshlrev_b32 v68, 16, v255
    v_and_b32 v69, 0xffff0000, v255
    v_add_f32 v62, v62, v66
    v_add_f32 v63, v63, v67
    v_add_f32 v64, v64, v68
    v_add_f32 v65, v65, v69
    v_cvt_pk_bf16_f32 v76, v62, v63
    v_cvt_pk_bf16_f32 v77, v64, v65
    buffer_store_dwordx2 v[76:77], v6, s[36:39], s56 offen offset:3328 sc1
    v_lshlrev_b32 v132, 16, v76
    v_and_b32 v133, 0xffff0000, v76
    v_lshlrev_b32 v134, 16, v77
    v_and_b32 v135, 0xffff0000, v77
    v_add_f32 v80, v120, v121
    v_add_f32 v80, v80, v122
    v_add_f32 v80, v80, v123
    v_add_f32 v80, v80, v124
    v_add_f32 v80, v80, v125
    v_add_f32 v80, v80, v126
    v_add_f32 v80, v80, v127
    v_add_f32 v80, v80, v128
    v_add_f32 v80, v80, v129
    v_add_f32 v80, v80, v130
    v_add_f32 v80, v80, v131
    v_add_f32 v80, v80, v132
    v_add_f32 v80, v80, v133
    v_add_f32 v80, v80, v134
    v_add_f32 v80, v80, v135
    v_mov_b32 v81, v80
    s_nop 1
    v_permlane16_swap_b32 v80, v81
    s_nop 1
    v_add_f32 v80, v80, v81
    v_mov_b32 v81, v80
    s_nop 1
    v_permlane32_swap_b32 v80, v81
    s_nop 1
    v_add_f32 v80, v80, v81
    v_mul_f32 v80, 0x3c800000, v80
    v_sub_f32 v82, v120, v80
    v_mul_f32 v81, v82, v82
    v_sub_f32 v82, v121, v80
    v_fmac_f32 v81, v82, v82
    v_sub_f32 v82, v122, v80
    v_fmac_f32 v81, v82, v82
    v_sub_f32 v82, v123, v80
    v_fmac_f32 v81, v82, v82
    v_sub_f32 v82, v124, v80
    v_fmac_f32 v81, v82, v82
    v_sub_f32 v82, v125, v80
    v_fmac_f32 v81, v82, v82
    v_sub_f32 v82, v126, v80
    v_fmac_f32 v81, v82, v82
    v_sub_f32 v82, v127, v80
    v_fmac_f32 v81, v82, v82
    v_sub_f32 v82, v128, v80
    v_fmac_f32 v81, v82, v82
    v_sub_f32 v82, v129, v80
    v_fmac_f32 v81, v82, v82
    v_sub_f32 v82, v130, v80
    v_fmac_f32 v81, v82, v82
    v_sub_f32 v82, v131, v80
    v_fmac_f32 v81, v82, v82
    v_sub_f32 v82, v132, v80
    v_fmac_f32 v81, v82, v82
    v_sub_f32 v82, v133, v80
    v_fmac_f32 v81, v82, v82
    v_sub_f32 v82, v134, v80
    v_fmac_f32 v81, v82, v82
    v_sub_f32 v82, v135, v80
    v_fmac_f32 v81, v82, v82
    v_mov_b32 v84, v80
    v_mov_b32 v82, v81
    s_nop 1
    v_permlane16_swap_b32 v81, v82
    s_nop 1
    v_add_f32 v81, v81, v82
    v_mov_b32 v82, v81
    s_nop 1
    v_permlane32_swap_b32 v81, v82
    s_nop 1
    v_add_f32 v81, v81, v82
    v_mov_b32 v85, v81
    s_mov_b64 exec, s[58:59]
    s_add_u32 s60, s57, 896
    buffer_store_dwordx2 v[84:85], v7, s[36:39], s60 offen sc1
    s_mov_b64 exec, -1
    s_lshl_b32 s46, s67, 7
    s_add_u32 s46, s46, 24215552
    s_waitcnt vmcnt(0)
    s_mov_b64 exec, 1
    v_mov_b32 v8, 0
    v_mov_b32 v9, 1
    buffer_atomic_add v9, v8, s[36:39], s46 offen
    s_mov_b64 exec, -1
    s_add_u32 s67, s67, s69
    s_cmp_lt_u32 s67, 64
    s_cbranch_scc1 TKL_V
    s_endpgm
TKP_F1:
    s_sub_u32 s66, s66, 184
    s_mul_i32 s67, s66, 1171
    s_lshr_b32 s67, s67, 16
    s_mul_i32 s68, s67, 56
    s_sub_u32 s68, s66, s68
    s_mov_b32 s69, 6
    v_mov_b32 v8, 0
    s_mov_b32 s46, 24198400
TKW_F1:
    s_sub_u32 s99, s99, 1
    s_cbranch_scc1 K2_ABORT
    buffer_load_dword v9, v8, s[36:39], s46 offen sc1
    s_waitcnt vmcnt(0)
    v_readfirstlane_b32 s47, v9
    s_cmp_ge_u32 s47, 203
    s_cbranch_scc1 TKW_F1_OK
    s_sleep 8
    s_branch TKW_F1
TKW_F1_OK:
TKL_F1:
    v_lshlrev_b32 v4, 4, v1
    v_and_b32 v2, 31, v1
    v_lshrrev_b32 v3, 5, v1
    s_lshr_b32 s50, s68, 1
    s_and_b32 s51, s68, 1
    s_lshl_b32 s52, s50, 2
    s_add_u32 s52, s52, s51
    s_mul_i32 s53, s52, 28*1024
    s_add_u32 s53, s53, 17825792
    s_add_u32 s54, s53, 57344
    s_mul_i32 s55, s67, 28*1024
    s_add_u32 s55, s55, 38797312
    s_add_u32 s60, s53, 0
    buffer_load_dwordx4 a[0:3], v4, s[36:39], s60 offen offset:0
    buffer_load_dwordx4 a[4:7], v4, s[36:39], s60 offen offset:1024
    buffer_load_dwordx4 a[8:11], v4, s[36:39], s60 offen offset:2048
    buffer_load_dwordx4 a[12:15], v4, s[36:39], s60 offen offset:3072
    s_add_u32 s60, s53, 4096
    buffer_load_dwordx4 a[16:19], v4, s[36:39], s60 offen offset:0
    buffer_load_dwordx4 a[20:23], v4, s[36:39], s60 offen offset:1024
    buffer_load_dwordx4 a[24:27], v4, s[36:39], s60 offen offset:2048
    buffer_load_dwordx4 a[28:31], v4, s[36:39], s60 offen offset:3072
    s_add_u32 s60, s53, 8192
    buffer_load_dwordx4 a[32:35], v4, s[36:39], s60 offen offset:0
    buffer_load_dwordx4 a[36:39], v4, s[36:39], s60 offen offset:1024
    buffer_load_dwordx4 a[40:43], v4, s[36:39], s60 offen offset:2048
    buffer_load_dwordx4 a[44:47], v4, s[36:39], s60 offen offset:3072
    s_add_u32 s60, s53, 12288
    buffer_load_dwordx4 a[48:51], v4, s[36:39], s60 offen offset:0
    buffer_load_dwordx4 a[52:55], v4, s[36:39], s60 offen offset:1024
    buffer_load_dwordx4 a[56:59], v4, s[36:39], s60 offen offset:2048
    buffer_load_dwordx4 a[60:63], v4, s[36:39], s60 offen offset:3072
    s_add_u32 s60, s53, 16384
    buffer_load_dwordx4 a[64:67], v4, s[36:39], s60 offen offset:0
    buffer_load_dwordx4 a[68:71], v4, s[36:39], s60 offen offset:1024
    buffer_load_dwordx4 a[72:75], v4, s[36:39], s60 offen offset:2048
    buffer_load_dwordx4 a[76:79], v4, s[36:39], s60 offen offset:3072
    s_add_u32 s60, s53, 20480
    buffer_load_dwordx4 a[80:83], v4, s[36:39], s60 offen offset:0
    buffer_load_dwordx4 a[84:87], v4, s[36:39], s60 offen offset:1024
    buffer_load_dwordx4 a[88:91], v4, s[36:39], s60 offen offset:2048
    buffer_load_dwordx4 a[92:95], v4, s[36:39], s60 offen offset:3072
    s_add_u32 s60, s53, 24576
    buffer_load_dwordx4 a[96:99], v4, s[36:39], s60 offen offset:0
    buffer_load_dwordx4 a[100:103], v4, s[36:39], s60 offen offset:1024
    buffer_load_dwordx4 a[104:107], v4, s[36:39], s60 offen offset:2048
    buffer_load_dwordx4 a[108:111], v4, s[36:39], s60 offen offset:3072
    s_add_u32 s60, s54, 0
    buffer_load_dwordx4 a[112:115], v4, s[36:39], s60 offen offset:0
    buffer_load_dwordx4 a[116:119], v4, s[36:39], s60 offen offset:1024
    buffer_load_dwordx4 a[120:123], v4, s[36:39], s60 offen offset:2048
    buffer_load_dwordx4 a[124:127], v4, s[36:39], s60 offen offset:3072
    s_add_u32 s60, s54, 4096
    buffer_load_dwordx4 a[128:131], v4, s[36:39], s60 offen offset:0
    buffer_load_dwordx4 a[132:135], v4, s[36:39], s60 offen offset:1024
    buffer_load_dwordx4 a[136:139], v4, s[36:39], s60 offen offset:2048
    buffer_load_dwordx4 a[140:143], v4, s[36:39], s60 offen offset:3072
    s_add_u32 s60, s54, 8192
    buffer_load_dwordx4 a[144:147], v4, s[36:39], s60 offen offset:0
    buffer_load_dwordx4 a[148:151], v4, s[36:39], s60 offen offset:1024
    buffer_load_dwordx4 a[152:155], v4, s[36:39], s60 offen offset:2048
    buffer_load_dwordx4 a[156:159], v4, s[36:39], s60 offen offset:3072
    s_add_u32 s60, s54, 12288
    buffer_load_dwordx4 a[160:163], v4, s[36:39], s60 offen offset:0
    buffer_load_dwordx4 a[164:167], v4, s[36:39], s60 offen offset:1024
    buffer_load_dwordx4 a[168:171], v4, s[36:39], s60 offen offset:2048
    buffer_load_dwordx4 a[172:175], v4, s[36:39], s60 offen offset:3072
    s_add_u32 s60, s54, 16384
    buffer_load_dwordx4 a[176:179], v4, s[36:39], s60 offen offset:0
    buffer_load_dwordx4 a[180:183], v4, s[36:39], s60 offen offset:1024
    buffer_load_dwordx4 a[184:187], v4, s[36:39], s60 offen offset:2048
    buffer_load_dwordx4 a[188:191], v4, s[36:39], s60 offen offset:3072
    s_add_u32 s60, s54, 20480
    buffer_load_dwordx4 a[192:195], v4, s[36:39], s60 offen offset:0
    buffer_load_dwordx4 a[196:199], v4, s[36:39], s60 offen offset:1024
    buffer_load_dwordx4 a[200:203], v4, s[36:39], s60 offen offset:2048
    buffer_load_dwordx4 a[204:207], v4, s[36:39], s60 offen offset:3072
    s_add_u32 s60, s54, 24576
    buffer_load_dwordx4 a[208:211], v4, s[36:39], s60 offen offset:0
    buffer_load_dwordx4 a[212:215], v4, s[36:39], s60 offen offset:1024
    buffer_load_dwordx4 a[216:219], v4, s[36:39], s60 offen offset:2048
    buffer_load_dwordx4 a[220:223], v4, s[36:39], s60 offen offset:3072
    v_lshlrev_b32 v5, 4, v3
    s_lshl_b32 s58, s52, 7
    s_add_u32 s58, s58, 24117248
    s_add_u32 s59, s58, 16384
    buffer_load_dwordx4 v[176:179], v5, s[36:39], s58 offen offset:0
    buffer_load_dwordx4 v[208:211], v5, s[36:39], s59 offen offset:0
    buffer_load_dwordx4 v[180:183], v5, s[36:39], s58 offen offset:32
    buffer_load_dwordx4 v[212:215], v5, s[36:39], s59 offen offset:32
    buffer_load_dwordx4 v[184:187], v5, s[36:39], s58 offen offset:64
    buffer_load_dwordx4 v[216:219], v5, s[36:39], s59 offen offset:64
    buffer_load_dwordx4 v[188:191], v5, s[36:39], s58 offen offset:96
    buffer_load_dwordx4 v[220:223], v5, s[36:39], s59 offen offset:96
    buffer_load_dwordx4 v[192:195], v5, s[36:39], s58 offen offset:256
    buffer_load_dwordx4 v[224:227], v5, s[36:39], s59 offen offset:256
    buffer_load_dwordx4 v[196:199], v5, s[36:39], s58 offen offset:288
    buffer_load_dwordx4 v[228:231], v5, s[36:39], s59 offen offset:288
    buffer_load_dwordx4 v[200:203], v5, s[36:39], s58 offen offset:320
    buffer_load_dwordx4 v[232:235], v5, s[36:39], s59 offen offset:320
    buffer_load_dwordx4 v[204:207], v5, s[36:39], s58 offen offset:352
    buffer_load_dwordx4 v[236:239], v5, s[36:39], s59 offen offset:352
    v_mov_b32 v8, 0
    s_lshl_b32 s46, s67, 7
    s_add_u32 s46, s46, 24215552
TK_F1_W:
    s_sub_u32 s99, s99, 1
    s_cbranch_scc1 K2_ABORT
    buffer_load_dword v9, v8, s[36:39], s46 offen sc1
    s_waitcnt vmcnt(0)
    v_readfirstlane_b32 s47, v9
    s_cmp_ge_u32 s47, 7
    s_cbranch_scc1 TK_F1_W_OK
    s_sleep 8
    s_branch TK_F1_W
TK_F1_W_OK:
    s_add_u32 s60, s55, 0
    buffer_load_dwordx4 v[48:51], v4, s[36:39], s60 offen offset:0 sc1
    buffer_load_dwordx4 v[52:55], v4, s[36:39], s60 offen offset:1024 sc1
    buffer_load_dwordx4 v[56:59], v4, s[36:39], s60 offen offset:2048 sc1
    buffer_load_dwordx4 v[60:63], v4, s[36:39], s60 offen offset:3072 sc1
    s_add_u32 s60, s55, 4096
    buffer_load_dwordx4 v[64:67], v4, s[36:39], s60 offen offset:0 sc1
    buffer_load_dwordx4 v[68:71], v4, s[36:39], s60 offen offset:1024 sc1
    buffer_load_dwordx4 v[72:75], v4, s[36:39], s60 offen offset:2048 sc1
    buffer_load_dwordx4 v[76:79], v4, s[36:39], s60 offen offset:3072 sc1
    s_add_u32 s60, s55, 8192
    buffer_load_dwordx4 v[80:83], v4, s[36:39], s60 offen offset:0 sc1
    buffer_load_dwordx4 v[84:87], v4, s[36:39], s60 offen offset:1024 sc1
    buffer_load_dwordx4 v[88:91], v4, s[36:39], s60 offen offset:2048 sc1
    buffer_load_dwordx4 v[92:95], v4, s[36:39], s60 offen offset:3072 sc1
    s_add_u32 s60, s55, 12288
    buffer_load_dwordx4 v[96:99], v4, s[36:39], s60 offen offset:0 sc1
    buffer_load_dwordx4 v[100:103], v4, s[36:39], s60 offen offset:1024 sc1
    buffer_load_dwordx4 v[104:107], v4, s[36:39], s60 offen offset:2048 sc1
    buffer_load_dwordx4 v[108:111], v4, s[36:39], s60 offen offset:3072 sc1
    s_add_u32 s60, s55, 16384
    buffer_load_dwordx4 v[112:115], v4, s[36:39], s60 offen offset:0 sc1
    buffer_load_dwordx4 v[116:119], v4, s[36:39], s60 offen offset:1024 sc1
    buffer_load_dwordx4 v[120:123], v4, s[36:39], s60 offen offset:2048 sc1
    buffer_load_dwordx4 v[124:127], v4, s[36:39], s60 offen offset:3072 sc1
    s_add_u32 s60, s55, 20480
    buffer_load_dwordx4 v[128:131], v4, s[36:39], s60 offen offset:0 sc1
    buffer_load_dwordx4 v[132:135], v4, s[36:39], s60 offen offset:1024 sc1
    buffer_load_dwordx4 v[136:139], v4, s[36:39], s60 offen offset:2048 sc1
    buffer_load_dwordx4 v[140:143], v4, s[36:39], s60 offen offset:3072 sc1
    s_add_u32 s60, s55, 24576
    buffer_load_dwordx4 v[144:147], v4, s[36:39], s60 offen offset:0 sc1
    buffer_load_dwordx4 v[148:151], v4, s[36:39], s60 offen offset:1024 sc1
    buffer_load_dwordx4 v[152:155], v4, s[36:39], s60 offen offset:2048 sc1
    buffer_load_dwordx4 v[156:159], v4, s[36:39], s60 offen offset:3072 sc1
    v_mul_u32_u24 v6, 56, v2
    s_mul_i32 s60, s67, 32*56
    s_add_u32 s60, s60, 40894464
    buffer_load_dwordx4 v[160:163], v6, s[36:39], s60 offen offset:0 sc1
    buffer_load_dwordx4 v[164:167], v6, s[36:39], s60 offen offset:16 sc1
    buffer_load_dwordx4 v[168:171], v6, s[36:39], s60 offen offset:32 sc1
    buffer_load_dwordx2 v[172:173], v6, s[36:39], s60 offen offset:48 sc1
    s_waitcnt vmcnt(31)
    v_mfma_f32_32x32x16_bf16 v[16:31], a[0:3], v[48:51], 0
    v_mfma_f32_32x32x16_bf16 v[32:47], a[112:115], v[48:51], 0
    s_waitcnt vmcnt(30)
    v_mfma_f32_32x32x16_bf16 v[16:31], a[4:7], v[52:55], v[16:31]
    v_mfma_f32_32x32x16_bf16 v[32:47], a[116:119], v[52:55], v[32:47]
    s_waitcnt vmcnt(29)
    v_mfma_f32_32x32x16_bf16 v[16:31], a[8:11], v[56:59], v[16:31]
    v_mfma_f32_32x32x16_bf16 v[32:47], a[120:123], v[56:59], v[32:47]
    s_waitcnt vmcnt(28)
    v_mfma_f32_32x32x16_bf16 v[16:31], a[12:15], v[60:63], v[16:31]
    v_mfma_f32_32x32x16_bf16 v[32:47], a[124:127], v[60:63], v[32:47]
    s_waitcnt vmcnt(27)
    v_mfma_f32_32x32x16_bf16 v[16:31], a[16:19], v[64:67], v[16:31]
    v_mfma_f32_32x32x16_bf16 v[32:47], a[128:131], v[64:67], v[32:47]
    s_waitcnt vmcnt(26)
    v_mfma_f32_32x32x16_bf16 v[16:31], a[20:23], v[68:71], v[16:31]
    v_mfma_f32_32x32x16_bf16 v[32:47], a[132:135], v[68:71], v[32:47]
    s_waitcnt vmcnt(25)
    v_mfma_f32_32x32x16_bf16 v[16:31], a[24:27], v[72:75], v[16:31]
    v_mfma_f32_32x32x16_bf16 v[32:47], a[136:139], v[72:75], v[32:47]
    s_waitcnt vmcnt(24)
    v_mfma_f32_32x32x16_bf16 v[16:31], a[28:31], v[76:79], v[16:31]
    v_mfma_f32_32x32x16_bf16 v[32:47], a[140:143], v[76:79], v[32:47]
    s_waitcnt vmcnt(23)
    v_mfma_f32_32x32x16_bf16 v[16:31], a[32:35], v[80:83], v[16:31]
    v_mfma_f32_32x32x16_bf16 v[32:47], a[144:147], v[80:83], v[32:47]
    s_waitcnt vmcnt(22)
    v_mfma_f32_32x32x16_bf16 v[16:31], a[36:39], v[84:87], v[16:31]
    v_mfma_f32_32x32x16_bf16 v[32:47], a[148:151], v[84:87], v[32:47]
    s_waitcnt vmcnt(21)
    v_mfma_f32_32x32x16_bf16 v[16:31], a[40:43], v[88:91], v[16:31]
    v_mfma_f32_32x32x16_bf16 v[32:47], a[152:155], v[88:91], v[32:47]
    s_waitcnt vmcnt(20)
    v_mfma_f32_32x32x16_bf16 v[16:31], a[44:47], v[92:95], v[16:31]
    v_mfma_f32_32x32x16_bf16 v[32:47], a[156:159], v[92:95], v[32:47]
    s_waitcnt vmcnt(19)
    v_mfma_f32_32x32x16_bf16 v[16:31], a[48:51], v[96:99], v[16:31]
    v_mfma_f32_32x32x16_bf16 v[32:47], a[160:163], v[96:99], v[32:47]
    s_waitcnt vmcnt(18)
    v_mfma_f32_32x32x16_bf16 v[16:31], a[52:55], v[100:103], v[16:31]
    v_mfma_f32_32x32x16_bf16 v[32:47], a[164:167], v[100:103], v[32:47]
    s_waitcnt vmcnt(17)
    v_mfma_f32_32x32x16_bf16 v[16:31], a[56:59], v[104:107], v[16:31]
    v_mfma_f32_32x32x16_bf16 v[32:47], a[168:171], v[104:107], v[32:47]
    s_waitcnt vmcnt(16)
    v_mfma_f32_32x32x16_bf16 v[16:31], a[60:63], v[108:111], v[16:31]
    v_mfma_f32_32x32x16_bf16 v[32:47], a[172:175], v[108:111], v[32:47]
    s_waitcnt vmcnt(15)
    v_mfma_f32_32x32x16_bf16 v[16:31], a[64:67], v[112:115], v[16:31]
    v_mfma_f32_32x32x16_bf16 v[32:47], a[176:179], v[112:115], v[32:47]
    s_waitcnt vmcnt(14)
    v_mfma_f32_32x32x16_bf16 v[16:31], a[68:71], v[116:119], v[16:31]
    v_mfma_f32_32x32x16_bf16 v[32:47], a[180:183], v[116:119], v[32:47]
    s_waitcnt vmcnt(13)
    v_mfma_f32_32x32x16_bf16 v[16:31], a[72:75], v[120:123], v[16:31]
    v_mfma_f32_32x32x16_bf16 v[32:47], a[184:187], v[120:123], v[32:47]
    s_waitcnt vmcnt(12)
    v_mfma_f32_32x32x16_bf16 v[16:31], a[76:79], v[124:127], v[16:31]
    v_mfma_f32_32x32x16_bf16 v[32:47], a[188:191], v[124:127], v[32:47]
    s_waitcnt vmcnt(11)
    v_mfma_f32_32x32x16_bf16 v[16:31], a[80:83], v[128:131], v[16:31]
    v_mfma_f32_32x32x16_bf16 v[32:47], a[192:195], v[128:131], v[32:47]
    s_waitcnt vmcnt(10)
    v_mfma_f32_32x32x16_bf16 v[16:31], a[84:87], v[132:135], v[16:31]
    v_mfma_f32_32x32x16_bf16 v[32:47], a[196:199], v[132:135], v[32:47]
    s_waitcnt vmcnt(9)
    v_mfma_f32_32x32x16_bf16 v[16:31], a[88:91], v[136:139], v[16:31]
    v_mfma_f32_32x32x16_bf16 v[32:47], a[200:203], v[136:139], v[32:47]
    s_waitcnt vmcnt(8)
    v_mfma_f32_32x32x16_bf16 v[16:31], a[92:95], v[140:143], v[16:31]
    v_mfma_f32_32x32x16_bf16 v[32:47], a[204:207], v[140:143], v[32:47]
    s_waitcnt vmcnt(7)
    v_mfma_f32_32x32x16_bf16 v[16:31], a[96:99], v[144:147], v[16:31]
    v_mfma_f32_32x32x16_bf16 v[32:47], a[208:211], v[144:147], v[32:47]
    s_waitcnt vmcnt(6)
    v_mfma_f32_32x32x16_bf16 v[16:31], a[100:103], v[148:151], v[16:31]
    v_mfma_f32_32x32x16_bf16 v[32:47], a[212:215], v[148:151], v[32:47]
    s_waitcnt vmcnt(5)
    v_mfma_f32_32x32x16_bf16 v[16:31], a[104:107], v[152:155], v[16:31]
    v_mfma_f32_32x32x16_bf16 v[32:47], a[216:219], v[152:155], v[32:47]
    s_waitcnt vmcnt(4)
    v_mfma_f32_32x32x16_bf16 v[16:31], a[108:111], v[156:159], v[16:31]
    v_mfma_f32_32x32x16_bf16 v[32:47], a[220:223], v[156:159], v[32:47]
    s_waitcnt vmcnt(0)
    v_add_f32 v176, v176, v208
    v_add_f32 v177, v177, v209
    v_add_f32 v178, v178, v210
    v_add_f32 v179, v179, v211
    v_add_f32 v180, v180, v212
    v_add_f32 v181, v181, v213
    v_add_f32 v182, v182, v214
    v_add_f32 v183, v183, v215
    v_add_f32 v184, v184, v216
    v_add_f32 v185, v185, v217
    v_add_f32 v186, v186, v218
    v_add_f32 v187, v187, v219
    v_add_f32 v188, v188, v220
    v_add_f32 v189, v189, v221
    v_add_f32 v190, v190, v222
    v_add_f32 v191, v191, v223
    v_add_f32 v192, v192, v224
    v_add_f32 v193, v193, v225
    v_add_f32 v194, v194, v226
    v_add_f32 v195, v195, v227
    v_add_f32 v196, v196, v228
    v_add_f32 v197, v197, v229
    v_add_f32 v198, v198, v230
    v_add_f32 v199, v199, v231
    v_add_f32 v200, v200, v232
    v_add_f32 v201, v201, v233
    v_add_f32 v202, v202, v234
    v_add_f32 v203, v203, v235
    v_add_f32 v204, v204, v236
    v_add_f32 v205, v205, v237
    v_add_f32 v206, v206, v238
    v_add_f32 v207, v207, v239
    v_add_f32 v8, v160, v162
    v_add_f32 v8, v8, v164
    v_add_f32 v8, v8, v166
    v_add_f32 v8, v8, v168
    v_add_f32 v8, v8, v170
    v_add_f32 v8, v8, v172
    v_mul_f32 v8, 0x3e124925, v8
    v_add_f32 v9, v161, v163
    v_add_f32 v9, v9, v165
    v_add_f32 v9, v9, v167
    v_add_f32 v9, v9, v169
    v_add_f32 v9, v9, v171
    v_add_f32 v9, v9, v173
    v_mov_b32 v10, 0
    v_sub_f32 v11, v160, v8
    v_fmac_f32 v10, v11, v11
    v_sub_f32 v11, v162, v8
    v_fmac_f32 v10, v11, v11
    v_sub_f32 v11, v164, v8
    v_fmac_f32 v10, v11, v11
    v_sub_f32 v11, v166, v8
    v_fmac_f32 v10, v11, v11
    v_sub_f32 v11, v168, v8
    v_fmac_f32 v10, v11, v11
    v_sub_f32 v11, v170, v8
    v_fmac_f32 v10, v11, v11
    v_sub_f32 v11, v172, v8
    v_fmac_f32 v10, v11, v11
    v_fmac_f32 v9, 0x42800000, v10
    v_mul_f32 v9, 0x3b124925, v9
    v_add_f32 v9, 0x3727c5ac, v9
    v_rsq_f32 v9, v9
    v_lshlrev_b32 v7, 4, v2
    v_lshl_add_u32 v7, v3, 3, v7
    s_mul_i32 s61, s67, 112
    s_lshl_b32 s62, s50, 2
    s_add_u32 s61, s61, s62
    s_lshl_b32 s62, s51, 1
    s_add_u32 s61, s61, s62
    s_lshl_b32 s61, s61, 10
    s_add_u32 s61, s61, 41943040
    v_fma_f32 v16, -v8, v176, v16
    v_fma_f32 v32, -v8, v192, v32
    v_mul_f32 v16, v16, v9
    v_mul_f32 v32, v32, v9
    v_fma_f32 v17, -v8, v177, v17
    v_fma_f32 v33, -v8, v193, v33
    v_mul_f32 v17, v17, v9
    v_mul_f32 v33, v33, v9
    v_fma_f32 v18, -v8, v178, v18
    v_fma_f32 v34, -v8, v194, v34
    v_mul_f32 v18, v18, v9
    v_mul_f32 v34, v34, v9
    v_fma_f32 v19, -v8, v179, v19
    v_fma_f32 v35, -v8, v195, v35
    v_mul_f32 v19, v19, v9
    v_mul_f32 v35, v35, v9
    v_cvt_pk_bf16_f32 v12, v16, v17
    v_cvt_pk_bf16_f32 v13, v32, v33
    v_lshlrev_b32 v16, 16, v12
    v_and_b32 v17, 0xffff0000, v12
    v_lshlrev_b32 v32, 16, v13
    v_and_b32 v33, 0xffff0000, v13
    v_max_f32 v16, 0, v16
    v_max_f32 v17, 0, v17
    v_mul_f32 v16, v16, v32
    v_mul_f32 v17, v17, v33
    v_cvt_pk_bf16_f32 v48, v16, v17
    v_cvt_pk_bf16_f32 v12, v18, v19
    v_cvt_pk_bf16_f32 v13, v34, v35
    v_lshlrev_b32 v18, 16, v12
    v_and_b32 v19, 0xffff0000, v12
    v_lshlrev_b32 v34, 16, v13
    v_and_b32 v35, 0xffff0000, v13
    v_max_f32 v18, 0, v18
    v_max_f32 v19, 0, v19
    v_mul_f32 v18, v18, v34
    v_mul_f32 v19, v19, v35
    v_cvt_pk_bf16_f32 v49, v18, v19
    buffer_store_dwordx2 v[48:49], v7, s[36:39], s61 offen offset:0 sc1
    v_fma_f32 v20, -v8, v180, v20
    v_fma_f32 v36, -v8, v196, v36
    v_mul_f32 v20, v20, v9
    v_mul_f32 v36, v36, v9
    v_fma_f32 v21, -v8, v181, v21
    v_fma_f32 v37, -v8, v197, v37
    v_mul_f32 v21, v21, v9
    v_mul_f32 v37, v37, v9
    v_fma_f32 v22, -v8, v182, v22
    v_fma_f32 v38, -v8, v198, v38
    v_mul_f32 v22, v22, v9
    v_mul_f32 v38, v38, v9
    v_fma_f32 v23, -v8, v183, v23
    v_fma_f32 v39, -v8, v199, v39
    v_mul_f32 v23, v23, v9
    v_mul_f32 v39, v39, v9
    v_cvt_pk_bf16_f32 v12, v20, v21
    v_cvt_pk_bf16_f32 v13, v36, v37
    v_lshlrev_b32 v20, 16, v12
    v_and_b32 v21, 0xffff0000, v12
    v_lshlrev_b32 v36, 16, v13
    v_and_b32 v37, 0xffff0000, v13
    v_max_f32 v20, 0, v20
    v_max_f32 v21, 0, v21
    v_mul_f32 v20, v20, v36
    v_mul_f32 v21, v21, v37
    v_cvt_pk_bf16_f32 v50, v20, v21
    v_cvt_pk_bf16_f32 v12, v22, v23
    v_cvt_pk_bf16_f32 v13, v38, v39
    v_lshlrev_b32 v22, 16, v12
    v_and_b32 v23, 0xffff0000, v12
    v_lshlrev_b32 v38, 16, v13
    v_and_b32 v39, 0xffff0000, v13
    v_max_f32 v22, 0, v22
    v_max_f32 v23, 0, v23
    v_mul_f32 v22, v22, v38
    v_mul_f32 v23, v23, v39
    v_cvt_pk_bf16_f32 v51, v22, v23
    buffer_store_dwordx2 v[50:51], v7, s[36:39], s61 offen offset:512 sc1
    v_fma_f32 v24, -v8, v184, v24
    v_fma_f32 v40, -v8, v200, v40
    v_mul_f32 v24, v24, v9
    v_mul_f32 v40, v40, v9
    v_fma_f32 v25, -v8, v185, v25
    v_fma_f32 v41, -v8, v201, v41
    v_mul_f32 v25, v25, v9
    v_mul_f32 v41, v41, v9
    v_fma_f32 v26, -v8, v186, v26
    v_fma_f32 v42, -v8, v202, v42
    v_mul_f32 v26, v26, v9
    v_mul_f32 v42, v42, v9
    v_fma_f32 v27, -v8, v187, v27
    v_fma_f32 v43, -v8, v203, v43
    v_mul_f32 v27, v27, v9
    v_mul_f32 v43, v43, v9
    v_cvt_pk_bf16_f32 v12, v24, v25
    v_cvt_pk_bf16_f32 v13, v40, v41
    v_lshlrev_b32 v24, 16, v12
    v_and_b32 v25, 0xffff0000, v12
    v_lshlrev_b32 v40, 16, v13
    v_and_b32 v41, 0xffff0000, v13
    v_max_f32 v24, 0, v24
    v_max_f32 v25, 0, v25
    v_mul_f32 v24, v24, v40
    v_mul_f32 v25, v25, v41
    v_cvt_pk_bf16_f32 v52, v24, v25
    v_cvt_pk_bf16_f32 v12, v26, v27
    v_cvt_pk_bf16_f32 v13, v42, v43
    v_lshlrev_b32 v26, 16, v12
    v_and_b32 v27, 0xffff0000, v12
    v_lshlrev_b32 v42, 16, v13
    v_and_b32 v43, 0xffff0000, v13
    v_max_f32 v26, 0, v26
    v_max_f32 v27, 0, v27
    v_mul_f32 v26, v26, v42
    v_mul_f32 v27, v27, v43
    v_cvt_pk_bf16_f32 v53, v26, v27
    buffer_store_dwordx2 v[52:53], v7, s[36:39], s61 offen offset:1024 sc1
    v_fma_f32 v28, -v8, v188, v28
    v_fma_f32 v44, -v8, v204, v44
    v_mul_f32 v28, v28, v9
    v_mul_f32 v44, v44, v9
    v_fma_f32 v29, -v8, v189, v29
    v_fma_f32 v45, -v8, v205, v45
    v_mul_f32 v29, v29, v9
    v_mul_f32 v45, v45, v9
    v_fma_f32 v30, -v8, v190, v30
    v_fma_f32 v46, -v8, v206, v46
    v_mul_f32 v30, v30, v9
    v_mul_f32 v46, v46, v9
    v_fma_f32 v31, -v8, v191, v31
    v_fma_f32 v47, -v8, v207, v47
    v_mul_f32 v31, v31, v9
    v_mul_f32 v47, v47, v9
    v_cvt_pk_bf16_f32 v12, v28, v29
    v_cvt_pk_bf16_f32 v13, v44, v45
    v_lshlrev_b32 v28, 16, v12
    v_and_b32 v29, 0xffff0000, v12
    v_lshlrev_b32 v44, 16, v13
    v_and_b32 v45, 0xffff0000, v13
    v_max_f32 v28, 0, v28
    v_max_f32 v29, 0, v29
    v_mul_f32 v28, v28, v44
    v_mul_f32 v29, v29, v45
    v_cvt_pk_bf16_f32 v54, v28, v29
    v_cvt_pk_bf16_f32 v12, v30, v31
    v_cvt_pk_bf16_f32 v13, v46, v47
    v_lshlrev_b32 v30, 16, v12
    v_and_b32 v31, 0xffff0000, v12
    v_lshlrev_b32 v46, 16, v13
    v_and_b32 v47, 0xffff0000, v13
    v_max_f32 v30, 0, v30
    v_max_f32 v31, 0, v31
    v_mul_f32 v30, v30, v46
    v_mul_f32 v31, v31, v47
    v_cvt_pk_bf16_f32 v55, v30, v31
    buffer_store_dwordx2 v[54:55], v7, s[36:39], s61 offen offset:1536 sc1
    s_lshl_b32 s46, s67, 7
    s_add_u32 s46, s46, 24223744
    s_waitcnt vmcnt(0)
    s_mov_b64 exec, 1
    v_mov_b32 v8, 0
    v_mov_b32 v9, 1
    buffer_atomic_add v9, v8, s[36:39], s46 offen
    s_mov_b64 exec, -1
    s_add_u32 s67, s67, s69
    s_cmp_lt_u32 s67, 64
    s_cbranch_scc1 TKL_F1
    s_endpgm
TKP_F2:
    s_sub_u32 s66, s66, 520
    s_mul_i32 s67, s66, 1171
    s_lshr_b32 s67, s67, 16
    s_mul_i32 s68, s67, 56
    s_sub_u32 s68, s66, s68
    s_mov_b32 s69, 6
    v_mov_b32 v8, 0
    s_mov_b32 s46, 24198400
TKW_F2:
    s_sub_u32 s99, s99, 1
    s_cbranch_scc1 K2_ABORT
    buffer_load_dword v9, v8, s[36:39], s46 offen sc1
    s_waitcnt vmcnt(0)
    v_readfirstlane_b32 s47, v9
    s_cmp_ge_u32 s47, 203
    s_cbranch_scc1 TKW_F2_OK
    s_sleep 8
    s_branch TKW_F2
TKW_F2_OK:
TKL_F2:
    v_lshlrev_b32 v4, 4, v1
    v_and_b32 v2, 31, v1
    v_lshrrev_b32 v3, 5, v1
    s_lshr_b32 s50, s68, 2
    s_mul_i32 s53, s50, 112
    s_mul_i32 s51, s40, 28
    s_add_u32 s53, s53, s51
    s_lshl_b32 s53, s53, 10
    s_add_u32 s53, s53, 22020096
    s_mul_i32 s55, s67, 112
    s_add_u32 s55, s55, s51
    s_lshl_b32 s55, s55, 10
    s_add_u32 s55, s55, 41943040
    s_add_u32 s60, s53, 0
    buffer_load_dwordx4 a[0:3], v4, s[36:39], s60 offen offset:0
    buffer_load_dwordx4 a[4:7], v4, s[36:39], s60 offen offset:1024
    buffer_load_dwordx4 a[8:11], v4, s[36:39], s60 offen offset:2048
    buffer_load_dwordx4 a[12:15], v4, s[36:39], s60 offen offset:3072
    s_add_u32 s60, s53, 4096
    buffer_load_dwordx4 a[16:19], v4, s[36:39], s60 offen offset:0
    buffer_load_dwordx4 a[20:23], v4, s[36:39], s60 offen offset:1024
    buffer_load_dwordx4 a[24:27], v4, s[36:39], s60 offen offset:2048
    buffer_load_dwordx4 a[28:31], v4, s[36:39], s60 offen offset:3072
    s_add_u32 s60, s53, 8192
    buffer_load_dwordx4 a[32:35], v4, s[36:39], s60 offen offset:0
    buffer_load_dwordx4 a[36:39], v4, s[36:39], s60 offen offset:1024
    buffer_load_dwordx4 a[40:43], v4, s[36:39], s60 offen offset:2048
    buffer_load_dwordx4 a[44:47], v4, s[36:39], s60 offen offset:3072
    s_add_u32 s60, s53, 12288
    buffer_load_dwordx4 a[48:51], v4, s[36:39], s60 offen offset:0
    buffer_load_dwordx4 a[52:55], v4, s[36:39], s60 offen offset:1024
    buffer_load_dwordx4 a[56:59], v4, s[36:39], s60 offen offset:2048
    buffer_load_dwordx4 a[60:63], v4, s[36:39], s60 offen offset:3072
    s_add_u32 s60, s53, 16384
    buffer_load_dwordx4 a[64:67], v4, s[36:39], s60 offen offset:0
    buffer_load_dwordx4 a[68:71], v4, s[36:39], s60 offen offset:1024
    buffer_load_dwordx4 a[72:75], v4, s[36:39], s60 offen offset:2048
    buffer_load_dwordx4 a[76:79], v4, s[36:39], s60 offen offset:3072
    s_add_u32 s60, s53, 20480
    buffer_load_dwordx4 a[80:83], v4, s[36:39], s60 offen offset:0
    buffer_load_dwordx4 a[84:87], v4, s[36:39], s60 offen offset:1024
    buffer_load_dwordx4 a[88:91], v4, s[36:39], s60 offen offset:2048
    buffer_load_dwordx4 a[92:95], v4, s[36:39], s60 offen offset:3072
    s_add_u32 s60, s53, 24576
    buffer_load_dwordx4 a[96:99], v4, s[36:39], s60 offen offset:0
    buffer_load_dwordx4 a[100:103], v4, s[36:39], s60 offen offset:1024
    buffer_load_dwordx4 a[104:107], v4, s[36:39], s60 offen offset:2048
    buffer_load_dwordx4 a[108:111], v4, s[36:39], s60 offen offset:3072
    v_lshlrev_b32 v7, 4, v2
    v_lshl_add_u32 v7, v3, 3, v7
    s_mul_i32 s58, s67, 28
    s_lshl_b32 s59, s50, 1
    s_add_u32 s58, s58, s59
    s_lshr_b32 s59, s40, 1
    s_add_u32 s58, s58, s59
    s_lshl_b32 s58, s58, 10
    s_and_b32 s59, s40, 1
    s_lshl_b32 s59, s59, 9
    s_add_u32 s58, s58, s59
    s_add_u32 s58, s58, 38797312
    v_mov_b32 v8, 0
    s_lshl_b32 s46, s67, 7
    s_add_u32 s46, s46, 24223744
TK_F2_W:
    s_sub_u32 s99, s99, 1
    s_cbranch_scc1 K2_ABORT
    buffer_load_dword v9, v8, s[36:39], s46 offen sc1
    s_waitcnt vmcnt(0)
    v_readfirstlane_b32 s47, v9
    s_cmp_ge_u32 s47, 56
    s_cbranch_scc1 TK_F2_W_OK
    s_sleep 8
    s_branch TK_F2_W
TK_F2_W_OK:
    s_add_u32 s60, s55, 0
    buffer_load_dwordx4 v[48:51], v4, s[36:39], s60 offen offset:0 sc1
    buffer_load_dwordx4 v[52:55], v4, s[36:39], s60 offen offset:1024 sc1
    buffer_load_dwordx4 v[56:59], v4, s[36:39], s60 offen offset:2048 sc1
    buffer_load_dwordx4 v[60:63], v4, s[36:39], s60 offen offset:3072 sc1
    s_add_u32 s60, s55, 4096
    buffer_load_dwordx4 v[64:67], v4, s[36:39], s60 offen offset:0 sc1
    buffer_load_dwordx4 v[68:71], v4, s[36:39], s60 offen offset:1024 sc1
    buffer_load_dwordx4 v[72:75], v4, s[36:39], s60 offen offset:2048 sc1
    buffer_load_dwordx4 v[76:79], v4, s[36:39], s60 offen offset:3072 sc1
    s_add_u32 s60, s55, 8192
    buffer_load_dwordx4 v[80:83], v4, s[36:39], s60 offen offset:0 sc1
    buffer_load_dwordx4 v[84:87], v4, s[36:39], s60 offen offset:1024 sc1
    buffer_load_dwordx4 v[88:91], v4, s[36:39], s60 offen offset:2048 sc1
    buffer_load_dwordx4 v[92:95], v4, s[36:39], s60 offen offset:3072 sc1
    s_add_u32 s60, s55, 12288
    buffer_load_dwordx4 v[96:99], v4, s[36:39], s60 offen offset:0 sc1
    buffer_load_dwordx4 v[100:103], v4, s[36:39], s60 offen offset:1024 sc1
    buffer_load_dwordx4 v[104:107], v4, s[36:39], s60 offen offset:2048 sc1
    buffer_load_dwordx4 v[108:111], v4, s[36:39], s60 offen offset:3072 sc1
    s_add_u32 s60, s55, 16384
    buffer_load_dwordx4 v[112:115], v4, s[36:39], s60 offen offset:0 sc1
    buffer_load_dwordx4 v[116:119], v4, s[36:39], s60 offen offset:1024 sc1
    buffer_load_dwordx4 v[120:123], v4, s[36:39], s60 offen offset:2048 sc1
    buffer_load_dwordx4 v[124:127], v4, s[36:39], s60 offen offset:3072 sc1
    s_add_u32 s60, s55, 20480
    buffer_load_dwordx4 v[128:131], v4, s[36:39], s60 offen offset:0 sc1
    buffer_load_dwordx4 v[132:135], v4, s[36:39], s60 offen offset:1024 sc1
    buffer_load_dwordx4 v[136:139], v4, s[36:39], s60 offen offset:2048 sc1
    buffer_load_dwordx4 v[140:143], v4, s[36:39], s60 offen offset:3072 sc1
    s_add_u32 s60, s55, 24576
    buffer_load_dwordx4 v[144:147], v4, s[36:39], s60 offen offset:0 sc1
    buffer_load_dwordx4 v[148:151], v4, s[36:39], s60 offen offset:1024 sc1
    buffer_load_dwordx4 v[152:155], v4, s[36:39], s60 offen offset:2048 sc1
    buffer_load_dwordx4 v[156:159], v4, s[36:39], s60 offen offset:3072 sc1
    buffer_load_dwordx2 v[44:45], v7, s[36:39], s58 offen sc1
    s_waitcnt vmcnt(28)
    v_mfma_f32_32x32x16_bf16 v[16:31], a[0:3], v[48:51], 0
    s_waitcnt vmcnt(27)
    v_mfma_f32_32x32x16_bf16 v[16:31], a[4:7], v[52:55], v[16:31]
    s_waitcnt vmcnt(26)
    v_mfma_f32_32x32x16_bf16 v[16:31], a[8:11], v[56:59], v[16:31]
    s_waitcnt vmcnt(25)
    v_mfma_f32_32x32x16_bf16 v[16:31], a[12:15], v[60:63], v[16:31]
    s_waitcnt vmcnt(24)
    v_mfma_f32_32x32x16_bf16 v[16:31], a[16:19], v[64:67], v[16:31]
    s_waitcnt vmcnt(23)
    v_mfma_f32_32x32x16_bf16 v[16:31], a[20:23], v[68:71], v[16:31]
    s_waitcnt vmcnt(22)
    v_mfma_f32_32x32x16_bf16 v[16:31], a[24:27], v[72:75], v[16:31]
    s_waitcnt vmcnt(21)
    v_mfma_f32_32x32x16_bf16 v[16:31], a[28:31], v[76:79], v[16:31]
    s_waitcnt vmcnt(20)
    v_mfma_f32_32x32x16_bf16 v[16:31], a[32:35], v[80:83], v[16:31]
    s_waitcnt vmcnt(19)
    v_mfma_f32_32x32x16_bf16 v[16:31], a[36:39], v[84:87], v[16:31]
    s_waitcnt vmcnt(18)
    v_mfma_f32_32x32x16_bf16 v[16:31], a[40:43], v[88:91], v[16:31]
    s_waitcnt vmcnt(17)
    v_mfma_f32_32x32x16_bf16 v[16:31], a[44:47], v[92:95], v[16:31]
    s_waitcnt vmcnt(16)
    v_mfma_f32_32x32x16_bf16 v[16:31], a[48:51], v[96:99], v[16:31]
    s_waitcnt vmcnt(15)
    v_mfma_f32_32x32x16_bf16 v[16:31], a[52:55], v[100:103], v[16:31]
    s_waitcnt vmcnt(14)
    v_mfma_f32_32x32x16_bf16 v[16:31], a[56:59], v[104:107], v[16:31]
    s_waitcnt vmcnt(13)
    v_mfma_f32_32x32x16_bf16 v[16:31], a[60:63], v[108:111], v[16:31]
    s_waitcnt vmcnt(12)
    v_mfma_f32_32x32x16_bf16 v[16:31], a[64:67], v[112:115], v[16:31]
    s_waitcnt vmcnt(11)
    v_mfma_f32_32x32x16_bf16 v[16:31], a[68:71], v[116:119], v[16:31]
    s_waitcnt vmcnt(10)
    v_mfma_f32_32x32x16_bf16 v[16:31], a[72:75], v[120:123], v[16:31]
    s_waitcnt vmcnt(9)
    v_mfma_f32_32x32x16_bf16 v[16:31], a[76:79], v[124:127], v[16:31]
    s_waitcnt vmcnt(8)
    v_mfma_f32_32x32x16_bf16 v[16:31], a[80:83], v[128:131], v[16:31]
    s_waitcnt vmcnt(7)
    v_mfma_f32_32x32x16_bf16 v[16:31], a[84:87], v[132:135], v[16:31]
    s_waitcnt vmcnt(6)
    v_mfma_f32_32x32x16_bf16 v[16:31], a[88:91], v[136:139], v[16:31]
    s_waitcnt vmcnt(5)
    v_mfma_f32_32x32x16_bf16 v[16:31], a[92:95], v[140:143], v[16:31]
    s_waitcnt vmcnt(4)
    v_mfma_f32_32x32x16_bf16 v[16:31], a[96:99], v[144:147], v[16:31]
    s_waitcnt vmcnt(3)
    v_mfma_f32_32x32x16_bf16 v[16:31], a[100:103], v[148:151], v[16:31]
    s_waitcnt vmcnt(2)
    v_mfma_f32_32x32x16_bf16 v[16:31], a[104:107], v[152:155], v[16:31]
    s_waitcnt vmcnt(1)
    v_mfma_f32_32x32x16_bf16 v[16:31], a[108:111], v[156:159], v[16:31]
    v_lshlrev_b32 v5, 4, v1
    s_lshl_b32 s59, s40, 12
    s_add_u32 s59, s59, 141056
    v_add_u32 v6, s59, v5
    s_lshl_b32 s59, s40, 10
    s_add_u32 s59, s59, 141056
    v_add_u32 v5, s59, v5
    s_nop 7
    s_nop 3
    ds_write_b128 v6, v[16:19] offset:0
    ds_write_b128 v6, v[20:23] offset:1024
    ds_write_b128 v6, v[24:27] offset:2048
    ds_write_b128 v6, v[28:31] offset:3072
    s_waitcnt lgkmcnt(0)
    s_barrier
    ds_read_b128 v[48:51], v5 offset:0
    ds_read_b128 v[52:55], v5 offset:4096
    ds_read_b128 v[56:59], v5 offset:8192
    ds_read_b128 v[60:63], v5 offset:12288
    s_waitcnt lgkmcnt(0)
    s_barrier
    v_add_f32 v48, v48, v52
    v_add_f32 v56, v56, v60
    v_add_f32 v48, v48, v56
    v_add_f32 v49, v49, v53
    v_add_f32 v57, v57, v61
    v_add_f32 v49, v49, v57
    v_add_f32 v50, v50, v54
    v_add_f32 v58, v58, v62
    v_add_f32 v50, v50, v58
    v_add_f32 v51, v51, v55
    v_add_f32 v59, v59, v63
    v_add_f32 v51, v51, v59
    v_cvt_pk_bf16_f32 v12, v48, v49
    v_cvt_pk_bf16_f32 v13, v50, v51
    v_lshlrev_b32 v8, 16, v12
    v_and_b32 v9, 0xffff0000, v12
    v_lshlrev_b32 v10, 16, v13
    v_and_b32 v11, 0xffff0000, v13
    s_waitcnt vmcnt(0)
    v_lshlrev_b32 v48, 16, v44
    v_and_b32 v49, 0xffff0000, v44
    v_lshlrev_b32 v50, 16, v45
    v_and_b32 v51, 0xffff0000, v45
    v_add_f32 v8, v8, v48
    v_add_f32 v9, v9, v49
    v_add_f32 v10, v10, v50
    v_add_f32 v11, v11, v51
    v_cvt_pk_bf16_f32 v14, v8, v9
    v_cvt_pk_bf16_f32 v15, v10, v11
    s_mov_b32 s44, s30
    s_and_b32 s45, s31, 0xffff
    s_mov_b32 s46, 1835008
    s_mov_b32 s47, 0x00020000
    v_mul_u32_u24 v6, 896, v2
    v_lshl_add_u32 v6, v3, 3, v6
    s_mul_i32 s59, s67, 32*896
    s_lshl_b32 s61, s50, 6
    s_add_u32 s59, s59, s61
    s_lshl_b32 s61, s40, 4
    s_add_u32 s59, s59, s61
    buffer_store_dwordx2 v[14:15], v6, s[44:47], s59 offen
    s_add_u32 s67, s67, s69
    s_cmp_lt_u32 s67, 64
    s_cbranch_scc1 TKL_F2
    s_endpgm
.section .rodata,"a"
.p2align 6
.amdhsa_kernel k1_kernel
  .amdhsa_next_free_vgpr 256
  .amdhsa_next_free_sgpr 102
  .amdhsa_accum_offset 256
  .amdhsa_group_segment_fixed_size 0
  .amdhsa_kernarg_size 112
  .amdhsa_user_sgpr_count 2
  .amdhsa_user_sgpr_kernarg_segment_ptr 1
  .amdhsa_system_sgpr_workgroup_id_x 1
.end_amdhsa_kernel
.p2align 6
.amdhsa_kernel k2_kernel
  .amdhsa_next_free_vgpr 512
  .amdhsa_next_free_sgpr 102
  .amdhsa_accum_offset 256
  .amdhsa_group_segment_fixed_size 0
  .amdhsa_kernarg_size 112
  .amdhsa_user_sgpr_count 2
  .amdhsa_user_sgpr_kernarg_segment_ptr 1
  .amdhsa_system_sgpr_workgroup_id_x 1
.end_amdhsa_kernel
```
